```python
import torch

def _softmax(x, axis=-1):
    return torch.softmax(x, dim=axis)

def _gelu(x):
    return torch.nn.functional.gelu(x, approximate='tanh')

def _silu(x):
    return torch.nn.functional.silu(x)

def _sigmoid(x):
    return torch.sigmoid(x)

def _layernorm(x, axis=-1, eps=1e-05):
    m = x.mean(dim=axis, keepdim=True)
    v = x.var(dim=axis, keepdim=True, unbiased=False)
    return (x - m) / torch.sqrt(v + eps)

def _scatter_add(tgt, idx, src, axis=0):
    return tgt.clone().index_add_(axis, idx, src)

def _segment_sum(src, seg, n):
    out = torch.zeros((n,) + src.shape[1:], dtype=src.dtype)
    return out.index_add_(0, seg, src)

def _pad(x, pw):
    flat = tuple((v for pair in reversed(pw) for v in pair))
    return torch.nn.functional.pad(x, flat)
kernel_name = 'adaLN_cond__ssm_conv_s4d__mixer_s_mlp__prompt'

def setup_inputs():

    _w = lambda a: (lambda t: t.to(torch.bfloat16) if t.is_floating_point() else t)(torch.as_tensor(a))

    def _A_setup():
        Bsz, L, D, N = (1, 2048, 640, 192)
        return {'u': _w((lambda *s: torch.randn(*s, dtype=torch.bfloat16) * 0.05)(Bsz, L, D)), 'log_A_real': _w((lambda *s: torch.randn(*s, dtype=torch.bfloat16) * 3.2)(D, N) * 0.5), 'A_imag': _w((lambda *s: torch.randn(*s, dtype=torch.bfloat16) * 0.1)(D, N) * 3.14), 'C_real': _w((lambda *s: torch.randn(*s, dtype=torch.bfloat16) * 0.8)(D, N) / N ** 0.5), 'C_imag': _w((lambda *s: torch.randn(*s, dtype=torch.bfloat16) * 0.8)(D, N) / N ** 0.5), 'log_dt': _w((lambda *s: torch.randn(*s, dtype=torch.bfloat16) * 0.1)(D) * 0.5 - 4.0), 'D_skip': _w((lambda *s: torch.randn(*s, dtype=torch.bfloat16) * 0.2)(D))}
    _A_in = _A_setup()

    def _B_setup():
        B, S, D, F = (1, 2048, 640, 1536)
        return {'x': _w((lambda *s: torch.randn(*s, dtype=torch.bfloat16) * 0.05)(B, S, D)), 'w1': _w((lambda *s: torch.randn(*s, dtype=torch.bfloat16) * 3.2)(D, D) * D ** (-0.5)), 'w2': _w((lambda *s: torch.randn(*s, dtype=torch.bfloat16) * 3.2)(D, D) * D ** (-0.5)), 'w3': _w((lambda *s: torch.randn(*s, dtype=torch.bfloat16) * 3.2)(D, F) * D ** (-0.5)), 'w4': _w((lambda *s: torch.randn(*s, dtype=torch.bfloat16) * 3.2)(F, D) * F ** (-0.5))}
    _B_in = _B_setup()
    return {'A_u': _A_in['u'], 'A_log_A_real': _A_in['log_A_real'], 'A_A_imag': _A_in['A_imag'], 'A_C_real': _A_in['C_real'], 'A_C_imag': _A_in['C_imag'], 'A_log_dt': _A_in['log_dt'], 'A_D_skip': _A_in['D_skip'], 'B_x': _B_in['x'], 'B_w1': _B_in['w1'], 'B_w2': _B_in['w2'], 'B_w3': _B_in['w3'], 'B_w4': _B_in['w4'], 'c': _w((lambda *s: torch.randn(*s, dtype=torch.bfloat16) * 0.1)(1, 640) * 8.0), 'w_mod': _w((lambda *s: torch.randn(*s, dtype=torch.bfloat16) * 0.1)(640, 6 * 640) * 640 ** (-0.5) * 8.0)}

def reference(A_u, A_log_A_real, A_A_imag, A_C_real, A_C_imag, A_log_dt, A_D_skip, B_x, B_w1, B_w2, B_w3, B_w4, c, w_mod):

    def _A_ref(u, log_A_real, A_imag, C_real, C_imag, log_dt, D_skip):
        L = u.shape[1]
        dt = torch.exp(log_dt)
        A = -torch.exp(log_A_real) + 1j * A_imag
        C = (C_real + 1j * C_imag) * dt[:, None]
        pos = (lambda x, dt: x.to(dt))(torch.arange(L), log_dt.dtype)
        P = torch.exp((A * dt[:, None])[:, :, None] * pos[None, None, :])
        K = 2.0 * torch.einsum('dn,dnl->dl', C, P).real
        L2 = 2 * L
        u_t = (lambda x, *d: x.permute(*d))(u, 0, 2, 1)
        Kf = (lambda x, *a, **k: torch.fft.rfft(x.float(), *a, **k))(K, L2)
        Uf = (lambda x, *a, **k: torch.fft.rfft(x.float(), *a, **k))(u_t, L2)
        y = (lambda x, *a, **k: torch.fft.irfft(x, *a, **k).to(torch.bfloat16))(Uf * Kf[None, :, :], L2)[:, :, :L]
        y = (lambda x, *d: x.permute(*d))(y, 0, 2, 1)
        return y + u * D_skip[None, None, :]

    def _B_ref(x, w1, w2, w3, w4):
        B, S, D = x.shape
        h = _gelu(_layernorm(x, axis=-1) @ w1)
        c = D // 4
        g0 = _pad(h[:, :, 0 * c:1 * c], ((0, 0), (1, 0), (0, 0)))[:, :S, :]
        g1 = _pad(h[:, :, 1 * c:2 * c], ((0, 0), (0, 1), (0, 0)))[:, 1:, :]
        g2 = _pad(h[:, :, 2 * c:3 * c], ((0, 0), (2, 0), (0, 0)))[:, :S, :]
        g3 = _pad(h[:, :, 3 * c:], ((0, 0), (0, 2), (0, 0)))[:, 2:, :]
        hs = torch.concatenate([g0, g1, g2, g3], axis=-1) @ w2
        x1 = x + hs
        h2 = _gelu(_layernorm(x1, axis=-1) @ w3) @ w4
        return x1 + h2
    x = A_u
    mod = (_silu(c) @ w_mod).reshape(c.shape[0], 6, 1, -1)
    sa, ca, ga, sb, cb, gb = (mod[:, 0].clone(), mod[:, 1].clone(), mod[:, 2].clone(), mod[:, 3].clone(), mod[:, 4].clone(), mod[:, 5].clone())
    h = _layernorm(x, axis=-1) * (1 + ca) + sa
    x = x + ga * _A_ref(h, A_log_A_real, A_A_imag, A_C_real, A_C_imag, A_log_dt, A_D_skip)
    h = _layernorm(x, axis=-1) * (1 + cb) + sb
    x = x + gb * _B_ref(h, B_w1, B_w2, B_w3, B_w4)
    return x
```

```asm
; @launch grid=(256,1,1) block=(512,1,1) lds=163840
.amdgcn_target "amdgcn-amd-amdhsa--gfx950"
.text
.globl adaLN_cond__ssm_conv_s4d__mixer_s_mlp__prompt_kernel
.p2align 8
.type adaLN_cond__ssm_conv_s4d__mixer_s_mlp__prompt_kernel,@function
adaLN_cond__ssm_conv_s4d__mixer_s_mlp__prompt_kernel:
  s_cmp_ge_u32 s2, 256
  s_cbranch_scc1 L_END
  s_load_dwordx16 s[8:23], s[0:1], 0
  s_load_dwordx16 s[24:39], s[0:1], 64
  s_load_dwordx2 s[40:41], s[0:1], 128
  v_and_b32 v1, 63, v0
  v_lshrrev_b32 v4, 6, v0
  v_and_b32 v2, 15, v1
  v_readfirstlane_b32 s3, v4
  v_lshrrev_b32 v3, 4, v1
  v_lshlrev_b32 v249, 4, v1
  v_mov_b32 v248, 0
  s_mov_b32 s95, 0
  s_getreg_b32 s96, hwreg(HW_REG_XCC_ID)
  s_cmp_lg_u32 s3, 6
  s_cbranch_scc1 L_NOCP
  s_getpc_b64 s[58:59]
  s_lshr_b32 s57, s2, 3
  s_and_b32 s57, s57, 7
  v_lshl_add_u32 v6, v1, 3, s57
  v_min_u32 v6, 328, v6
  v_lshlrev_b32 v6, 7, v6
  v_mov_b32 v7, s59
  v_add_co_u32 v6, vcc, s58, v6
  s_nop 1
  v_addc_co_u32 v7, vcc, 0, v7, vcc
  global_load_dword v247, v[6:7], off
L_NOCP:
  v_and_b32 v5, 31, v1
  v_lshrrev_b32 v4, 5, v0
  s_and_b32 s56, s2, 127
  s_lshl_b32 s56, s56, 4
  v_add_u32 v6, s56, v4
  v_mul_u32_u24 v6, 1280, v6
  v_lshl_add_u32 v7, v5, 3, v6
  v_lshl_add_u32 v6, v5, 4, v6
  s_waitcnt lgkmcnt(0)
  s_load_dword s42, s[40:41], 0
  s_mov_b32 s101, 26214144
  s_load_dword s43, s[40:41], s101
  s_mov_b32 s44, s40
  s_mov_b32 s45, s41
  s_mov_b32 s46, 27262976
  s_mov_b32 s47, 0x20000
  s_cmp_ge_u32 s2, 160
  s_cbranch_scc1 L_HELPER
  s_and_b32 s60, s2, 7
  s_mul_i32 s60, s60, 20
  s_lshr_b32 s61, s2, 3
  s_add_u32 s60, s60, s61
  s_and_b32 s61, s3, 3
  s_lshr_b32 s62, s3, 2
  s_lshl_b32 s63, s60, 2
  s_add_u32 s63, s63, s61
  s_mul_i32 s64, s63, 384
  v_lshl_add_u32 v26, v1, 1, s64
  s_lshl_b32 s64, s63, 1
  v_mov_b32 v27, s64
  global_load_ushort v44, v27, s[18:19]
  global_load_ushort v32, v26, s[10:11] offset:0 nt
  global_load_ushort v35, v26, s[12:13] offset:0 nt
  global_load_ushort v33, v26, s[10:11] offset:128 nt
  global_load_ushort v36, v26, s[12:13] offset:128 nt
  global_load_ushort v34, v26, s[10:11] offset:256 nt
  global_load_ushort v37, v26, s[12:13] offset:256 nt
  s_cmp_eq_u32 s62, 0
  s_cbranch_scc1 L_NOC
  global_load_ushort v38, v26, s[14:15] offset:0 nt
  global_load_ushort v41, v26, s[16:17] offset:0 nt
  global_load_ushort v39, v26, s[14:15] offset:128 nt
  global_load_ushort v42, v26, s[16:17] offset:128 nt
  global_load_ushort v40, v26, s[14:15] offset:256 nt
  global_load_ushort v43, v26, s[16:17] offset:256 nt
L_NOC:
  s_barrier
  s_lshl_b32 s64, s60, 3
  v_mov_b32 v27, s64
  global_load_dwordx2 v[46:47], v27, s[20:21]
  s_cmp_ge_u32 s2, 128
  s_cselect_b64 exec, 1, -1
  global_load_dwordx4 v[16:19], v6, s[8:9] nt
  global_load_dwordx4 v[20:23], v6, s[8:9] offset:512 nt
  global_load_dwordx2 v[24:25], v7, s[8:9] offset:1024 nt
  s_mov_b64 exec, -1
  v_lshlrev_b32 v13, 5, v0
  s_mov_b32 s70, 65536
  s_mov_b32 s71, 81920
  v_min_u32 v12, 11, v1
  v_lshrrev_b32 v26, 2, v12
  v_mul_u32_u24 v26, 5120, v26
  v_and_b32 v27, 1, v12
  v_mul_u32_u24 v27, 30720, v27
  v_and_b32 v28, 2, v12
  v_lshlrev_b32 v28, 3, v28
  v_add3_u32 v12, v26, v27, v28
  s_lshl_b32 s72, s60, 5
  s_add_u32 s72, s72, 147456
  v_lshlrev_b32 v14, 2, v0
  v_add_u32 v14, 113152, v14
  v_mul_u32_u24 v48, 1296, v4
  v_add_u32 v48, 124928, v48
  v_lshl_add_u32 v49, v5, 3, v48
  v_lshl_add_u32 v48, v5, 4, v48
  v_lshrrev_b32 v31, 3, v0
  v_and_b32 v30, 7, v0
  v_mul_u32_u24 v51, 2592, v30
  v_lshl_add_u32 v51, v31, 3, v51
  v_add_u32 v51, 124928, v51
  s_mov_b32 s57, 1507328
  v_lshlrev_b32 v30, 4, v30
  v_lshlrev_b32 v244, 4, v4
  v_add_u32 v26, 0, v31
  v_mul_u32_u24 v27, 3277, v26
  v_lshrrev_b32 v27, 16, v27
  v_mul_lo_u32 v27, v27, s57
  v_lshl_add_u32 v27, v26, 14, v27
  v_mad_u32_u24 v26, v26, 5, s2
  v_and_b32 v26, 127, v26
  v_lshl_add_u32 v26, v26, 7, v30
  v_add_u32 v54, v26, v27
  v_add_u32 v26, 64, v31
  v_mul_u32_u24 v27, 3277, v26
  v_lshrrev_b32 v27, 16, v27
  v_mul_lo_u32 v27, v27, s57
  v_lshl_add_u32 v27, v26, 14, v27
  v_mad_u32_u24 v26, v26, 5, s2
  v_and_b32 v26, 127, v26
  v_lshl_add_u32 v26, v26, 7, v30
  v_add_u32 v55, v26, v27
  v_add_u32 v26, 128, v31
  v_mul_u32_u24 v27, 3277, v26
  v_lshrrev_b32 v27, 16, v27
  v_mul_lo_u32 v27, v27, s57
  v_lshl_add_u32 v27, v26, 14, v27
  v_mad_u32_u24 v26, v26, 5, s2
  v_and_b32 v26, 127, v26
  v_lshl_add_u32 v26, v26, 7, v30
  v_add_u32 v50, v26, v27
  s_mul_i32 s66, s61, 17408
  s_mov_b32 s68, 8704
  s_mov_b32 s69, 0
  s_cmp_lg_u32 s62, 0
  s_cbranch_scc1 L_KA1
  v_and_b32 v26, 3, v2
  v_mul_u32_u24 v26, 2624, v26
  v_and_b32 v27, 12, v2
  v_lshlrev_b32 v28, 3, v3
  v_sub_u32 v27, v28, v27
  v_lshl_add_u32 v26, v27, 1, v26
  s_mul_i32 s64, s61, 10496
  s_add_u32 s64, s64, 69080
  v_add_u32 v8, s64, v26
  s_mul_i32 s64, s61, 4608
  s_add_u32 s64, s64, 112672
  v_lshlrev_b32 v27, 4, v3
  v_lshl_add_u32 v26, v2, 5, v27
  v_add_u32 v9, s64, v26
  s_lshl_b32 s64, s61, 13
  s_add_u32 s64, s64, 131072
  v_lshlrev_b32 v26, 6, v3
  v_xor_b32 v26, v26, v249
  v_add_u32 v10, s64, v26
  s_sub_u32 s84, 3, s3
  s_min_u32 s84, s84, 2
  s_lshr_b32 s73, s84, 1
  s_mul_i32 s76, s73, s3
  s_lshl_b32 s76, s76, 1
  s_add_u32 s73, s73, 4
  v_lshrrev_b32 v26, s73, v1
  v_add_u32 v26, s76, v26
  s_lshl_b32 s77, 1, s73
  s_sub_u32 s78, s77, 1
  v_and_b32 v27, s78, v1
  s_lshl_b32 s79, s84, 8
  s_add_u32 s79, s79, 147712
  s_lshl_b32 s80, 8, s84
  s_cmp_eq_u32 s84, 0
  s_cselect_b32 s79, 147456, s79
  s_cselect_b32 s80, 0, s80
  s_sub_u32 s81, 5, s84
  v_lshlrev_b32 v28, s81, v27
  v_mul_u32_u24 v29, 2080, v26
  v_add3_u32 v60, v28, v29, s79
  s_sub_u32 s80, 2285, s80
  v_sub_u32 v28, s80, v27
  v_mul_u32_u24 v11, 10496, v26
  v_lshl_add_u32 v11, v28, 5, v11
  v_cmp_eq_u32 s[86:87], 0, v27
  v_lshrrev_b32 v26, 2, v1
  v_mul_u32_u24 v26, 2624, v26
  v_and_b32 v27, 3, v1
  v_lshl_add_u32 v26, v27, 4, v26
  v_add_u32 v15, 73152, v26
  s_cmp_eq_u32 s3, 0
  s_cbranch_scc1 L_KA2
  v_subrev_u32 v27, 64, v0
  v_lshrrev_b32 v26, 5, v27
  v_mul_u32_u24 v26, 4608, v26
  v_lshl_add_u32 v26, v5, 4, v26
  v_add_u32 v15, 112640, v26
  s_branch L_KA2
L_KA1:
  v_lshrrev_b32 v27, 5, v1
  v_mul_u32_u24 v82, 272, v5
  v_lshl_add_u32 v82, v27, 4, v82
  s_mul_i32 s67, s61, 11424
  s_add_u32 s64, s67, 69632
  v_add_u32 v83, s64, v82
  v_add_u32 v82, s66, v82
  s_add_u32 s66, s67, 12288
  s_mov_b32 s68, 5712
  s_mov_b32 s67, 8704
  s_mul_i32 s64, s61, 2080
  s_add_u32 s64, s64, 147464
  v_lshlrev_b32 v28, 4, v5
  v_lshl_add_u32 v28, v27, 3, v28
  v_add_u32 v56, s64, v28
  v_sub_u32 v28, 3, v27
  v_lshlrev_b32 v28, v28, v5
  v_lshlrev_b32 v29, 8, v27
  v_add3_u32 v57, v28, v29, s64
  v_mul_u32_u24 v30, 124, v27
  v_add_u32 v58, v57, v30
  v_lshl_add_u32 v59, v5, 1, v29
  v_add_u32 v59, s64, v59
  s_sub_u32 s65, s64, 8
  v_mov_b32 v26, s65
  v_mov_b32 v28, 0
  v_mov_b32 v29, 0
  ds_write_b64 v26, v[28:29]
L_KA2:
  s_mul_i32 s63, s60, 640
  v_lshl_add_u32 v6, v0, 4, s63
  v_and_b32 v6, 0x3fff, v6
  v_xor_b32 v7, 0x2000, v6
  s_and_b32 s63, s2, 7
  s_mul_i32 s63, s63, 1835008
  s_lshr_b32 s59, s2, 3
  s_lshl_b32 s59, s59, 14
  s_add_u32 s63, s63, s59
  s_add_u32 s63, s63, 10485760
  s_waitcnt lgkmcnt(0)
  s_add_u32 s42, s42, 0x9e3779b9
  s_add_u32 s43, s43, 0x85ebca6b
  v_mov_b32 v242, s42
  v_mov_b32 v243, s43
  s_waitcnt vmcnt(4)
  v_lshlrev_b32 v44, 16, v44
  v_lshlrev_b32 v32, 16, v32
  v_lshlrev_b32 v33, 16, v33
  v_lshlrev_b32 v34, 16, v34
  v_mul_f32 v44, 0x3fb8aa3b, v44
  v_mul_f32 v32, 0x3fb8aa3b, v32
  v_mul_f32 v33, 0x3fb8aa3b, v33
  v_mul_f32 v34, 0x3fb8aa3b, v34
  v_exp_f32 v44, v44
  v_exp_f32 v32, v32
  v_exp_f32 v33, v33
  v_exp_f32 v34, v34
  v_lshlrev_b32 v35, 16, v35
  v_lshlrev_b32 v36, 16, v36
  v_lshlrev_b32 v37, 16, v37
  v_cvt_pk_bf16_f32 v44, v44, v32
  v_cvt_pk_bf16_f32 v33, v33, v34
  v_and_b32 v32, 0xffff0000, v44
  v_lshlrev_b32 v44, 16, v44
  v_and_b32 v34, 0xffff0000, v33
  v_lshlrev_b32 v33, 16, v33
  v_mul_f32 v32, v32, v44
  v_mul_f32 v33, v33, v44
  v_mul_f32 v34, v34, v44
  v_mul_f32 v35, v35, v44
  v_mul_f32 v36, v36, v44
  v_mul_f32 v37, v37, v44
  v_mul_f32 v32, 0xbfb8aa3b, v32
  v_mul_f32 v35, 0x3e22f983, v35
  v_mul_f32 v33, 0xbfb8aa3b, v33
  v_mul_f32 v36, 0x3e22f983, v36
  v_mul_f32 v34, 0xbfb8aa3b, v34
  v_mul_f32 v37, 0x3e22f983, v37
  s_cmp_eq_u32 s62, 0
  s_cbranch_scc1 L_KGS
  v_lshlrev_b32 v38, 16, v38
  v_lshlrev_b32 v39, 16, v39
  v_lshlrev_b32 v40, 16, v40
  v_lshlrev_b32 v41, 16, v41
  v_lshlrev_b32 v42, 16, v42
  v_lshlrev_b32 v43, 16, v43
  v_max3_f32 v26, abs(v38), abs(v39), abs(v40)
  v_max3_f32 v26, abs(v41), abs(v42), v26
  v_max_f32 v26, abs(v43), v26
  s_nop 1
  v_max_f32_dpp v26, v26, v26 quad_perm:[1,0,3,2] row_mask:0xf bank_mask:0xf
  s_nop 1
  v_max_f32_dpp v26, v26, v26 quad_perm:[2,3,0,1] row_mask:0xf bank_mask:0xf
  s_nop 1
  v_max_f32_dpp v26, v26, v26 row_half_mirror row_mask:0xf bank_mask:0xf
  s_nop 1
  v_max_f32_dpp v26, v26, v26 row_mirror row_mask:0xf bank_mask:0xf
  s_nop 1
  v_max_f32_dpp v26, v26, v26 row_bcast:15 row_mask:0xa bank_mask:0xf
  s_nop 1
  v_max_f32_dpp v26, v26, v26 row_bcast:31 row_mask:0xc bank_mask:0xf
  s_nop 0
  v_readlane_b32 s64, v26, 63
  s_nop 0
  s_lshr_b32 s64, s64, 23
  s_min_u32 s64, s64, 253
  s_sub_u32 s65, 254, s64
  s_lshl_b32 s65, s65, 23
  s_add_u32 s64, s64, 1
  s_lshl_b32 s64, s64, 23
  s_nop 0
  v_mul_f32 v80, s64, v44
  v_mov_b32 v64, 0
  v_mov_b32 v65, 0
  v_mov_b32 v66, 0
  v_mov_b32 v67, 0
  v_mov_b32 v68, 0
  v_mov_b32 v69, 0
  v_mov_b32 v70, 0
  v_mov_b32 v71, 0
  v_mov_b32 v72, 0
  v_mov_b32 v73, 0
  v_mov_b32 v74, 0
  v_mov_b32 v75, 0
  v_mov_b32 v76, 0
  v_mov_b32 v77, 0
  v_mov_b32 v78, 0
  v_mov_b32 v79, 0
L_KGS:
  s_cmp_ge_u32 s2, 128
  s_cbranch_scc1 L_KG
  v_mov_b32 v28, 0x3f803f80
  v_mov_b32 v240, 0
  v_mov_b32 v241, 0
  s_waitcnt vmcnt(0)
  ds_write_b128 v48, v[16:19]
  ds_write_b128 v48, v[20:23] offset:512
  ds_write_b64 v49, v[24:25] offset:1024
  v_dot2c_f32_bf16 v240, v16, v28
  v_dot2c_f32_bf16 v241, v16, v16
  v_dot2c_f32_bf16 v240, v17, v28
  v_dot2c_f32_bf16 v241, v17, v17
  v_dot2c_f32_bf16 v240, v18, v28
  v_dot2c_f32_bf16 v241, v18, v18
  v_dot2c_f32_bf16 v240, v19, v28
  v_dot2c_f32_bf16 v241, v19, v19
  v_dot2c_f32_bf16 v240, v20, v28
  v_dot2c_f32_bf16 v241, v20, v20
  v_dot2c_f32_bf16 v240, v21, v28
  v_dot2c_f32_bf16 v241, v21, v21
  v_dot2c_f32_bf16 v240, v22, v28
  v_dot2c_f32_bf16 v241, v22, v22
  v_dot2c_f32_bf16 v240, v23, v28
  v_dot2c_f32_bf16 v241, v23, v23
  v_dot2c_f32_bf16 v240, v24, v28
  v_dot2c_f32_bf16 v241, v24, v24
  v_dot2c_f32_bf16 v240, v25, v28
  v_dot2c_f32_bf16 v241, v25, v25
  s_waitcnt lgkmcnt(0)
  s_barrier
  ds_read_b64 v[16:17], v51 offset:0
  ds_read_b64 v[18:19], v51 offset:1296
  ds_read_b64 v[20:21], v51 offset:512
  ds_read_b64 v[22:23], v51 offset:1808
  ds_read_b64 v[24:25], v51 offset:1024
  ds_read_b64 v[26:27], v51 offset:2320
  s_nop 1
  v_add_f32_dpp v240, v240, v240 quad_perm:[1,0,3,2] row_mask:0xf bank_mask:0xf
  v_add_f32_dpp v241, v241, v241 quad_perm:[1,0,3,2] row_mask:0xf bank_mask:0xf
  s_nop 0
  v_add_f32_dpp v240, v240, v240 quad_perm:[2,3,0,1] row_mask:0xf bank_mask:0xf
  v_add_f32_dpp v241, v241, v241 quad_perm:[2,3,0,1] row_mask:0xf bank_mask:0xf
  s_nop 0
  v_add_f32_dpp v240, v240, v240 row_half_mirror row_mask:0xf bank_mask:0xf
  v_add_f32_dpp v241, v241, v241 row_half_mirror row_mask:0xf bank_mask:0xf
  s_nop 0
  v_add_f32_dpp v240, v240, v240 row_mirror row_mask:0xf bank_mask:0xf
  v_add_f32_dpp v241, v241, v241 row_mirror row_mask:0xf bank_mask:0xf
  v_mov_b32 v52, v240
  v_mov_b32 v53, v241
  s_nop 0
  v_permlane16_swap_b32 v240, v52
  v_permlane16_swap_b32 v241, v53
  v_add_f32 v240, v240, v52
  v_add_f32 v241, v241, v53
  s_mov_b32 s57, 10485760
  s_waitcnt lgkmcnt(0)
  buffer_store_dwordx4 v[16:19], v54, s[44:47], s57 offen sc1
  buffer_store_dwordx4 v[20:23], v55, s[44:47], s57 offen sc1
  s_cmp_gt_u32 s3, 3
  s_cbranch_scc1 L_LN2
  buffer_store_dwordx4 v[24:27], v50, s[44:47], s57 offen sc1
L_LN2:
  v_mul_f32 v240, 0x3acccccd, v240
  v_mul_f32 v241, 0x3acccccd, v241
  v_fma_f32 v241, -v240, v240, v241
  v_max_f32 v241, 0, v241
  v_cvt_pk_bf16_f32 v241, v241, v241
  v_and_b32 v241, 0xffff0000, v241
  v_add_f32 v241, 0x3727c5ac, v241
  v_cvt_pk_bf16_f32 v241, v241, v241
  v_and_b32 v241, 0xffff0000, v241
  v_sqrt_f32 v241, v241
  s_nop 0
  v_cvt_pk_bf16_f32 v241, v241, v241
  v_and_b32 v241, 0xffff0000, v241
  v_cvt_pk_bf16_f32 v240, v240, v240
  v_and_b32 v240, 0xffff0000, v240
  v_rcp_f32 v241, v241
  v_lshrrev_b32 v52, 1, v244
  v_add_u32 v52, 145664, v52
  ds_write_b64 v52, v[240:241]
L_KG:
  s_mov_b32 m0, s66
  s_cmp_lg_u32 s62, 0
  s_cbranch_scc1 L_KG1
  v_mul_f32 v94, 0x41000000, v32
  v_mul_f32 v95, 0x41000000, v35
  v_exp_f32 v94, v94
  v_fract_f32 v95, v95
  v_cos_f32 v100, v95
  v_sin_f32 v101, v95
  s_nop 0
  v_pk_mul_f32 v[100:101], v[100:101], v[94:95] op_sel_hi:[1,0]
  v_mov_b32 v96, 0x3c00
  ds_write_addtid_b32 v96
  v_mov_b32 v104, v100
  v_mov_b32 v105, v101
  v_pk_mul_f32 v[102:103], v[104:105], v[100:101] op_sel_hi:[0,1]
  v_pk_fma_f32 v[102:103], v[104:105], v[100:101], v[102:103] op_sel:[1,1,0] op_sel_hi:[1,0,1] neg_lo:[1,0,0]
  v_cvt_pk_f16_f32 v97, v100, v101
  ds_write_addtid_b32 v97 offset:272
  v_mov_b32 v104, v102
  v_mov_b32 v105, v103
  v_pk_mul_f32 v[112:113], v[100:101], v[102:103] op_sel_hi:[0,1]
  v_cvt_pk_f16_f32 v98, v102, v103
  ds_write_addtid_b32 v98 offset:544
  v_pk_fma_f32 v[112:113], v[100:101], v[102:103], v[112:113] op_sel:[1,1,0] op_sel_hi:[1,0,1] neg_lo:[1,0,0]
  v_pk_mul_f32 v[106:107], v[104:105], v[102:103] op_sel_hi:[0,1]
  v_cvt_pk_f16_f32 v99, v112, v113
  ds_write_addtid_b32 v99 offset:816
  v_pk_fma_f32 v[106:107], v[104:105], v[102:103], v[106:107] op_sel:[1,1,0] op_sel_hi:[1,0,1] neg_lo:[1,0,0]
  v_pk_mul_f32 v[110:111], v[112:113], v[102:103] op_sel_hi:[0,1]
  v_cvt_pk_f16_f32 v96, v106, v107
  ds_write_addtid_b32 v96 offset:1088
  v_pk_fma_f32 v[110:111], v[112:113], v[102:103], v[110:111] op_sel:[1,1,0] op_sel_hi:[1,0,1] neg_lo:[1,0,0]
  v_pk_mul_f32 v[108:109], v[106:107], v[102:103] op_sel_hi:[0,1]
  v_cvt_pk_f16_f32 v97, v110, v111
  ds_write_addtid_b32 v97 offset:1360
  v_pk_fma_f32 v[108:109], v[106:107], v[102:103], v[108:109] op_sel:[1,1,0] op_sel_hi:[1,0,1] neg_lo:[1,0,0]
  v_pk_mul_f32 v[112:113], v[110:111], v[102:103] op_sel_hi:[0,1]
  v_cvt_pk_f16_f32 v98, v108, v109
  ds_write_addtid_b32 v98 offset:1632
  v_pk_fma_f32 v[112:113], v[110:111], v[102:103], v[112:113] op_sel:[1,1,0] op_sel_hi:[1,0,1] neg_lo:[1,0,0]
  v_pk_mul_f32 v[106:107], v[108:109], v[102:103] op_sel_hi:[0,1]
  v_cvt_pk_f16_f32 v99, v112, v113
  ds_write_addtid_b32 v99 offset:1904
  v_pk_fma_f32 v[106:107], v[108:109], v[102:103], v[106:107] op_sel:[1,1,0] op_sel_hi:[1,0,1] neg_lo:[1,0,0]
  v_pk_mul_f32 v[110:111], v[112:113], v[102:103] op_sel_hi:[0,1]
  v_cvt_pk_f16_f32 v96, v106, v107
  ds_write_addtid_b32 v96 offset:2176
  v_pk_fma_f32 v[110:111], v[112:113], v[102:103], v[110:111] op_sel:[1,1,0] op_sel_hi:[1,0,1] neg_lo:[1,0,0]
  v_pk_mul_f32 v[108:109], v[106:107], v[102:103] op_sel_hi:[0,1]
  v_cvt_pk_f16_f32 v97, v110, v111
  ds_write_addtid_b32 v97 offset:2448
  v_pk_fma_f32 v[108:109], v[106:107], v[102:103], v[108:109] op_sel:[1,1,0] op_sel_hi:[1,0,1] neg_lo:[1,0,0]
  v_pk_mul_f32 v[112:113], v[110:111], v[102:103] op_sel_hi:[0,1]
  v_cvt_pk_f16_f32 v98, v108, v109
  ds_write_addtid_b32 v98 offset:2720
  v_pk_fma_f32 v[112:113], v[110:111], v[102:103], v[112:113] op_sel:[1,1,0] op_sel_hi:[1,0,1] neg_lo:[1,0,0]
  v_pk_mul_f32 v[106:107], v[108:109], v[102:103] op_sel_hi:[0,1]
  v_cvt_pk_f16_f32 v99, v112, v113
  ds_write_addtid_b32 v99 offset:2992
  v_pk_fma_f32 v[106:107], v[108:109], v[102:103], v[106:107] op_sel:[1,1,0] op_sel_hi:[1,0,1] neg_lo:[1,0,0]
  v_pk_mul_f32 v[110:111], v[112:113], v[102:103] op_sel_hi:[0,1]
  v_cvt_pk_f16_f32 v96, v106, v107
  ds_write_addtid_b32 v96 offset:3264
  v_pk_fma_f32 v[110:111], v[112:113], v[102:103], v[110:111] op_sel:[1,1,0] op_sel_hi:[1,0,1] neg_lo:[1,0,0]
  v_pk_mul_f32 v[108:109], v[106:107], v[102:103] op_sel_hi:[0,1]
  v_cvt_pk_f16_f32 v97, v110, v111
  ds_write_addtid_b32 v97 offset:3536
  v_pk_fma_f32 v[108:109], v[106:107], v[102:103], v[108:109] op_sel:[1,1,0] op_sel_hi:[1,0,1] neg_lo:[1,0,0]
  v_pk_mul_f32 v[112:113], v[110:111], v[102:103] op_sel_hi:[0,1]
  v_cvt_pk_f16_f32 v98, v108, v109
  ds_write_addtid_b32 v98 offset:3808
  v_pk_fma_f32 v[112:113], v[110:111], v[102:103], v[112:113] op_sel:[1,1,0] op_sel_hi:[1,0,1] neg_lo:[1,0,0]
  v_pk_mul_f32 v[106:107], v[108:109], v[102:103] op_sel_hi:[0,1]
  v_cvt_pk_f16_f32 v99, v112, v113
  ds_write_addtid_b32 v99 offset:4080
  v_pk_fma_f32 v[106:107], v[108:109], v[102:103], v[106:107] op_sel:[1,1,0] op_sel_hi:[1,0,1] neg_lo:[1,0,0]
  v_pk_mul_f32 v[110:111], v[112:113], v[102:103] op_sel_hi:[0,1]
  v_cvt_pk_f16_f32 v96, v106, v107
  ds_write_addtid_b32 v96 offset:4352
  v_pk_fma_f32 v[110:111], v[112:113], v[102:103], v[110:111] op_sel:[1,1,0] op_sel_hi:[1,0,1] neg_lo:[1,0,0]
  v_pk_mul_f32 v[108:109], v[106:107], v[102:103] op_sel_hi:[0,1]
  v_cvt_pk_f16_f32 v97, v110, v111
  ds_write_addtid_b32 v97 offset:4624
  v_pk_fma_f32 v[108:109], v[106:107], v[102:103], v[108:109] op_sel:[1,1,0] op_sel_hi:[1,0,1] neg_lo:[1,0,0]
  v_pk_mul_f32 v[112:113], v[110:111], v[102:103] op_sel_hi:[0,1]
  v_cvt_pk_f16_f32 v98, v108, v109
  ds_write_addtid_b32 v98 offset:4896
  v_pk_fma_f32 v[112:113], v[110:111], v[102:103], v[112:113] op_sel:[1,1,0] op_sel_hi:[1,0,1] neg_lo:[1,0,0]
  v_pk_mul_f32 v[106:107], v[108:109], v[102:103] op_sel_hi:[0,1]
  v_cvt_pk_f16_f32 v99, v112, v113
  ds_write_addtid_b32 v99 offset:5168
  v_pk_fma_f32 v[106:107], v[108:109], v[102:103], v[106:107] op_sel:[1,1,0] op_sel_hi:[1,0,1] neg_lo:[1,0,0]
  v_pk_mul_f32 v[110:111], v[112:113], v[102:103] op_sel_hi:[0,1]
  v_cvt_pk_f16_f32 v96, v106, v107
  ds_write_addtid_b32 v96 offset:5440
  v_pk_fma_f32 v[110:111], v[112:113], v[102:103], v[110:111] op_sel:[1,1,0] op_sel_hi:[1,0,1] neg_lo:[1,0,0]
  v_pk_mul_f32 v[108:109], v[106:107], v[102:103] op_sel_hi:[0,1]
  v_cvt_pk_f16_f32 v97, v110, v111
  ds_write_addtid_b32 v97 offset:5712
  v_pk_fma_f32 v[108:109], v[106:107], v[102:103], v[108:109] op_sel:[1,1,0] op_sel_hi:[1,0,1] neg_lo:[1,0,0]
  v_pk_mul_f32 v[112:113], v[110:111], v[102:103] op_sel_hi:[0,1]
  v_cvt_pk_f16_f32 v98, v108, v109
  ds_write_addtid_b32 v98 offset:5984
  v_pk_fma_f32 v[112:113], v[110:111], v[102:103], v[112:113] op_sel:[1,1,0] op_sel_hi:[1,0,1] neg_lo:[1,0,0]
  v_pk_mul_f32 v[106:107], v[108:109], v[102:103] op_sel_hi:[0,1]
  v_cvt_pk_f16_f32 v99, v112, v113
  ds_write_addtid_b32 v99 offset:6256
  v_pk_fma_f32 v[106:107], v[108:109], v[102:103], v[106:107] op_sel:[1,1,0] op_sel_hi:[1,0,1] neg_lo:[1,0,0]
  v_pk_mul_f32 v[110:111], v[112:113], v[102:103] op_sel_hi:[0,1]
  v_cvt_pk_f16_f32 v96, v106, v107
  ds_write_addtid_b32 v96 offset:6528
  v_pk_fma_f32 v[110:111], v[112:113], v[102:103], v[110:111] op_sel:[1,1,0] op_sel_hi:[1,0,1] neg_lo:[1,0,0]
  v_pk_mul_f32 v[108:109], v[106:107], v[102:103] op_sel_hi:[0,1]
  v_cvt_pk_f16_f32 v97, v110, v111
  ds_write_addtid_b32 v97 offset:6800
  v_pk_fma_f32 v[108:109], v[106:107], v[102:103], v[108:109] op_sel:[1,1,0] op_sel_hi:[1,0,1] neg_lo:[1,0,0]
  v_pk_mul_f32 v[112:113], v[110:111], v[102:103] op_sel_hi:[0,1]
  v_cvt_pk_f16_f32 v98, v108, v109
  ds_write_addtid_b32 v98 offset:7072
  v_pk_fma_f32 v[112:113], v[110:111], v[102:103], v[112:113] op_sel:[1,1,0] op_sel_hi:[1,0,1] neg_lo:[1,0,0]
  v_pk_mul_f32 v[106:107], v[108:109], v[102:103] op_sel_hi:[0,1]
  v_cvt_pk_f16_f32 v99, v112, v113
  ds_write_addtid_b32 v99 offset:7344
  v_pk_fma_f32 v[106:107], v[108:109], v[102:103], v[106:107] op_sel:[1,1,0] op_sel_hi:[1,0,1] neg_lo:[1,0,0]
  v_pk_mul_f32 v[110:111], v[112:113], v[102:103] op_sel_hi:[0,1]
  v_cvt_pk_f16_f32 v96, v106, v107
  ds_write_addtid_b32 v96 offset:7616
  v_pk_fma_f32 v[110:111], v[112:113], v[102:103], v[110:111] op_sel:[1,1,0] op_sel_hi:[1,0,1] neg_lo:[1,0,0]
  v_pk_mul_f32 v[108:109], v[106:107], v[102:103] op_sel_hi:[0,1]
  v_cvt_pk_f16_f32 v97, v110, v111
  ds_write_addtid_b32 v97 offset:7888
  v_pk_fma_f32 v[108:109], v[106:107], v[102:103], v[108:109] op_sel:[1,1,0] op_sel_hi:[1,0,1] neg_lo:[1,0,0]
  v_pk_mul_f32 v[112:113], v[110:111], v[102:103] op_sel_hi:[0,1]
  v_cvt_pk_f16_f32 v98, v108, v109
  ds_write_addtid_b32 v98 offset:8160
  v_pk_fma_f32 v[112:113], v[110:111], v[102:103], v[112:113] op_sel:[1,1,0] op_sel_hi:[1,0,1] neg_lo:[1,0,0]
  v_cvt_pk_f16_f32 v99, v112, v113
  ds_write_addtid_b32 v99 offset:8432
  s_branch L_KG2
L_KG1:
  v_exp_f32 v94, v32
  v_fract_f32 v95, v35
  v_cos_f32 v100, v95
  v_sin_f32 v101, v95
  s_nop 0
  v_pk_mul_f32 v[100:101], v[100:101], v[94:95] op_sel_hi:[1,0]
  v_mul_f32 v94, 0x43800000, v32
  v_mul_f32 v95, 0x43800000, v35
  v_exp_f32 v94, v94
  v_fract_f32 v95, v95
  v_cos_f32 v102, v95
  v_sin_f32 v103, v95
  s_nop 0
  v_pk_mul_f32 v[102:103], v[102:103], v[94:95] op_sel_hi:[1,0]
  v_mul_f32 v106, s65, v38
  v_mul_f32 v107, s65, v41
  v_pk_mul_f32 v[108:109], v[106:107], v[100:101] op_sel_hi:[0,1]
  v_cvt_pk_f16_f32 v96, v106, -v107
  ds_write_addtid_b32 v96 offset:57344
  v_pk_fma_f32 v[108:109], v[106:107], v[100:101], v[108:109] op_sel:[1,1,0] op_sel_hi:[1,0,1] neg_lo:[1,0,0]
  v_pk_mul_f32 v[122:123], v[106:107], v[102:103] op_sel_hi:[0,1]
  v_cvt_pk_f16_f32 v97, v108, -v109
  ds_write_addtid_b32 v97 offset:57616
  v_pk_fma_f32 v[122:123], v[106:107], v[102:103], v[122:123] op_sel:[1,1,0] op_sel_hi:[1,0,1] neg_lo:[1,0,0]
  v_pk_mul_f32 v[110:111], v[108:109], v[100:101] op_sel_hi:[0,1]
  v_cvt_pk_f16_f32 v98, v122, -v123
  ds_write_addtid_b32 v98 offset:59520
  v_pk_fma_f32 v[110:111], v[108:109], v[100:101], v[110:111] op_sel:[1,1,0] op_sel_hi:[1,0,1] neg_lo:[1,0,0]
  v_pk_mul_f32 v[130:131], v[122:123], v[102:103] op_sel_hi:[0,1]
  v_cvt_pk_f16_f32 v99, v110, -v111
  ds_write_addtid_b32 v99 offset:57888
  v_pk_fma_f32 v[130:131], v[122:123], v[102:103], v[130:131] op_sel:[1,1,0] op_sel_hi:[1,0,1] neg_lo:[1,0,0]
  v_pk_mul_f32 v[112:113], v[110:111], v[100:101] op_sel_hi:[0,1]
  v_cvt_pk_f16_f32 v96, v130, -v131
  ds_write_addtid_b32 v96 offset:60608
  v_pk_fma_f32 v[112:113], v[110:111], v[100:101], v[112:113] op_sel:[1,1,0] op_sel_hi:[1,0,1] neg_lo:[1,0,0]
  v_pk_mul_f32 v[134:135], v[130:131], v[102:103] op_sel_hi:[0,1]
  v_cvt_pk_f16_f32 v97, v112, -v113
  ds_write_addtid_b32 v97 offset:58160
  v_pk_fma_f32 v[134:135], v[130:131], v[102:103], v[134:135] op_sel:[1,1,0] op_sel_hi:[1,0,1] neg_lo:[1,0,0]
  v_pk_mul_f32 v[114:115], v[112:113], v[100:101] op_sel_hi:[0,1]
  v_cvt_pk_f16_f32 v98, v134, -v135
  ds_write_addtid_b32 v98 offset:61152
  v_pk_fma_f32 v[114:115], v[112:113], v[100:101], v[114:115] op_sel:[1,1,0] op_sel_hi:[1,0,1] neg_lo:[1,0,0]
  v_pk_mul_f32 v[124:125], v[110:111], v[102:103] op_sel_hi:[0,1]
  v_cvt_pk_f16_f32 v99, v114, -v115
  ds_write_addtid_b32 v99 offset:58432
  v_pk_fma_f32 v[124:125], v[110:111], v[102:103], v[124:125] op_sel:[1,1,0] op_sel_hi:[1,0,1] neg_lo:[1,0,0]
  v_pk_mul_f32 v[116:117], v[114:115], v[100:101] op_sel_hi:[0,1]
  v_cvt_pk_f16_f32 v96, v124, -v125
  ds_write_addtid_b32 v96 offset:59792
  v_pk_fma_f32 v[116:117], v[114:115], v[100:101], v[116:117] op_sel:[1,1,0] op_sel_hi:[1,0,1] neg_lo:[1,0,0]
  v_pk_mul_f32 v[108:109], v[134:135], v[102:103] op_sel_hi:[0,1]
  v_cvt_pk_f16_f32 v97, v116, -v117
  ds_write_addtid_b32 v97 offset:58704
  v_pk_fma_f32 v[108:109], v[134:135], v[102:103], v[108:109] op_sel:[1,1,0] op_sel_hi:[1,0,1] neg_lo:[1,0,0]
  v_pk_mul_f32 v[118:119], v[116:117], v[100:101] op_sel_hi:[0,1]
  v_cvt_pk_f16_f32 v98, v108, -v109
  ds_write_addtid_b32 v98 offset:61696
  v_pk_fma_f32 v[118:119], v[116:117], v[100:101], v[118:119] op_sel:[1,1,0] op_sel_hi:[1,0,1] neg_lo:[1,0,0]
  v_pk_mul_f32 v[126:127], v[114:115], v[102:103] op_sel_hi:[0,1]
  v_cvt_pk_f16_f32 v99, v118, -v119
  ds_write_addtid_b32 v99 offset:58976
  v_pk_fma_f32 v[126:127], v[114:115], v[102:103], v[126:127] op_sel:[1,1,0] op_sel_hi:[1,0,1] neg_lo:[1,0,0]
  v_pk_mul_f32 v[120:121], v[118:119], v[100:101] op_sel_hi:[0,1]
  v_cvt_pk_f16_f32 v96, v126, -v127
  ds_write_addtid_b32 v96 offset:60064
  v_pk_fma_f32 v[120:121], v[118:119], v[100:101], v[120:121] op_sel:[1,1,0] op_sel_hi:[1,0,1] neg_lo:[1,0,0]
  v_pk_mul_f32 v[112:113], v[108:109], v[102:103] op_sel_hi:[0,1]
  v_cvt_pk_f16_f32 v97, v120, -v121
  ds_write_addtid_b32 v97 offset:59248
  v_pk_fma_f32 v[112:113], v[108:109], v[102:103], v[112:113] op_sel:[1,1,0] op_sel_hi:[1,0,1] neg_lo:[1,0,0]
  v_pk_mul_f32 v[128:129], v[118:119], v[102:103] op_sel_hi:[0,1]
  v_cvt_pk_f16_f32 v98, v112, -v113
  ds_write_addtid_b32 v98 offset:61968
  v_pk_fma_f32 v[128:129], v[118:119], v[102:103], v[128:129] op_sel:[1,1,0] op_sel_hi:[1,0,1] neg_lo:[1,0,0]
  v_pk_mul_f32 v[132:133], v[126:127], v[102:103] op_sel_hi:[0,1]
  v_cvt_pk_f16_f32 v99, v128, -v129
  ds_write_addtid_b32 v99 offset:60336
  v_pk_fma_f32 v[132:133], v[126:127], v[102:103], v[132:133] op_sel:[1,1,0] op_sel_hi:[1,0,1] neg_lo:[1,0,0]
  v_pk_mul_f32 v[116:117], v[112:113], v[102:103] op_sel_hi:[0,1]
  v_cvt_pk_f16_f32 v96, v132, -v133
  ds_write_addtid_b32 v96 offset:60880
  v_pk_fma_f32 v[116:117], v[112:113], v[102:103], v[116:117] op_sel:[1,1,0] op_sel_hi:[1,0,1] neg_lo:[1,0,0]
  v_pk_mul_f32 v[136:137], v[132:133], v[102:103] op_sel_hi:[0,1]
  v_cvt_pk_f16_f32 v97, v116, -v117
  ds_write_addtid_b32 v97 offset:62240
  v_pk_fma_f32 v[136:137], v[132:133], v[102:103], v[136:137] op_sel:[1,1,0] op_sel_hi:[1,0,1] neg_lo:[1,0,0]
  v_pk_mul_f32 v[120:121], v[116:117], v[102:103] op_sel_hi:[0,1]
  v_cvt_pk_f16_f32 v98, v136, -v137
  ds_write_addtid_b32 v98 offset:61424
  v_pk_fma_f32 v[120:121], v[116:117], v[102:103], v[120:121] op_sel:[1,1,0] op_sel_hi:[1,0,1] neg_lo:[1,0,0]
  v_pk_mul_f32 v[108:109], v[120:121], v[102:103] op_sel_hi:[0,1]
  v_cvt_pk_f16_f32 v99, v120, -v121
  ds_write_addtid_b32 v99 offset:62512
  v_pk_fma_f32 v[108:109], v[120:121], v[102:103], v[108:109] op_sel:[1,1,0] op_sel_hi:[1,0,1] neg_lo:[1,0,0]
  v_cvt_pk_f16_f32 v96, v108, -v109
  ds_write_addtid_b32 v96 offset:62784
  v_mov_b32 v38, v39
  v_mov_b32 v39, v40
  v_mov_b32 v41, v42
  v_mov_b32 v42, v43
  s_cmp_eq_u32 s69, 0
  s_cbranch_scc1 L_KG2
  s_waitcnt lgkmcnt(15)
  v_mfma_f32_32x32x16_f16 v[64:79], v[144:147], v[148:151], v[64:79]
  v_mfma_f32_32x32x16_f16 v[64:79], v[152:155], v[156:159], v[64:79]
  v_mfma_f32_32x32x16_f16 v[64:79], v[160:163], v[164:167], v[64:79]
  v_mfma_f32_32x32x16_f16 v[64:79], v[168:171], v[172:175], v[64:79]
  v_mfma_f32_32x32x16_f16 v[64:79], v[176:179], v[180:183], v[64:79]
  v_mfma_f32_32x32x16_f16 v[64:79], v[184:187], v[188:191], v[64:79]
  v_mfma_f32_32x32x16_f16 v[64:79], v[192:195], v[196:199], v[64:79]
  v_mfma_f32_32x32x16_f16 v[64:79], v[200:203], v[204:207], v[64:79]
L_KG2:
  v_mov_b32 v32, v33
  v_mov_b32 v33, v34
  v_mov_b32 v35, v36
  v_mov_b32 v36, v37
  s_cmp_eq_u32 s69, 1
  s_cbranch_scc1 L_KG3
  s_waitcnt vmcnt(0)
  s_cmp_eq_u32 s69, 0
  s_cbranch_scc1 L_KG3
  s_branch L_GCa
L_GRa:
  s_mov_b64 exec, vcc
  buffer_load_dwordx4 v[208:211], v13, s[44:47], s70 offen sc1
  buffer_load_dwordx4 v[212:215], v13, s[44:47], s70 offen offset:16 sc1
  buffer_load_dwordx4 v[216:219], v13, s[44:47], s71 offen sc1
  buffer_load_dwordx4 v[220:223], v13, s[44:47], s71 offen offset:16 sc1
  s_mov_b64 exec, -1
L_GCa:
  s_waitcnt vmcnt(0)
  v_cmp_ne_u64 vcc, s[42:43], v[210:211]
  v_cmp_ne_u64 s[92:93], s[42:43], v[214:215]
  s_nop 0
  s_or_b64 vcc, vcc, s[92:93]
  v_cmp_ne_u64 s[92:93], s[42:43], v[218:219]
  s_nop 0
  s_or_b64 vcc, vcc, s[92:93]
  v_cmp_ne_u64 s[92:93], s[42:43], v[222:223]
  s_nop 0
  s_or_b64 vcc, vcc, s[92:93]
  s_cbranch_vccz L_GDa
  s_add_u32 s95, s95, 1
  s_cmp_gt_u32 s95, 262144
  s_cbranch_scc1 L_GDa
  s_sleep 2
  s_branch L_GRa
L_GDa:
  buffer_load_dwordx4 v[48:51], v6, s[44:47], s63 offen sc1
  buffer_load_dwordx4 v[52:55], v7, s[44:47], s63 offen sc1
  buffer_load_dwordx4 v[224:227], v12, s[44:47], s72 offen sc1
L_KG3:
  s_waitcnt lgkmcnt(0)
  s_barrier
  s_cmp_eq_u32 s62, 0
  s_cbranch_scc1 L_KG3C
  ds_read_b128 v[144:147], v83 offset:0
  ds_read_b128 v[148:151], v82 offset:0
  ds_read_b128 v[152:155], v83 offset:32
  ds_read_b128 v[156:159], v82 offset:32
  ds_read_b128 v[160:163], v83 offset:64
  ds_read_b128 v[164:167], v82 offset:64
  ds_read_b128 v[168:171], v83 offset:96
  ds_read_b128 v[172:175], v82 offset:96
  ds_read_b128 v[176:179], v83 offset:128
  ds_read_b128 v[180:183], v82 offset:128
  ds_read_b128 v[184:187], v83 offset:160
  ds_read_b128 v[188:191], v82 offset:160
  ds_read_b128 v[192:195], v83 offset:192
  ds_read_b128 v[196:199], v82 offset:192
  ds_read_b128 v[200:203], v83 offset:224
  ds_read_b128 v[204:207], v82 offset:224
  v_add_u32 v82, s67, v82
  v_add_u32 v83, s68, v83
  s_sub_u32 s67, 0, s67
L_KG3C:
  s_add_u32 s66, s66, s68
  s_sub_u32 s68, 0, s68
  s_cmp_eq_u32 s69, 0
  s_cbranch_scc1 L_KG4
  s_cmp_lg_u32 s69, 1
  s_cbranch_scc1 L_KG5
  buffer_load_dwordx4 v[208:211], v13, s[44:47], s70 offen sc1
  buffer_load_dwordx4 v[212:215], v13, s[44:47], s70 offen offset:16 sc1
  buffer_load_dwordx4 v[216:219], v13, s[44:47], s71 offen sc1
  buffer_load_dwordx4 v[220:223], v13, s[44:47], s71 offen offset:16 sc1
  s_branch L_KG5
L_KG4:
  s_cmp_ge_u32 s2, 128
  s_cbranch_scc1 L_KG4B
  s_lshl_b32 s57, s2, 8
  s_add_u32 s57, s57, 65536
  s_cmp_lg_u32 s3, 0
  s_cbranch_scc1 L_KG4B
  v_lshlrev_b32 v52, 3, v2
  v_add_u32 v52, 145664, v52
  ds_read_b64 v[240:241], v52
  s_waitcnt lgkmcnt(0)
  s_mov_b64 exec, 0xffff
  buffer_store_dwordx4 v[240:243], v249, s[44:47], s57 offen sc1
  s_mov_b64 exec, -1
L_KG4B:
  s_cmp_lg_u32 s3, 7
  s_cbranch_scc1 LX_1
  s_and_b32 s88, s2, 7
  s_lshl_b32 s88, s88, 5
  s_lshr_b32 s89, s2, 3
  s_add_u32 s88, s88, s89
  s_lshl_b32 s88, s88, 4
  s_add_u32 s88, s88, 32768
  s_and_b32 s96, s96, 15
  v_mov_b32 v28, s96
  v_mov_b32 v29, 0
  v_mov_b32 v30, s42
  v_mov_b32 v31, s43
  s_mov_b64 exec, 1
  buffer_store_dwordx4 v[28:31], v248, s[44:47], s88 offen sc1
  s_mov_b64 exec, -1
LX_1:
L_KG5:
  s_add_u32 s69, s69, 1
  s_cmp_lt_u32 s69, 3
  s_cbranch_scc1 L_KG
  v_mov_b32 v84, -1
  v_mov_b32 v85, -1
  v_mov_b32 v86, -1
  v_mov_b32 v87, -1
  v_lshlrev_b32 v88, 4, v0
  s_mul_i32 s57, s60, 17024
  s_add_u32 s57, s57, 1048704
  s_add_u32 s58, s57, 8192
  buffer_store_dwordx4 v[84:87], v88, s[44:47], s57 offen sc1
  buffer_store_dwordx4 v[84:87], v88, s[44:47], s58 offen sc1
  v_lshrrev_b32 v89, 2, v1
  v_mul_u32_u24 v89, 16400, v89
  v_and_b32 v90, 3, v1
  v_lshl_add_u32 v89, v90, 2, v89
  s_sub_u32 s57, s57, 16
  s_mov_b64 exec, 0xff
  buffer_store_dword v248, v89, s[44:47], s57 offen sc1
  s_mov_b64 exec, -1
  s_cmp_lg_u32 s62, 0
  s_cbranch_scc1 L_KD1
  s_waitcnt vmcnt(3)
LM_2:
  v_cmp_ne_u64 vcc, s[42:43], v[226:227]
  s_cbranch_vccnz LM_3
LM_4:
  v_add_f32_dpp v224, v224, v224 quad_perm:[1,0,3,2] row_mask:0xf bank_mask:0xf
  v_add_f32_dpp v225, v225, v225 quad_perm:[1,0,3,2] row_mask:0xf bank_mask:0xf
  v_cvt_pk_bf16_f32 v225, v224, v225
  v_lshlrev_b32 v224, 16, v225
  v_and_b32 v225, 0xffff0000, v225
  v_add_f32 v226, 1.0, v224
  v_add_f32 v227, 1.0, v225
  v_cvt_pk_bf16_f32 v227, v226, v227
  v_lshlrev_b32 v226, 16, v227
  v_and_b32 v227, 0xffff0000, v227
  v_readlane_b32 s72, v224, 0
  v_readlane_b32 s76, v226, 4
  v_readlane_b32 s80, v224, 8
  v_readlane_b32 s73, v225, 0
  v_readlane_b32 s77, v227, 4
  v_readlane_b32 s81, v225, 8
  v_readlane_b32 s74, v224, 2
  v_readlane_b32 s78, v226, 6
  v_readlane_b32 s82, v224, 10
  v_readlane_b32 s75, v225, 2
  v_readlane_b32 s79, v227, 6
  v_readlane_b32 s83, v225, 10
  v_mul_f32 v210, v208, v209
  v_mul_f32 v214, v212, v213
  v_mul_f32 v218, v216, v217
  v_mul_f32 v222, v220, v221
  v_mov_b32 v20, s72
  v_mov_b32 v21, s73
  v_mov_b32 v22, s74
  v_mov_b32 v23, s75
  v_lshlrev_b32 v224, 16, v48
  v_and_b32 v225, 0xffff0000, v48
  v_lshlrev_b32 v226, 16, v49
  v_and_b32 v227, 0xffff0000, v49
  v_pk_fma_f32 v[176:177], v[224:225], v[208:209], v[210:211] op_sel:[0,1,0] op_sel_hi:[1,1,0] neg_lo:[0,0,1] neg_hi:[0,0,1]
  v_pk_fma_f32 v[178:179], v[226:227], v[208:209], v[210:211] op_sel:[0,1,0] op_sel_hi:[1,1,0] neg_lo:[0,0,1] neg_hi:[0,0,1]
  v_pk_fma_f32 v[176:177], v[176:177], s[76:77], v[20:21]
  v_pk_fma_f32 v[178:179], v[178:179], s[78:79], v[22:23]
  v_lshlrev_b32 v228, 16, v50
  v_and_b32 v229, 0xffff0000, v50
  v_lshlrev_b32 v230, 16, v51
  v_and_b32 v231, 0xffff0000, v51
  v_pk_fma_f32 v[180:181], v[228:229], v[212:213], v[214:215] op_sel:[0,1,0] op_sel_hi:[1,1,0] neg_lo:[0,0,1] neg_hi:[0,0,1]
  v_pk_fma_f32 v[182:183], v[230:231], v[212:213], v[214:215] op_sel:[0,1,0] op_sel_hi:[1,1,0] neg_lo:[0,0,1] neg_hi:[0,0,1]
  v_pk_fma_f32 v[180:181], v[180:181], s[76:77], v[20:21]
  v_pk_fma_f32 v[182:183], v[182:183], s[78:79], v[22:23]
  v_cvt_pk_bf16_f32 v24, v176, v180
  v_cvt_pk_bf16_f32 v25, v177, v181
  v_cvt_pk_bf16_f32 v26, v178, v182
  v_cvt_pk_bf16_f32 v27, v179, v183
  v_lshlrev_b32 v232, 16, v52
  v_and_b32 v233, 0xffff0000, v52
  v_lshlrev_b32 v234, 16, v53
  v_and_b32 v235, 0xffff0000, v53
  v_pk_fma_f32 v[184:185], v[232:233], v[216:217], v[218:219] op_sel:[0,1,0] op_sel_hi:[1,1,0] neg_lo:[0,0,1] neg_hi:[0,0,1]
  v_pk_fma_f32 v[186:187], v[234:235], v[216:217], v[218:219] op_sel:[0,1,0] op_sel_hi:[1,1,0] neg_lo:[0,0,1] neg_hi:[0,0,1]
  v_pk_fma_f32 v[184:185], v[184:185], s[76:77], v[20:21]
  v_pk_fma_f32 v[186:187], v[186:187], s[78:79], v[22:23]
  v_lshlrev_b32 v236, 16, v54
  v_and_b32 v237, 0xffff0000, v54
  v_lshlrev_b32 v238, 16, v55
  v_and_b32 v239, 0xffff0000, v55
  v_pk_fma_f32 v[188:189], v[236:237], v[220:221], v[222:223] op_sel:[0,1,0] op_sel_hi:[1,1,0] neg_lo:[0,0,1] neg_hi:[0,0,1]
  v_pk_fma_f32 v[190:191], v[238:239], v[220:221], v[222:223] op_sel:[0,1,0] op_sel_hi:[1,1,0] neg_lo:[0,0,1] neg_hi:[0,0,1]
  v_pk_fma_f32 v[188:189], v[188:189], s[76:77], v[20:21]
  v_pk_fma_f32 v[190:191], v[190:191], s[78:79], v[22:23]
  v_cvt_pk_bf16_f32 v28, v184, v188
  v_cvt_pk_bf16_f32 v29, v185, v189
  v_cvt_pk_bf16_f32 v30, v186, v190
  v_cvt_pk_bf16_f32 v31, v187, v191
  s_branch L_KD2
L_KD1:
  s_waitcnt lgkmcnt(0)
  v_mfma_f32_32x32x16_f16 v[64:79], v[144:147], v[148:151], v[64:79]
  v_mfma_f32_32x32x16_f16 v[64:79], v[152:155], v[156:159], v[64:79]
  v_mfma_f32_32x32x16_f16 v[64:79], v[160:163], v[164:167], v[64:79]
  v_mfma_f32_32x32x16_f16 v[64:79], v[168:171], v[172:175], v[64:79]
  v_mfma_f32_32x32x16_f16 v[64:79], v[176:179], v[180:183], v[64:79]
  v_mfma_f32_32x32x16_f16 v[64:79], v[184:187], v[188:191], v[64:79]
  v_mfma_f32_32x32x16_f16 v[64:79], v[192:195], v[196:199], v[64:79]
  v_mfma_f32_32x32x16_f16 v[64:79], v[200:203], v[204:207], v[64:79]
  s_nop 11
  v_pk_mul_f32 v[64:65], v[64:65], v[80:81] op_sel_hi:[1,0]
  v_pk_mul_f32 v[66:67], v[66:67], v[80:81] op_sel_hi:[1,0]
  v_pk_mul_f32 v[68:69], v[68:69], v[80:81] op_sel_hi:[1,0]
  v_pk_mul_f32 v[70:71], v[70:71], v[80:81] op_sel_hi:[1,0]
  v_pk_mul_f32 v[72:73], v[72:73], v[80:81] op_sel_hi:[1,0]
  v_pk_mul_f32 v[74:75], v[74:75], v[80:81] op_sel_hi:[1,0]
  v_cvt_pk_bf16_f32 v96, v64, v65
  v_cvt_pk_bf16_f32 v97, v66, v67
  v_cvt_pk_bf16_f32 v98, v68, v69
  v_cvt_pk_bf16_f32 v99, v70, v71
  v_cvt_pk_bf16_f32 v100, v72, v73
  v_cvt_pk_bf16_f32 v101, v74, v75
  ds_write_b64 v56, v[96:97]
  ds_write_b32 v57, v98 offset:512
  ds_write_b32 v58, v99 offset:516
  ds_write_b16 v59, v100 offset:1024
  ds_write_b16_d16_hi v59, v100 offset:1088
  ds_write_b16 v59, v101 offset:1152
  ds_write_b16_d16_hi v59, v101 offset:1216
L_KD2:
  s_waitcnt lgkmcnt(0)
  s_barrier
  s_cmp_lg_u32 s3, 99
  s_cbranch_scc1 L_RDY
  s_lshl_b32 s57, s60, 6
  s_add_u32 s57, s57, 268288
  s_mov_b64 exec, 1
  buffer_store_dwordx2 v[242:243], v248, s[44:47], s57 offen sc1
  s_mov_b64 exec, -1
L_RDY:
  s_cmp_lg_u32 s62, 0
  s_cbranch_scc1 L_EXD
  s_cmp_lg_u32 s84, 2
  s_cbranch_scc1 L_EX2
  ds_read_u16 v100, v60 offset:16
  ds_read_u16 v101, v60 offset:14
  ds_read_u16 v102, v60 offset:12
  ds_read_u16 v103, v60 offset:10
  ds_read_u16 v104, v60 offset:8
  v_cndmask_b32 v62, 4, 3, s[86:87]
  v_lshl_add_u32 v62, v62, 1, v60
  ds_read_u16 v121, v62
  v_cndmask_b32 v63, 3, 2, s[86:87]
  v_lshl_add_u32 v63, v63, 1, v60
  ds_read_u16 v122, v63
  s_waitcnt lgkmcnt(0)
  v_lshl_or_b32 v144, v101, 16, v101
  v_lshl_or_b32 v145, v102, 16, v102
  v_lshl_or_b32 v146, v102, 16, v102
  v_lshl_or_b32 v147, v103, 16, v102
  v_lshl_or_b32 v148, v103, 16, v103
  v_lshl_or_b32 v149, v104, 16, v104
  v_lshl_or_b32 v150, v104, 16, v104
  v_lshl_or_b32 v151, v122, 16, v121
  ds_write_b128 v11, v[144:147] offset:0
  ds_write_b128 v11, v[148:151] offset:16
  v_lshl_or_b32 v152, v101, 16, v101
  v_lshl_or_b32 v153, v102, 16, v101
  v_lshl_or_b32 v154, v102, 16, v102
  v_lshl_or_b32 v155, v102, 16, v102
  v_lshl_or_b32 v156, v103, 16, v103
  v_lshl_or_b32 v157, v104, 16, v103
  v_lshl_or_b32 v158, v104, 16, v104
  v_lshl_or_b32 v159, v121, 16, v104
  ds_write_b128 v11, v[152:155] offset:2624
  ds_write_b128 v11, v[156:159] offset:2640
  v_lshl_or_b32 v160, v101, 16, v100
  v_lshl_or_b32 v161, v101, 16, v101
  v_lshl_or_b32 v162, v102, 16, v102
  v_lshl_or_b32 v163, v102, 16, v102
  v_lshl_or_b32 v164, v103, 16, v102
  v_lshl_or_b32 v165, v103, 16, v103
  v_lshl_or_b32 v166, v104, 16, v104
  v_lshl_or_b32 v167, v104, 16, v104
  ds_write_b128 v11, v[160:163] offset:5248
  ds_write_b128 v11, v[164:167] offset:5264
  v_lshl_or_b32 v168, v100, 16, v100
  v_lshl_or_b32 v169, v101, 16, v101
  v_lshl_or_b32 v170, v102, 16, v101
  v_lshl_or_b32 v171, v102, 16, v102
  v_lshl_or_b32 v172, v102, 16, v102
  v_lshl_or_b32 v173, v103, 16, v103
  v_lshl_or_b32 v174, v104, 16, v103
  v_lshl_or_b32 v175, v104, 16, v104
  ds_write_b128 v11, v[168:171] offset:7872
  ds_write_b128 v11, v[172:175] offset:7888
  s_branch L_EXD
L_EX2:
  s_cmp_lg_u32 s84, 1
  s_cbranch_scc1 L_EX1
  ds_read_u16 v100, v60 offset:24
  ds_read_u16 v101, v60 offset:22
  ds_read_u16 v102, v60 offset:20
  ds_read_u16 v103, v60 offset:18
  ds_read_u16 v104, v60 offset:16
  ds_read_u16 v105, v60 offset:14
  ds_read_u16 v106, v60 offset:12
  ds_read_u16 v107, v60 offset:10
  ds_read_u16 v108, v60 offset:8
  v_cndmask_b32 v61, 4, 3, s[86:87]
  v_lshl_add_u32 v61, v61, 1, v60
  ds_read_u16 v120, v61
  v_cndmask_b32 v62, 3, 2, s[86:87]
  v_lshl_add_u32 v62, v62, 1, v60
  ds_read_u16 v121, v62
  v_cndmask_b32 v63, 2, 1, s[86:87]
  v_lshl_add_u32 v63, v63, 1, v60
  ds_read_u16 v122, v63
  s_waitcnt lgkmcnt(0)
  v_lshl_or_b32 v144, v102, 16, v102
  v_lshl_or_b32 v145, v104, 16, v103
  v_lshl_or_b32 v146, v104, 16, v104
  v_lshl_or_b32 v147, v106, 16, v105
  v_lshl_or_b32 v148, v106, 16, v106
  v_lshl_or_b32 v149, v108, 16, v107
  v_lshl_or_b32 v150, v120, 16, v108
  v_lshl_or_b32 v151, v122, 16, v121
  ds_write_b128 v11, v[144:147] offset:0
  ds_write_b128 v11, v[148:151] offset:16
  v_lshl_or_b32 v152, v102, 16, v102
  v_lshl_or_b32 v153, v103, 16, v102
  v_lshl_or_b32 v154, v104, 16, v104
  v_lshl_or_b32 v155, v105, 16, v104
  v_lshl_or_b32 v156, v106, 16, v106
  v_lshl_or_b32 v157, v107, 16, v106
  v_lshl_or_b32 v158, v108, 16, v108
  v_lshl_or_b32 v159, v121, 16, v120
  ds_write_b128 v11, v[152:155] offset:2624
  ds_write_b128 v11, v[156:159] offset:2640
  v_lshl_or_b32 v160, v102, 16, v101
  v_lshl_or_b32 v161, v102, 16, v102
  v_lshl_or_b32 v162, v104, 16, v103
  v_lshl_or_b32 v163, v104, 16, v104
  v_lshl_or_b32 v164, v106, 16, v105
  v_lshl_or_b32 v165, v106, 16, v106
  v_lshl_or_b32 v166, v108, 16, v107
  v_lshl_or_b32 v167, v120, 16, v108
  ds_write_b128 v11, v[160:163] offset:5248
  ds_write_b128 v11, v[164:167] offset:5264
  v_lshl_or_b32 v168, v101, 16, v100
  v_lshl_or_b32 v169, v102, 16, v102
  v_lshl_or_b32 v170, v103, 16, v102
  v_lshl_or_b32 v171, v104, 16, v104
  v_lshl_or_b32 v172, v105, 16, v104
  v_lshl_or_b32 v173, v106, 16, v106
  v_lshl_or_b32 v174, v107, 16, v106
  v_lshl_or_b32 v175, v108, 16, v108
  ds_write_b128 v11, v[168:171] offset:7872
  ds_write_b128 v11, v[172:175] offset:7888
  s_branch L_EXD
L_EX1:
  ds_read_u16 v100, v60 offset:38
  ds_read_u16 v101, v60 offset:36
  ds_read_u16 v102, v60 offset:34
  ds_read_u16 v103, v60 offset:32
  ds_read_u16 v104, v60 offset:30
  ds_read_u16 v105, v60 offset:28
  ds_read_u16 v106, v60 offset:26
  ds_read_u16 v107, v60 offset:24
  ds_read_u16 v108, v60 offset:22
  ds_read_u16 v109, v60 offset:20
  ds_read_u16 v110, v60 offset:18
  ds_read_u16 v111, v60 offset:16
  ds_read_u16 v112, v60 offset:14
  ds_read_u16 v113, v60 offset:12
  ds_read_u16 v114, v60 offset:10
  ds_read_u16 v115, v60 offset:8
  ds_read_u16 v116, v60 offset:6
  ds_read_u16 v117, v60 offset:4
  ds_read_u16 v118, v60 offset:2
  s_waitcnt lgkmcnt(0)
  v_lshl_or_b32 v144, v104, 16, v103
  v_lshl_or_b32 v145, v106, 16, v105
  v_lshl_or_b32 v146, v108, 16, v107
  v_lshl_or_b32 v147, v110, 16, v109
  v_lshl_or_b32 v148, v112, 16, v111
  v_lshl_or_b32 v149, v114, 16, v113
  v_lshl_or_b32 v150, v116, 16, v115
  v_lshl_or_b32 v151, v118, 16, v117
  ds_write_b128 v11, v[144:147] offset:0
  ds_write_b128 v11, v[148:151] offset:16
  v_lshl_or_b32 v152, v103, 16, v102
  v_lshl_or_b32 v153, v105, 16, v104
  v_lshl_or_b32 v154, v107, 16, v106
  v_lshl_or_b32 v155, v109, 16, v108
  v_lshl_or_b32 v156, v111, 16, v110
  v_lshl_or_b32 v157, v113, 16, v112
  v_lshl_or_b32 v158, v115, 16, v114
  v_lshl_or_b32 v159, v117, 16, v116
  ds_write_b128 v11, v[152:155] offset:2624
  ds_write_b128 v11, v[156:159] offset:2640
  v_lshl_or_b32 v160, v102, 16, v101
  v_lshl_or_b32 v161, v104, 16, v103
  v_lshl_or_b32 v162, v106, 16, v105
  v_lshl_or_b32 v163, v108, 16, v107
  v_lshl_or_b32 v164, v110, 16, v109
  v_lshl_or_b32 v165, v112, 16, v111
  v_lshl_or_b32 v166, v114, 16, v113
  v_lshl_or_b32 v167, v116, 16, v115
  ds_write_b128 v11, v[160:163] offset:5248
  ds_write_b128 v11, v[164:167] offset:5264
  v_lshl_or_b32 v168, v101, 16, v100
  v_lshl_or_b32 v169, v103, 16, v102
  v_lshl_or_b32 v170, v105, 16, v104
  v_lshl_or_b32 v171, v107, 16, v106
  v_lshl_or_b32 v172, v109, 16, v108
  v_lshl_or_b32 v173, v111, 16, v110
  v_lshl_or_b32 v174, v113, 16, v112
  v_lshl_or_b32 v175, v115, 16, v114
  ds_write_b128 v11, v[168:171] offset:7872
  ds_write_b128 v11, v[172:175] offset:7888
L_EXD:
  s_cmp_gt_u32 s3, 2
  s_cbranch_scc1 L_ZD
  v_mov_b32 v18, 0
  v_mov_b32 v19, 0
  ds_write_b64 v15, v[18:19]
  ds_write_b64 v15, v[18:19] offset:8
L_ZD:
  v_lshlrev_b32 v45, 2, v2
  v_add_u32 v45, 70144, v45
  ds_write_b32 v45, v248
  s_cmp_eq_u32 s62, 0
  s_cbranch_scc1 L_HC2
  s_waitcnt vmcnt(3)
LM_5:
  v_cmp_ne_u64 vcc, s[42:43], v[226:227]
  s_cbranch_vccnz LM_6
LM_7:
  v_add_f32_dpp v224, v224, v224 quad_perm:[1,0,3,2] row_mask:0xf bank_mask:0xf
  v_add_f32_dpp v225, v225, v225 quad_perm:[1,0,3,2] row_mask:0xf bank_mask:0xf
  v_cvt_pk_bf16_f32 v225, v224, v225
  v_lshlrev_b32 v224, 16, v225
  v_and_b32 v225, 0xffff0000, v225
  v_add_f32 v226, 1.0, v224
  v_add_f32 v227, 1.0, v225
  v_cvt_pk_bf16_f32 v227, v226, v227
  v_lshlrev_b32 v226, 16, v227
  v_and_b32 v227, 0xffff0000, v227
  v_readlane_b32 s72, v224, 0
  v_readlane_b32 s76, v226, 4
  v_readlane_b32 s80, v224, 8
  v_readlane_b32 s73, v225, 0
  v_readlane_b32 s77, v227, 4
  v_readlane_b32 s81, v225, 8
  v_readlane_b32 s74, v224, 2
  v_readlane_b32 s78, v226, 6
  v_readlane_b32 s82, v224, 10
  v_readlane_b32 s75, v225, 2
  v_readlane_b32 s79, v227, 6
  v_readlane_b32 s83, v225, 10
  v_mul_f32 v210, v208, v209
  v_mul_f32 v214, v212, v213
  v_mul_f32 v218, v216, v217
  v_mul_f32 v222, v220, v221
  v_mov_b32 v20, s72
  v_mov_b32 v21, s73
  v_mov_b32 v22, s74
  v_mov_b32 v23, s75
  v_lshlrev_b32 v224, 16, v48
  v_and_b32 v225, 0xffff0000, v48
  v_lshlrev_b32 v226, 16, v49
  v_and_b32 v227, 0xffff0000, v49
  v_pk_fma_f32 v[176:177], v[224:225], v[208:209], v[210:211] op_sel:[0,1,0] op_sel_hi:[1,1,0] neg_lo:[0,0,1] neg_hi:[0,0,1]
  v_pk_fma_f32 v[178:179], v[226:227], v[208:209], v[210:211] op_sel:[0,1,0] op_sel_hi:[1,1,0] neg_lo:[0,0,1] neg_hi:[0,0,1]
  v_pk_fma_f32 v[176:177], v[176:177], s[76:77], v[20:21]
  v_pk_fma_f32 v[178:179], v[178:179], s[78:79], v[22:23]
  v_lshlrev_b32 v228, 16, v50
  v_and_b32 v229, 0xffff0000, v50
  v_lshlrev_b32 v230, 16, v51
  v_and_b32 v231, 0xffff0000, v51
  v_pk_fma_f32 v[180:181], v[228:229], v[212:213], v[214:215] op_sel:[0,1,0] op_sel_hi:[1,1,0] neg_lo:[0,0,1] neg_hi:[0,0,1]
  v_pk_fma_f32 v[182:183], v[230:231], v[212:213], v[214:215] op_sel:[0,1,0] op_sel_hi:[1,1,0] neg_lo:[0,0,1] neg_hi:[0,0,1]
  v_pk_fma_f32 v[180:181], v[180:181], s[76:77], v[20:21]
  v_pk_fma_f32 v[182:183], v[182:183], s[78:79], v[22:23]
  v_cvt_pk_bf16_f32 v24, v176, v180
  v_cvt_pk_bf16_f32 v25, v177, v181
  v_cvt_pk_bf16_f32 v26, v178, v182
  v_cvt_pk_bf16_f32 v27, v179, v183
  v_lshlrev_b32 v232, 16, v52
  v_and_b32 v233, 0xffff0000, v52
  v_lshlrev_b32 v234, 16, v53
  v_and_b32 v235, 0xffff0000, v53
  v_pk_fma_f32 v[184:185], v[232:233], v[216:217], v[218:219] op_sel:[0,1,0] op_sel_hi:[1,1,0] neg_lo:[0,0,1] neg_hi:[0,0,1]
  v_pk_fma_f32 v[186:187], v[234:235], v[216:217], v[218:219] op_sel:[0,1,0] op_sel_hi:[1,1,0] neg_lo:[0,0,1] neg_hi:[0,0,1]
  v_pk_fma_f32 v[184:185], v[184:185], s[76:77], v[20:21]
  v_pk_fma_f32 v[186:187], v[186:187], s[78:79], v[22:23]
  v_lshlrev_b32 v236, 16, v54
  v_and_b32 v237, 0xffff0000, v54
  v_lshlrev_b32 v238, 16, v55
  v_and_b32 v239, 0xffff0000, v55
  v_pk_fma_f32 v[188:189], v[236:237], v[220:221], v[222:223] op_sel:[0,1,0] op_sel_hi:[1,1,0] neg_lo:[0,0,1] neg_hi:[0,0,1]
  v_pk_fma_f32 v[190:191], v[238:239], v[220:221], v[222:223] op_sel:[0,1,0] op_sel_hi:[1,1,0] neg_lo:[0,0,1] neg_hi:[0,0,1]
  v_pk_fma_f32 v[188:189], v[188:189], s[76:77], v[20:21]
  v_pk_fma_f32 v[190:191], v[190:191], s[78:79], v[22:23]
  v_cvt_pk_bf16_f32 v28, v184, v188
  v_cvt_pk_bf16_f32 v29, v185, v189
  v_cvt_pk_bf16_f32 v30, v186, v190
  v_cvt_pk_bf16_f32 v31, v187, v191
L_HC2:
  ds_write_b32 v14, v24 offset:0
  ds_write_b32 v14, v25 offset:4608
  ds_write_b32 v14, v26 offset:9216
  ds_write_b32 v14, v27 offset:13824
  ds_write_b32 v14, v28 offset:2048
  ds_write_b32 v14, v29 offset:6656
  ds_write_b32 v14, v30 offset:11264
  ds_write_b32 v14, v31 offset:15872
  s_waitcnt vmcnt(0) lgkmcnt(0)
  s_barrier
  s_cmp_eq_u32 s62, 0
  s_cbranch_scc1 L_CVM
  s_cmp_lg_u32 s3, 4
  s_cbranch_scc1 L_RD2
  s_lshl_b32 s57, s60, 6
  s_add_u32 s57, s57, 268288
  s_mov_b64 exec, 1
  buffer_store_dwordx2 v[242:243], v248, s[44:47], s57 offen sc1
  s_mov_b64 exec, -1
L_RD2:
  s_setprio 0
  s_and_b32 s8, s2, 7
  s_lshl_b32 s8, s8, 5
  s_lshr_b32 s88, s2, 3
  s_add_u32 s8, s8, s88
  s_lshr_b32 s9, s8, 3
  s_and_b32 s10, s8, 7
  s_lshr_b32 s11, s10, 2
  s_add_u32 s11, s11, 1
  s_sub_u32 s88, 0, s11
  s_bitcmp1_b32 s10, 1
  s_cselect_b32 s11, s88, s11
  s_mul_i32 s13, s10, 80
  s_and_b32 s88, s10, 1
  s_lshl_b32 s89, s88, 4
  s_add_u32 s12, s13, s89
  s_xor_b32 s89, s88, 1
  s_lshl_b32 s89, s89, 6
  s_add_u32 s13, s13, s89
  s_lshr_b32 s89, s10, 1
  s_mul_i32 s89, s89, 5
  s_mul_i32 s14, s88, 3
  s_add_u32 s14, s14, s89
  s_lshl_b32 s14, s14, 10
  s_add_u32 s89, s89, 2
  s_lshl_b32 s89, s89, 10
  s_lshl_b32 s88, s88, 3
  s_add_u32 s15, s89, s88
  s_and_b32 s16, s8, 31
  s_lshr_b32 s17, s16, 3
  s_and_b32 s19, s8, 15
  s_mul_i32 s18, s17, 72
  s_lshl_b32 s88, s9, 6
  s_sub_u32 s18, s18, s88
  s_add_u32 s18, s18, 2
  s_and_b32 s88, s2, 7
  s_mul_i32 s88, s88, 1835008
  s_add_u32 s88, s88, 10485760
  s_add_u32 s48, s40, s88
  s_addc_u32 s49, s41, 0
  s_mov_b32 s50, 1835008
  s_mov_b32 s51, 0x20000
  s_lshl_b32 s21, s3, 10
  s_mul_i32 s22, s10, 102400
  s_add_u32 s23, s22, 5242880
  s_add_u32 s22, s22, 4194304
  s_mul_i32 s24, s19, 122880
  s_add_u32 s24, s24, 6291456
  s_mul_i32 s25, s10, 245760
  s_add_u32 s25, s25, 8388608
  s_and_b32 s88, s17, 1
  s_mul_i32 s88, s88, 122880
  s_add_u32 s25, s25, s88
  s_and_b32 s26, s8, 0xe0
  s_lshl_b32 s26, s26, 4
  s_add_u32 s26, s26, 32768
  s_mov_b32 s27, 262144
  s_and_b32 s96, s96, 15
  s_mul_i32 s64, s60, 17024
  s_add_u32 s64, s64, 1048704
  s_add_u32 s65, s64, 8192
  s_mov_b32 s68, 0
  s_mul_i32 s66, s10, 80
  s_lshr_b32 s66, s66, 6
  s_lshl_b32 s66, s66, 8
  s_add_u32 s66, s66, 1507328
  v_and_b32 v44, 3, v1
  v_lshlrev_b32 v44, 7, v44
  buffer_load_dwordx2 v[36:37], v44, s[48:51], s66 offen sc1
  s_cmp_lg_u32 s3, 4
  s_cbranch_scc1 LT_8
  s_and_b32 s88, s2, 7
  s_mul_i32 s88, s88, 1835008
  s_lshr_b32 s89, s2, 3
  s_mul_i32 s89, s89, 3328
  s_add_u32 s88, s88, s89
  s_add_u32 s88, s88, 11141120
  v_add_u32 v48, 0, v1
  v_min_u32 v48, 25, v48
  v_lshlrev_b32 v48, 7, v48
  buffer_load_dword v247, v48, s[44:47], s88 offen sc1
LT_8:
  s_lshl_b32 s68, s61, 10
  s_setprio 0
  v_lshrrev_b32 v100, 5, v1
  v_bfe_u32 v101, v1, 3, 2
  v_and_b32 v102, 7, v1
  s_mul_i32 s57, s61, 2080
  s_add_u32 s57, s57, 147464
  v_lshlrev_b32 v103, 3, v102
  v_sub_u32 v103, v103, v101
  v_lshl_add_u32 v104, v103, 1, v100
  v_lshlrev_b32 v104, 1, v104
  s_add_u32 s58, s57, 1240
  v_sub_u32 v104, s58, v104
  v_mov_b32 v105, s57
  ds_read_u16 v108, v104 offset:28
  ds_read_u16 v109, v104 offset:24
  ds_read_u16 v110, v104 offset:20
  ds_read_u16 v111, v104 offset:16
  ds_read_u16 v112, v104 offset:12
  ds_read_u16 v113, v104 offset:8
  ds_read_u16 v114, v104 offset:4
  ds_read_u16 v115, v104 offset:0
  ds_read_u16 v116, v105 offset:1024
  ds_read_u16 v117, v105 offset:1022
  s_mul_i32 s58, s61, 10496
  s_add_u32 s58, s58, 69056
  v_mul_u32_u24 v106, 2624, v101
  v_mul_u32_u24 v107, 192, v100
  v_add3_u32 v107, v107, v106, s58
  v_and_b32 v119, 3, v102
  v_lshl_add_u32 v119, v119, 4, v107
  v_lshl_add_u32 v107, v102, 4, v107
  v_min_u32 v118, 2, v102
  v_lshl_add_u32 v106, v118, 4, v106
  v_add_u32 v106, s58, v106
  v_mov_b32 v120, 0
  v_mov_b32 v121, 0
  v_mov_b32 v122, 0
  v_mov_b32 v123, 0
  ds_write_b128 v119, v[120:123] offset:1728
  ds_write_b128 v106, v[120:123] offset:1984
  s_waitcnt lgkmcnt(2)
  v_cmp_ge_i32 vcc, 55, v103
  s_nop 1
  v_cndmask_b32 v113, 0, v113, vcc
  v_cmp_ge_i32 vcc, 54, v103
  s_nop 1
  v_cndmask_b32 v114, 0, v114, vcc
  v_cmp_ge_i32 vcc, 53, v103
  s_nop 1
  v_cndmask_b32 v115, 0, v115, vcc
  v_lshl_or_b32 v124, v109, 16, v108
  v_lshl_or_b32 v125, v111, 16, v110
  v_lshl_or_b32 v126, v113, 16, v112
  v_lshl_or_b32 v127, v115, 16, v114
  ds_write_b128 v107, v[124:127] offset:1600
  v_lshl_or_b32 v130, v116, 16, v116
  v_lshlrev_b32 v118, 16, v116
  v_lshl_or_b32 v119, v117, 16, v116
  v_cmp_eq_u32 vcc, 0, v101
  s_nop 1
  v_cndmask_b32 v131, v130, v119, vcc
  v_cndmask_b32 v128, 0, v130, vcc
  v_cmp_eq_u32 vcc, 1, v101
  s_nop 1
  v_cndmask_b32 v128, v128, v118, vcc
  v_cmp_eq_u32 vcc, 3, v101
  s_nop 1
  v_cndmask_b32 v129, v130, v118, vcc
  v_mul_u32_u24 v106, 2624, v101
  v_add_u32 v106, s58, v106
  ds_write_b128 v106, v[128:131] offset:2032
  s_lshl_b32 s57, s61, 2
  s_add_u32 s57, s57, 70148
  v_mov_b32 v45, s57
  s_waitcnt lgkmcnt(0)
  ds_write_b32 v45, v45
  v_mov_b32 v45, 70144
  s_setprio 0
  v_lshlrev_b32 v16, 16, v46
  v_and_b32 v17, 0xffff0000, v46
  v_lshlrev_b32 v18, 16, v47
  v_and_b32 v19, 0xffff0000, v47
  v_mul_f32 v16, s80, v16
  v_mul_f32 v17, s81, v17
  v_mul_f32 v18, s82, v18
  v_mul_f32 v19, s83, v19
  v_lshlrev_b32 v20, 16, v24
  v_and_b32 v21, 0xffff0000, v24
  v_fmac_f32 v224, v20, v16
  v_fmac_f32 v228, v21, v16
  v_lshlrev_b32 v20, 16, v25
  v_and_b32 v21, 0xffff0000, v25
  v_fmac_f32 v225, v20, v17
  v_fmac_f32 v229, v21, v17
  v_lshlrev_b32 v20, 16, v26
  v_and_b32 v21, 0xffff0000, v26
  v_fmac_f32 v226, v20, v18
  v_fmac_f32 v230, v21, v18
  v_lshlrev_b32 v20, 16, v27
  v_and_b32 v21, 0xffff0000, v27
  v_fmac_f32 v227, v20, v19
  v_fmac_f32 v231, v21, v19
  v_lshlrev_b32 v20, 16, v28
  v_and_b32 v21, 0xffff0000, v28
  v_fmac_f32 v232, v20, v16
  v_fmac_f32 v236, v21, v16
  v_lshlrev_b32 v20, 16, v29
  v_and_b32 v21, 0xffff0000, v29
  v_fmac_f32 v233, v20, v17
  v_fmac_f32 v237, v21, v17
  v_lshlrev_b32 v20, 16, v30
  v_and_b32 v21, 0xffff0000, v30
  v_fmac_f32 v234, v20, v18
  v_fmac_f32 v238, v21, v18
  v_lshlrev_b32 v20, 16, v31
  v_and_b32 v21, 0xffff0000, v31
  v_fmac_f32 v235, v20, v19
  v_fmac_f32 v239, v21, v19
  v_lshrrev_b32 v18, 7, v0
  v_bfe_u32 v19, v0, 1, 2
  v_bfe_u32 v20, v0, 3, 4
  v_lshlrev_b32 v21, 2, v19
  v_xor_b32 v20, v20, v21
  v_lshlrev_b32 v16, 10, v18
  v_lshl_add_u32 v16, v19, 8, v16
  v_lshl_add_u32 v16, v20, 4, v16
  v_and_b32 v18, 1, v0
  v_lshl_add_u32 v16, v18, 3, v16
  v_add_u32 v16, 131072, v16
  v_lshlrev_b32 v17, 4, v0
  s_cmp_ge_u32 s68, 69632
  s_cbranch_scc1 L_CP3
  s_cmp_ge_u32 s68, 4096
  s_cbranch_scc1 L_CP2
  s_branch L_CP1B
L_CP1:
  s_sleep 2
  s_mul_i32 s66, s10, 80
  s_lshr_b32 s66, s66, 6
  s_lshl_b32 s66, s66, 8
  s_add_u32 s66, s66, 1507328
  v_and_b32 v44, 3, v1
  v_lshlrev_b32 v44, 7, v44
  buffer_load_dwordx2 v[36:37], v44, s[48:51], s66 offen sc1
L_CP1B:
  ds_read_b32 v49, v45
  s_waitcnt vmcnt(0) lgkmcnt(0)
  v_cmp_ne_u32 vcc, 0, v49
  s_cbranch_vccnz L_CP3
  v_cmp_ne_u64 vcc, s[42:43], v[36:37]
  s_cbranch_vccnz L_CP1
L_CP2:
  ds_read_b32 v49, v45
  s_mov_b32 m0, s68
  s_add_u32 s89, s68, s22
  s_add_u32 s68, s68, 4096
  buffer_load_dwordx4 v249, s[44:47], s89 offen sc1 lds
  s_cmp_ge_u32 s68, 69632
  s_cbranch_scc1 L_CP3
  s_waitcnt lgkmcnt(0)
  v_cmp_ne_u32 vcc, 0, v49
  s_cbranch_vccz L_CP2
L_CP3:
  s_setprio 0
  s_mov_b32 s26, 702464
  buffer_load_dwordx4 v[32:35], v248, s[48:51], s26 offen sc1
  s_branch L_CVE
L_CVM:
  ds_read_b128 v[96:99], v9 offset:0
  ds_read_b64 v[64:65], v8 offset:3584
  ds_read_b64 v[66:67], v8 offset:3592
  ds_read_b128 v[100:103], v9 offset:512
  ds_read_b64 v[68:69], v8 offset:3072
  ds_read_b64 v[70:71], v8 offset:3080
  ds_read_b128 v[104:107], v9 offset:1024
  ds_read_b64 v[72:73], v8 offset:2560
  ds_read_b64 v[74:75], v8 offset:2568
  ds_read_b128 v[108:111], v9 offset:1536
  ds_read_b64 v[76:77], v8 offset:2048
  ds_read_b64 v[78:79], v8 offset:2056
  ds_read_b128 v[112:115], v9 offset:2048
  ds_read_b128 v[116:119], v9 offset:2560
  ds_read_b128 v[120:123], v9 offset:3072
  ds_read_b128 v[124:127], v9 offset:3584
  s_waitcnt lgkmcnt(13)
  v_mfma_f32_16x16x32_bf16 v[192:195], v[64:67], v[96:99], 0
  ds_read_b128 v[160:163], v9 offset:64
  v_add_u32 v44, 4, v2
  s_waitcnt lgkmcnt(11)
  v_mfma_f32_16x16x32_bf16 v[196:199], v[64:67], v[100:103], 0
  ds_read_b64 v[128:129], v8 offset:3648
  v_lshlrev_b32 v45, 3, v3
  v_mfma_f32_16x16x32_bf16 v[196:199], v[68:71], v[96:99], v[196:199]
  ds_read_b64 v[130:131], v8 offset:3656
  v_mov_b32 v57, 511
  v_mfma_f32_16x16x32_bf16 v[200:203], v[68:71], v[100:103], 0
  ds_read_b128 v[164:167], v9 offset:576
  s_waitcnt lgkmcnt(11)
  v_mfma_f32_16x16x32_bf16 v[200:203], v[64:67], v[104:107], v[200:203]
  ds_read_b64 v[132:133], v8 offset:3136
  v_mfma_f32_16x16x32_bf16 v[204:207], v[68:71], v[104:107], 0
  ds_read_b64 v[134:135], v8 offset:3144
  v_mfma_f32_16x16x32_bf16 v[200:203], v[72:75], v[96:99], v[200:203]
  ds_read_b128 v[168:171], v9 offset:1088
  v_mfma_f32_16x16x32_bf16 v[204:207], v[72:75], v[100:103], v[204:207]
  ds_read_b64 v[136:137], v8 offset:2624
  v_mfma_f32_16x16x32_bf16 v[208:211], v[72:75], v[104:107], 0
  ds_read_b64 v[138:139], v8 offset:2632
  s_waitcnt lgkmcnt(13)
  v_mfma_f32_16x16x32_bf16 v[204:207], v[64:67], v[108:111], v[204:207]
  ds_read_b128 v[172:175], v9 offset:1600
  v_mfma_f32_16x16x32_bf16 v[208:211], v[68:71], v[108:111], v[208:211]
  ds_read_b64 v[140:141], v8 offset:2112
  v_mfma_f32_16x16x32_bf16 v[212:215], v[72:75], v[108:111], 0
  ds_read_b64 v[142:143], v8 offset:2120
  v_mfma_f32_16x16x32_bf16 v[204:207], v[76:79], v[96:99], v[204:207]
  ds_read_b128 v[176:179], v9 offset:2112
  v_mfma_f32_16x16x32_bf16 v[208:211], v[76:79], v[100:103], v[208:211]
  ds_read_b128 v[180:183], v9 offset:2624
  v_mfma_f32_16x16x32_bf16 v[212:215], v[76:79], v[104:107], v[212:215]
  ds_read_b128 v[184:187], v9 offset:3136
  v_mfma_f32_16x16x32_bf16 v[216:219], v[76:79], v[108:111], 0
  ds_read_b128 v[188:191], v9 offset:3648
  s_waitcnt lgkmcnt(15)
  v_mfma_f32_16x16x32_bf16 v[208:211], v[64:67], v[112:115], v[208:211]
  v_lshlrev_b32 v57, v44, v57
  v_lshrrev_b32 v57, v45, v57
  v_mfma_f32_16x16x32_bf16 v[212:215], v[68:71], v[112:115], v[212:215]
  v_bfe_u32 v58, v57, 0, 1
  v_bfe_u32 v59, v57, 1, 1
  v_mfma_f32_16x16x32_bf16 v[216:219], v[72:75], v[112:115], v[216:219]
  v_lshl_or_b32 v58, v59, 16, v58
  v_mul_u32_u24 v48, 0x3f80, v58
  v_mfma_f32_16x16x32_bf16 v[220:223], v[76:79], v[112:115], 0
  v_bfe_u32 v58, v57, 2, 1
  v_bfe_u32 v59, v57, 3, 1
  s_waitcnt lgkmcnt(15)
  v_mfma_f32_16x16x32_bf16 v[212:215], v[64:67], v[116:119], v[212:215]
  v_lshl_or_b32 v58, v59, 16, v58
  v_mul_u32_u24 v49, 0x3f80, v58
  v_mfma_f32_16x16x32_bf16 v[216:219], v[68:71], v[116:119], v[216:219]
  v_bfe_u32 v58, v57, 4, 1
  v_bfe_u32 v59, v57, 5, 1
  v_mfma_f32_16x16x32_bf16 v[220:223], v[72:75], v[116:119], v[220:223]
  v_lshl_or_b32 v58, v59, 16, v58
  v_mul_u32_u24 v50, 0x3f80, v58
  s_waitcnt lgkmcnt(15)
  v_mfma_f32_16x16x32_bf16 v[216:219], v[64:67], v[120:123], v[216:219]
  v_bfe_u32 v58, v57, 6, 1
  v_bfe_u32 v59, v57, 7, 1
  v_mfma_f32_16x16x32_bf16 v[220:223], v[68:71], v[120:123], v[220:223]
  v_lshl_or_b32 v58, v59, 16, v58
  v_mul_u32_u24 v51, 0x3f80, v58
  s_waitcnt lgkmcnt(15)
  v_mfma_f32_16x16x32_bf16 v[220:223], v[64:67], v[124:127], v[220:223]
  v_mov_b32 v57, 254
  v_lshlrev_b32 v57, v44, v57
  s_waitcnt lgkmcnt(0)
  v_mfma_f32_16x16x32_bf16 v[192:195], v[128:131], v[160:163], v[192:195]
  ds_read_b128 v[96:99], v9 offset:128
  v_lshrrev_b32 v57, v45, v57
  v_mfma_f32_16x16x32_bf16 v[196:199], v[128:131], v[164:167], v[196:199]
  ds_read_b64 v[64:65], v8 offset:3712
  v_bfe_u32 v58, v57, 0, 1
  v_mfma_f32_16x16x32_bf16 v[196:199], v[132:135], v[160:163], v[196:199]
  ds_read_b64 v[66:67], v8 offset:3720
  v_bfe_u32 v59, v57, 1, 1
  v_mfma_f32_16x16x32_bf16 v[200:203], v[132:135], v[164:167], v[200:203]
  ds_read_b128 v[100:103], v9 offset:640
  v_lshl_or_b32 v58, v59, 16, v58
  v_mfma_f32_16x16x32_bf16 v[200:203], v[128:131], v[168:171], v[200:203]
  ds_read_b64 v[68:69], v8 offset:3200
  v_mul_u32_u24 v52, 0x3f80, v58
  v_mfma_f32_16x16x32_bf16 v[204:207], v[132:135], v[168:171], v[204:207]
  ds_read_b64 v[70:71], v8 offset:3208
  v_bfe_u32 v58, v57, 2, 1
  v_mfma_f32_16x16x32_bf16 v[200:203], v[136:139], v[160:163], v[200:203]
  ds_read_b128 v[104:107], v9 offset:1152
  v_bfe_u32 v59, v57, 3, 1
  v_mfma_f32_16x16x32_bf16 v[204:207], v[136:139], v[164:167], v[204:207]
  ds_read_b64 v[72:73], v8 offset:2688
  v_lshl_or_b32 v58, v59, 16, v58
  v_mfma_f32_16x16x32_bf16 v[208:211], v[136:139], v[168:171], v[208:211]
  ds_read_b64 v[74:75], v8 offset:2696
  v_mul_u32_u24 v53, 0x3f80, v58
  v_mfma_f32_16x16x32_bf16 v[204:207], v[128:131], v[172:175], v[204:207]
  ds_read_b128 v[108:111], v9 offset:1664
  v_bfe_u32 v58, v57, 4, 1
  v_mfma_f32_16x16x32_bf16 v[208:211], v[132:135], v[172:175], v[208:211]
  ds_read_b64 v[76:77], v8 offset:2176
  v_bfe_u32 v59, v57, 5, 1
  v_mfma_f32_16x16x32_bf16 v[212:215], v[136:139], v[172:175], v[212:215]
  ds_read_b64 v[78:79], v8 offset:2184
  v_lshl_or_b32 v58, v59, 16, v58
  v_mfma_f32_16x16x32_bf16 v[204:207], v[140:143], v[160:163], v[204:207]
  ds_read_b128 v[112:115], v9 offset:2176
  v_mul_u32_u24 v54, 0x3f80, v58
  v_mfma_f32_16x16x32_bf16 v[208:211], v[140:143], v[164:167], v[208:211]
  ds_read_b128 v[116:119], v9 offset:2688
  v_bfe_u32 v58, v57, 6, 1
  v_mfma_f32_16x16x32_bf16 v[212:215], v[140:143], v[168:171], v[212:215]
  ds_read_b128 v[120:123], v9 offset:3200
  v_bfe_u32 v59, v57, 7, 1
  v_mfma_f32_16x16x32_bf16 v[216:219], v[140:143], v[172:175], v[216:219]
  ds_read_b128 v[124:127], v9 offset:3712
  v_lshl_or_b32 v58, v59, 16, v58
  v_mfma_f32_16x16x32_bf16 v[208:211], v[128:131], v[176:179], v[208:211]
  ds_read_b128 v[144:147], v9 offset:448
  v_mul_u32_u24 v55, 0x3f80, v58
  v_mfma_f32_16x16x32_bf16 v[212:215], v[132:135], v[176:179], v[212:215]
  ds_read_b128 v[148:151], v9 offset:960
  v_sub_u32 v60, v8, v45
  v_mfma_f32_16x16x32_bf16 v[216:219], v[136:139], v[176:179], v[216:219]
  ds_read_b128 v[152:155], v9 offset:1472
  v_lshlrev_b32 v16, 16, v46
  v_mfma_f32_16x16x32_bf16 v[220:223], v[140:143], v[176:179], v[220:223]
  ds_read_b128 v[156:159], v9 offset:1984
  v_and_b32 v17, 0xffff0000, v46
  v_mfma_f32_16x16x32_bf16 v[212:215], v[128:131], v[180:183], v[212:215]
  v_lshlrev_b32 v18, 16, v47
  v_and_b32 v19, 0xffff0000, v47
  v_mfma_f32_16x16x32_bf16 v[216:219], v[132:135], v[180:183], v[216:219]
  v_mul_f32 v16, s80, v16
  v_mul_f32 v17, s81, v17
  v_mfma_f32_16x16x32_bf16 v[220:223], v[136:139], v[180:183], v[220:223]
  v_mul_f32 v18, s82, v18
  v_mul_f32 v19, s83, v19
  v_mfma_f32_16x16x32_bf16 v[216:219], v[128:131], v[184:187], v[216:219]
  v_lshlrev_b32 v20, 16, v24
  v_and_b32 v21, 0xffff0000, v24
  v_mfma_f32_16x16x32_bf16 v[220:223], v[132:135], v[184:187], v[220:223]
  v_fmac_f32 v224, v20, v16
  v_fmac_f32 v228, v21, v16
  v_mfma_f32_16x16x32_bf16 v[220:223], v[128:131], v[188:191], v[220:223]
  v_lshlrev_b32 v20, 16, v25
  v_and_b32 v21, 0xffff0000, v25
  s_waitcnt lgkmcnt(0)
  v_mfma_f32_16x16x32_bf16 v[192:195], v[64:67], v[96:99], v[192:195]
  ds_read_b128 v[160:163], v9 offset:192
  v_fmac_f32 v225, v20, v17
  v_mfma_f32_16x16x32_bf16 v[196:199], v[64:67], v[100:103], v[196:199]
  ds_read_b64 v[128:129], v8 offset:3776
  v_fmac_f32 v229, v21, v17
  v_mfma_f32_16x16x32_bf16 v[196:199], v[68:71], v[96:99], v[196:199]
  ds_read_b64 v[130:131], v8 offset:3784
  v_lshlrev_b32 v20, 16, v26
  v_mfma_f32_16x16x32_bf16 v[200:203], v[68:71], v[100:103], v[200:203]
  ds_read_b128 v[164:167], v9 offset:704
  v_mfma_f32_16x16x32_bf16 v[200:203], v[64:67], v[104:107], v[200:203]
  ds_read_b64 v[132:133], v8 offset:3264
  v_mfma_f32_16x16x32_bf16 v[204:207], v[68:71], v[104:107], v[204:207]
  ds_read_b64 v[134:135], v8 offset:3272
  v_mfma_f32_16x16x32_bf16 v[200:203], v[72:75], v[96:99], v[200:203]
  ds_read_b128 v[168:171], v9 offset:1216
  v_mfma_f32_16x16x32_bf16 v[204:207], v[72:75], v[100:103], v[204:207]
  ds_read_b64 v[136:137], v8 offset:2752
  v_mfma_f32_16x16x32_bf16 v[208:211], v[72:75], v[104:107], v[208:211]
  ds_read_b64 v[138:139], v8 offset:2760
  v_mfma_f32_16x16x32_bf16 v[204:207], v[64:67], v[108:111], v[204:207]
  ds_read_b128 v[172:175], v9 offset:1728
  v_mfma_f32_16x16x32_bf16 v[208:211], v[68:71], v[108:111], v[208:211]
  ds_read_b64 v[140:141], v8 offset:2240
  v_mfma_f32_16x16x32_bf16 v[212:215], v[72:75], v[108:111], v[212:215]
  ds_read_b64 v[142:143], v8 offset:2248
  v_mfma_f32_16x16x32_bf16 v[204:207], v[76:79], v[96:99], v[204:207]
  ds_read_b128 v[176:179], v9 offset:2240
  v_mfma_f32_16x16x32_bf16 v[208:211], v[76:79], v[100:103], v[208:211]
  ds_read_b128 v[180:183], v9 offset:2752
  v_mfma_f32_16x16x32_bf16 v[212:215], v[76:79], v[104:107], v[212:215]
  ds_read_b128 v[184:187], v9 offset:3264
  v_mfma_f32_16x16x32_bf16 v[216:219], v[76:79], v[108:111], v[216:219]
  ds_read_b128 v[188:191], v9 offset:3776
  v_mfma_f32_16x16x32_bf16 v[208:211], v[64:67], v[112:115], v[208:211]
  v_and_b32 v21, 0xffff0000, v26
  v_fmac_f32 v226, v20, v18
  v_mfma_f32_16x16x32_bf16 v[212:215], v[68:71], v[112:115], v[212:215]
  v_fmac_f32 v230, v21, v18
  v_lshlrev_b32 v20, 16, v27
  v_mfma_f32_16x16x32_bf16 v[216:219], v[72:75], v[112:115], v[216:219]
  v_and_b32 v21, 0xffff0000, v27
  v_fmac_f32 v227, v20, v19
  v_mfma_f32_16x16x32_bf16 v[220:223], v[76:79], v[112:115], v[220:223]
  v_fmac_f32 v231, v21, v19
  v_lshlrev_b32 v20, 16, v28
  v_mfma_f32_16x16x32_bf16 v[212:215], v[64:67], v[116:119], v[212:215]
  v_and_b32 v21, 0xffff0000, v28
  v_fmac_f32 v232, v20, v16
  v_mfma_f32_16x16x32_bf16 v[216:219], v[68:71], v[116:119], v[216:219]
  v_fmac_f32 v236, v21, v16
  v_lshlrev_b32 v20, 16, v29
  v_mfma_f32_16x16x32_bf16 v[220:223], v[72:75], v[116:119], v[220:223]
  v_and_b32 v21, 0xffff0000, v29
  v_fmac_f32 v233, v20, v17
  v_mfma_f32_16x16x32_bf16 v[216:219], v[64:67], v[120:123], v[216:219]
  v_fmac_f32 v237, v21, v17
  v_lshlrev_b32 v20, 16, v30
  v_mfma_f32_16x16x32_bf16 v[220:223], v[68:71], v[120:123], v[220:223]
  v_and_b32 v21, 0xffff0000, v30
  v_fmac_f32 v234, v20, v18
  v_mfma_f32_16x16x32_bf16 v[220:223], v[64:67], v[124:127], v[220:223]
  v_fmac_f32 v238, v21, v18
  v_lshlrev_b32 v20, 16, v31
  v_mfma_f32_16x16x32_bf16 v[80:83], v[144:147], v[52:55], 0
  v_and_b32 v21, 0xffff0000, v31
  v_fmac_f32 v235, v20, v19
  v_mfma_f32_16x16x32_bf16 v[84:87], v[148:151], v[52:55], 0
  v_fmac_f32 v239, v21, v19
  v_lshrrev_b32 v18, 7, v0
  v_mfma_f32_16x16x32_bf16 v[88:91], v[152:155], v[52:55], 0
  v_bfe_u32 v19, v0, 1, 2
  v_bfe_u32 v20, v0, 3, 4
  v_mfma_f32_16x16x32_bf16 v[92:95], v[156:159], v[52:55], 0
  v_lshlrev_b32 v21, 2, v19
  v_xor_b32 v20, v20, v21
  s_waitcnt lgkmcnt(0)
  v_mfma_f32_16x16x32_bf16 v[192:195], v[128:131], v[160:163], v[192:195]
  ds_read_b128 v[96:99], v9 offset:256
  v_lshlrev_b32 v16, 10, v18
  v_mfma_f32_16x16x32_bf16 v[196:199], v[128:131], v[164:167], v[196:199]
  ds_read_b64 v[64:65], v8 offset:3840
  v_lshl_add_u32 v16, v19, 8, v16
  v_mfma_f32_16x16x32_bf16 v[196:199], v[132:135], v[160:163], v[196:199]
  ds_read_b64 v[66:67], v8 offset:3848
  v_lshl_add_u32 v16, v20, 4, v16
  v_mfma_f32_16x16x32_bf16 v[200:203], v[132:135], v[164:167], v[200:203]
  ds_read_b128 v[100:103], v9 offset:768
  v_cvt_pk_bf16_f32 v80, v80, v81
  v_mfma_f32_16x16x32_bf16 v[200:203], v[128:131], v[168:171], v[200:203]
  ds_read_b64 v[68:69], v8 offset:3328
  v_cvt_pk_bf16_f32 v81, v82, v83
  v_mfma_f32_16x16x32_bf16 v[204:207], v[132:135], v[168:171], v[204:207]
  ds_read_b64 v[70:71], v8 offset:3336
  v_cvt_pk_bf16_f32 v82, v84, v85
  v_mfma_f32_16x16x32_bf16 v[200:203], v[136:139], v[160:163], v[200:203]
  ds_read_b128 v[104:107], v9 offset:1280
  v_cvt_pk_bf16_f32 v83, v86, v87
  v_mfma_f32_16x16x32_bf16 v[204:207], v[136:139], v[164:167], v[204:207]
  ds_read_b64 v[72:73], v8 offset:2816
  v_cvt_pk_bf16_f32 v84, v88, v89
  v_mfma_f32_16x16x32_bf16 v[208:211], v[136:139], v[168:171], v[208:211]
  ds_read_b64 v[74:75], v8 offset:2824
  v_cvt_pk_bf16_f32 v85, v90, v91
  v_mfma_f32_16x16x32_bf16 v[204:207], v[128:131], v[172:175], v[204:207]
  ds_read_b128 v[108:111], v9 offset:1792
  v_cvt_pk_bf16_f32 v86, v92, v93
  v_mfma_f32_16x16x32_bf16 v[208:211], v[132:135], v[172:175], v[208:211]
  ds_read_b64 v[76:77], v8 offset:2304
  v_cvt_pk_bf16_f32 v87, v94, v95
  v_mfma_f32_16x16x32_bf16 v[212:215], v[136:139], v[172:175], v[212:215]
  ds_read_b64 v[78:79], v8 offset:2312
  v_mfma_f32_16x16x32_bf16 v[204:207], v[140:143], v[160:163], v[204:207]
  ds_read_b128 v[112:115], v9 offset:2304
  v_mfma_f32_16x16x32_bf16 v[208:211], v[140:143], v[164:167], v[208:211]
  ds_read_b128 v[116:119], v9 offset:2816
  v_mfma_f32_16x16x32_bf16 v[212:215], v[140:143], v[168:171], v[212:215]
  ds_read_b128 v[120:123], v9 offset:3328
  v_mfma_f32_16x16x32_bf16 v[216:219], v[140:143], v[172:175], v[216:219]
  ds_read_b128 v[124:127], v9 offset:3840
  v_mfma_f32_16x16x32_bf16 v[208:211], v[128:131], v[176:179], v[208:211]
  ds_read_b128 v[144:147], v9 offset:432
  v_mfma_f32_16x16x32_bf16 v[212:215], v[132:135], v[176:179], v[212:215]
  ds_read_b128 v[148:151], v9 offset:944
  v_mfma_f32_16x16x32_bf16 v[216:219], v[136:139], v[176:179], v[216:219]
  ds_read_b128 v[152:155], v9 offset:1456
  v_mfma_f32_16x16x32_bf16 v[220:223], v[140:143], v[176:179], v[220:223]
  ds_read_b128 v[156:159], v9 offset:1968
  v_mfma_f32_16x16x32_bf16 v[212:215], v[128:131], v[180:183], v[212:215]
  v_and_b32 v18, 1, v0
  v_lshl_add_u32 v16, v18, 3, v16
  v_mfma_f32_16x16x32_bf16 v[216:219], v[132:135], v[180:183], v[216:219]
  v_add_u32 v16, 131072, v16
  v_lshlrev_b32 v17, 4, v0
  v_mfma_f32_16x16x32_bf16 v[220:223], v[136:139], v[180:183], v[220:223]
  s_and_b32 s8, s2, 7
  s_lshl_b32 s8, s8, 5
  v_mfma_f32_16x16x32_bf16 v[216:219], v[128:131], v[184:187], v[216:219]
  s_lshr_b32 s88, s2, 3
  s_add_u32 s8, s8, s88
  v_mfma_f32_16x16x32_bf16 v[220:223], v[132:135], v[184:187], v[220:223]
  s_lshr_b32 s9, s8, 3
  s_and_b32 s10, s8, 7
  v_mfma_f32_16x16x32_bf16 v[220:223], v[128:131], v[188:191], v[220:223]
  s_lshr_b32 s11, s10, 2
  s_add_u32 s11, s11, 1
  s_waitcnt lgkmcnt(0)
  v_mfma_f32_16x16x32_bf16 v[192:195], v[64:67], v[96:99], v[192:195]
  ds_read_b128 v[160:163], v9 offset:320
  s_sub_u32 s88, 0, s11
  v_mfma_f32_16x16x32_bf16 v[196:199], v[64:67], v[100:103], v[196:199]
  ds_read_b64 v[128:129], v8 offset:3904
  s_bitcmp1_b32 s10, 1
  v_mfma_f32_16x16x32_bf16 v[196:199], v[68:71], v[96:99], v[196:199]
  ds_read_b64 v[130:131], v8 offset:3912
  s_cselect_b32 s11, s88, s11
  v_mfma_f32_16x16x32_bf16 v[200:203], v[68:71], v[100:103], v[200:203]
  ds_read_b128 v[164:167], v9 offset:832
  v_mfma_f32_16x16x32_bf16 v[200:203], v[64:67], v[104:107], v[200:203]
  ds_read_b64 v[132:133], v8 offset:3392
  v_mfma_f32_16x16x32_bf16 v[204:207], v[68:71], v[104:107], v[204:207]
  ds_read_b64 v[134:135], v8 offset:3400
  v_mfma_f32_16x16x32_bf16 v[200:203], v[72:75], v[96:99], v[200:203]
  ds_read_b128 v[168:171], v9 offset:1344
  v_mfma_f32_16x16x32_bf16 v[204:207], v[72:75], v[100:103], v[204:207]
  ds_read_b64 v[136:137], v8 offset:2880
  v_mfma_f32_16x16x32_bf16 v[208:211], v[72:75], v[104:107], v[208:211]
  ds_read_b64 v[138:139], v8 offset:2888
  v_mfma_f32_16x16x32_bf16 v[204:207], v[64:67], v[108:111], v[204:207]
  ds_read_b128 v[172:175], v9 offset:1856
  v_mfma_f32_16x16x32_bf16 v[208:211], v[68:71], v[108:111], v[208:211]
  ds_read_b64 v[140:141], v8 offset:2368
  v_mfma_f32_16x16x32_bf16 v[212:215], v[72:75], v[108:111], v[212:215]
  ds_read_b64 v[142:143], v8 offset:2376
  v_mfma_f32_16x16x32_bf16 v[204:207], v[76:79], v[96:99], v[204:207]
  ds_read_b128 v[176:179], v9 offset:2368
  v_mfma_f32_16x16x32_bf16 v[208:211], v[76:79], v[100:103], v[208:211]
  ds_read_b128 v[180:183], v9 offset:2880
  v_mfma_f32_16x16x32_bf16 v[212:215], v[76:79], v[104:107], v[212:215]
  ds_read_b128 v[184:187], v9 offset:3392
  v_mfma_f32_16x16x32_bf16 v[216:219], v[76:79], v[108:111], v[216:219]
  ds_read_b128 v[188:191], v9 offset:3904
  v_mfma_f32_16x16x32_bf16 v[208:211], v[64:67], v[112:115], v[208:211]
  s_mul_i32 s13, s10, 80
  s_and_b32 s88, s10, 1
  v_mfma_f32_16x16x32_bf16 v[212:215], v[68:71], v[112:115], v[212:215]
  s_lshl_b32 s89, s88, 4
  s_add_u32 s12, s13, s89
  v_mfma_f32_16x16x32_bf16 v[216:219], v[72:75], v[112:115], v[216:219]
  s_xor_b32 s89, s88, 1
  s_lshl_b32 s89, s89, 6
  v_mfma_f32_16x16x32_bf16 v[220:223], v[76:79], v[112:115], v[220:223]
  s_add_u32 s13, s13, s89
  s_lshr_b32 s89, s10, 1
  v_mfma_f32_16x16x32_bf16 v[212:215], v[64:67], v[116:119], v[212:215]
  s_mul_i32 s89, s89, 5
  s_mul_i32 s14, s88, 3
  v_mfma_f32_16x16x32_bf16 v[216:219], v[68:71], v[116:119], v[216:219]
  s_add_u32 s14, s14, s89
  s_lshl_b32 s14, s14, 10
  v_mfma_f32_16x16x32_bf16 v[220:223], v[72:75], v[116:119], v[220:223]
  s_add_u32 s89, s89, 2
  s_lshl_b32 s89, s89, 10
  v_mfma_f32_16x16x32_bf16 v[216:219], v[64:67], v[120:123], v[216:219]
  s_lshl_b32 s88, s88, 3
  s_add_u32 s15, s89, s88
  v_mfma_f32_16x16x32_bf16 v[220:223], v[68:71], v[120:123], v[220:223]
  s_and_b32 s16, s8, 31
  s_lshr_b32 s17, s16, 3
  v_mfma_f32_16x16x32_bf16 v[220:223], v[64:67], v[124:127], v[220:223]
  s_and_b32 s19, s8, 15
  s_mul_i32 s18, s17, 72
  v_mfma_f32_16x16x32_bf16 v[88:91], v[144:147], v[48:51], 0
  s_lshl_b32 s88, s9, 6
  s_sub_u32 s18, s18, s88
  v_mfma_f32_16x16x32_bf16 v[92:95], v[148:151], v[48:51], 0
  s_add_u32 s18, s18, 2
  s_and_b32 s88, s2, 7
  s_waitcnt lgkmcnt(0)
  v_mfma_f32_16x16x32_bf16 v[192:195], v[128:131], v[160:163], v[192:195]
  ds_read_b128 v[96:99], v9 offset:384
  s_mul_i32 s88, s88, 1835008
  v_mfma_f32_16x16x32_bf16 v[196:199], v[128:131], v[164:167], v[196:199]
  ds_read_b64 v[64:65], v8 offset:3968
  s_add_u32 s88, s88, 10485760
  v_mfma_f32_16x16x32_bf16 v[196:199], v[132:135], v[160:163], v[196:199]
  ds_read_b64 v[66:67], v8 offset:3976
  s_add_u32 s48, s40, s88
  v_mfma_f32_16x16x32_bf16 v[200:203], v[132:135], v[164:167], v[200:203]
  ds_read_b128 v[100:103], v9 offset:896
  v_cvt_pk_bf16_f32 v88, v88, v89
  v_mfma_f32_16x16x32_bf16 v[200:203], v[128:131], v[168:171], v[200:203]
  ds_read_b64 v[68:69], v8 offset:3456
  v_cvt_pk_bf16_f32 v89, v90, v91
  v_mfma_f32_16x16x32_bf16 v[204:207], v[132:135], v[168:171], v[204:207]
  ds_read_b64 v[70:71], v8 offset:3464
  v_cvt_pk_bf16_f32 v90, v92, v93
  v_mfma_f32_16x16x32_bf16 v[200:203], v[136:139], v[160:163], v[200:203]
  ds_read_b128 v[104:107], v9 offset:1408
  v_cvt_pk_bf16_f32 v91, v94, v95
  v_mfma_f32_16x16x32_bf16 v[204:207], v[136:139], v[164:167], v[204:207]
  ds_read_b64 v[72:73], v8 offset:2944
  v_mfma_f32_16x16x32_bf16 v[208:211], v[136:139], v[168:171], v[208:211]
  ds_read_b64 v[74:75], v8 offset:2952
  v_mfma_f32_16x16x32_bf16 v[204:207], v[128:131], v[172:175], v[204:207]
  ds_read_b128 v[108:111], v9 offset:1920
  v_mfma_f32_16x16x32_bf16 v[208:211], v[132:135], v[172:175], v[208:211]
  ds_read_b64 v[76:77], v8 offset:2432
  v_mfma_f32_16x16x32_bf16 v[212:215], v[136:139], v[172:175], v[212:215]
  ds_read_b64 v[78:79], v8 offset:2440
  v_mfma_f32_16x16x32_bf16 v[204:207], v[140:143], v[160:163], v[204:207]
  ds_read_b128 v[112:115], v9 offset:2432
  v_mfma_f32_16x16x32_bf16 v[208:211], v[140:143], v[164:167], v[208:211]
  ds_read_b128 v[116:119], v9 offset:2944
  v_mfma_f32_16x16x32_bf16 v[212:215], v[140:143], v[168:171], v[212:215]
  ds_read_b128 v[120:123], v9 offset:3456
  v_mfma_f32_16x16x32_bf16 v[216:219], v[140:143], v[172:175], v[216:219]
  ds_read_b128 v[124:127], v9 offset:3968
  v_mfma_f32_16x16x32_bf16 v[208:211], v[128:131], v[176:179], v[208:211]
  s_addc_u32 s49, s41, 0
  s_mov_b32 s50, 1835008
  v_mfma_f32_16x16x32_bf16 v[212:215], v[132:135], v[176:179], v[212:215]
  s_mov_b32 s51, 0x20000
  s_lshl_b32 s21, s3, 10
  v_mfma_f32_16x16x32_bf16 v[216:219], v[136:139], v[176:179], v[216:219]
  s_mul_i32 s22, s10, 102400
  s_add_u32 s23, s22, 5242880
  v_mfma_f32_16x16x32_bf16 v[220:223], v[140:143], v[176:179], v[220:223]
  s_add_u32 s22, s22, 4194304
  s_mul_i32 s24, s19, 122880
  v_mfma_f32_16x16x32_bf16 v[212:215], v[128:131], v[180:183], v[212:215]
  s_add_u32 s24, s24, 6291456
  s_mul_i32 s25, s10, 245760
  v_mfma_f32_16x16x32_bf16 v[216:219], v[132:135], v[180:183], v[216:219]
  s_add_u32 s25, s25, 8388608
  s_and_b32 s88, s17, 1
  v_mfma_f32_16x16x32_bf16 v[220:223], v[136:139], v[180:183], v[220:223]
  s_mul_i32 s88, s88, 122880
  s_add_u32 s25, s25, s88
  v_mfma_f32_16x16x32_bf16 v[216:219], v[128:131], v[184:187], v[216:219]
  s_and_b32 s26, s8, 0xe0
  s_lshl_b32 s26, s26, 4
  v_mfma_f32_16x16x32_bf16 v[220:223], v[132:135], v[184:187], v[220:223]
  s_add_u32 s26, s26, 32768
  s_mov_b32 s27, 262144
  v_mfma_f32_16x16x32_bf16 v[220:223], v[128:131], v[188:191], v[220:223]
  s_and_b32 s96, s96, 15
  s_mul_i32 s64, s60, 17024
  v_mfma_f32_16x16x32_bf16 v[144:147], v[152:155], v[48:51], 0
  s_add_u32 s64, s64, 1048704
  s_add_u32 s65, s64, 8192
  v_mfma_f32_16x16x32_bf16 v[148:151], v[156:159], v[48:51], 0
  s_mov_b32 s68, 0
  v_and_b32 v45, 12, v1
  v_add_u32 v45, 70148, v45
L_TB:
  ds_read_b32 v44, v45
  s_waitcnt lgkmcnt(0)
  v_cmp_eq_u32 vcc, 0, v44
  s_cbranch_vccnz L_TB
  s_waitcnt lgkmcnt(0)
  v_mfma_f32_16x16x32_bf16 v[192:195], v[64:67], v[96:99], v[192:195]
  ds_read_b128 v[160:163], v9 offset:448
  v_mfma_f32_16x16x32_bf16 v[196:199], v[64:67], v[100:103], v[196:199]
  ds_read_b64 v[128:129], v8 offset:4032
  v_mfma_f32_16x16x32_bf16 v[196:199], v[68:71], v[96:99], v[196:199]
  ds_read_b64 v[130:131], v8 offset:4040
  v_mfma_f32_16x16x32_bf16 v[200:203], v[68:71], v[100:103], v[200:203]
  ds_read_b128 v[164:167], v9 offset:960
  v_cvt_pk_bf16_f32 v92, v144, v145
  v_mfma_f32_16x16x32_bf16 v[200:203], v[64:67], v[104:107], v[200:203]
  ds_read_b64 v[132:133], v8 offset:3520
  v_cvt_pk_bf16_f32 v93, v146, v147
  v_mfma_f32_16x16x32_bf16 v[204:207], v[68:71], v[104:107], v[204:207]
  ds_read_b64 v[134:135], v8 offset:3528
  v_cvt_pk_bf16_f32 v94, v148, v149
  v_mfma_f32_16x16x32_bf16 v[200:203], v[72:75], v[96:99], v[200:203]
  ds_read_b128 v[168:171], v9 offset:1472
  v_cvt_pk_bf16_f32 v95, v150, v151
  v_mfma_f32_16x16x32_bf16 v[204:207], v[72:75], v[100:103], v[204:207]
  ds_read_b64 v[136:137], v8 offset:3008
  v_mfma_f32_16x16x32_bf16 v[208:211], v[72:75], v[104:107], v[208:211]
  ds_read_b64 v[138:139], v8 offset:3016
  v_mfma_f32_16x16x32_bf16 v[204:207], v[64:67], v[108:111], v[204:207]
  ds_read_b128 v[172:175], v9 offset:1984
  v_mfma_f32_16x16x32_bf16 v[208:211], v[68:71], v[108:111], v[208:211]
  ds_read_b64 v[140:141], v8 offset:2496
  v_mfma_f32_16x16x32_bf16 v[212:215], v[72:75], v[108:111], v[212:215]
  ds_read_b64 v[142:143], v8 offset:2504
  v_mfma_f32_16x16x32_bf16 v[204:207], v[76:79], v[96:99], v[204:207]
  ds_read_b128 v[176:179], v9 offset:2496
  v_mfma_f32_16x16x32_bf16 v[208:211], v[76:79], v[100:103], v[208:211]
  ds_read_b128 v[180:183], v9 offset:3008
  v_mfma_f32_16x16x32_bf16 v[212:215], v[76:79], v[104:107], v[212:215]
  ds_read_b128 v[184:187], v9 offset:3520
  v_mfma_f32_16x16x32_bf16 v[216:219], v[76:79], v[108:111], v[216:219]
  ds_read_b128 v[188:191], v9 offset:4032
  v_mfma_f32_16x16x32_bf16 v[208:211], v[64:67], v[112:115], v[208:211]
  ds_read_b64 v[152:153], v8 offset:1984
  v_mfma_f32_16x16x32_bf16 v[212:215], v[68:71], v[112:115], v[212:215]
  ds_read_b64 v[154:155], v8 offset:1992
  v_mfma_f32_16x16x32_bf16 v[216:219], v[72:75], v[112:115], v[216:219]
  v_mfma_f32_16x16x32_bf16 v[220:223], v[76:79], v[112:115], v[220:223]
  v_mfma_f32_16x16x32_bf16 v[212:215], v[64:67], v[116:119], v[212:215]
  v_mfma_f32_16x16x32_bf16 v[216:219], v[68:71], v[116:119], v[216:219]
  v_mfma_f32_16x16x32_bf16 v[220:223], v[72:75], v[116:119], v[220:223]
  v_mfma_f32_16x16x32_bf16 v[216:219], v[64:67], v[120:123], v[216:219]
  v_mfma_f32_16x16x32_bf16 v[220:223], v[68:71], v[120:123], v[220:223]
  v_mfma_f32_16x16x32_bf16 v[220:223], v[64:67], v[124:127], v[220:223]
  v_mov_b32 v45, 70144
  ds_write_b32 v45, v45
  s_waitcnt lgkmcnt(0)
  v_mfma_f32_16x16x32_bf16 v[192:195], v[128:131], v[160:163], v[192:195]
  ds_read_b64 v[96:97], v60 offset:1696
  v_mfma_f32_16x16x32_bf16 v[196:199], v[128:131], v[164:167], v[196:199]
  ds_read_b64 v[98:99], v60 offset:1728
  v_mfma_f32_16x16x32_bf16 v[196:199], v[132:135], v[160:163], v[196:199]
  ds_read_b64 v[100:101], v60 offset:1664
  v_mfma_f32_16x16x32_bf16 v[200:203], v[132:135], v[164:167], v[200:203]
  ds_read_b64 v[102:103], v60 offset:1696
  v_mfma_f32_16x16x32_bf16 v[200:203], v[128:131], v[168:171], v[200:203]
  ds_read_b64 v[104:105], v60 offset:1632
  v_mfma_f32_16x16x32_bf16 v[204:207], v[132:135], v[168:171], v[204:207]
  ds_read_b64 v[106:107], v60 offset:1664
  v_mfma_f32_16x16x32_bf16 v[200:203], v[136:139], v[160:163], v[200:203]
  ds_read_b64 v[108:109], v60 offset:1600
  v_mfma_f32_16x16x32_bf16 v[204:207], v[136:139], v[164:167], v[204:207]
  ds_read_b64 v[110:111], v60 offset:1632
  v_mfma_f32_16x16x32_bf16 v[208:211], v[136:139], v[168:171], v[208:211]
  ds_read_b64 v[112:113], v60 offset:1888
  v_mfma_f32_16x16x32_bf16 v[204:207], v[128:131], v[172:175], v[204:207]
  ds_read_b64 v[114:115], v60 offset:1920
  v_mfma_f32_16x16x32_bf16 v[208:211], v[132:135], v[172:175], v[208:211]
  ds_read_b64 v[116:117], v60 offset:1856
  v_mfma_f32_16x16x32_bf16 v[212:215], v[136:139], v[172:175], v[212:215]
  ds_read_b64 v[118:119], v60 offset:1888
  v_mfma_f32_16x16x32_bf16 v[204:207], v[140:143], v[160:163], v[204:207]
  ds_read_b64 v[120:121], v60 offset:1824
  v_mfma_f32_16x16x32_bf16 v[208:211], v[140:143], v[164:167], v[208:211]
  ds_read_b64 v[122:123], v60 offset:1856
  v_mfma_f32_16x16x32_bf16 v[212:215], v[140:143], v[168:171], v[212:215]
  ds_read_b64 v[124:125], v60 offset:1792
  v_mfma_f32_16x16x32_bf16 v[216:219], v[140:143], v[172:175], v[216:219]
  ds_read_b64 v[126:127], v60 offset:1824
  v_mfma_f32_16x16x32_bf16 v[208:211], v[128:131], v[176:179], v[208:211]
  v_mfma_f32_16x16x32_bf16 v[212:215], v[132:135], v[176:179], v[212:215]
  v_mfma_f32_16x16x32_bf16 v[216:219], v[136:139], v[176:179], v[216:219]
  v_mfma_f32_16x16x32_bf16 v[220:223], v[140:143], v[176:179], v[220:223]
  v_mfma_f32_16x16x32_bf16 v[212:215], v[128:131], v[180:183], v[212:215]
  v_mfma_f32_16x16x32_bf16 v[216:219], v[132:135], v[180:183], v[216:219]
  v_mfma_f32_16x16x32_bf16 v[220:223], v[136:139], v[180:183], v[220:223]
  v_mfma_f32_16x16x32_bf16 v[216:219], v[128:131], v[184:187], v[216:219]
  v_mfma_f32_16x16x32_bf16 v[220:223], v[132:135], v[184:187], v[220:223]
  v_mfma_f32_16x16x32_bf16 v[220:223], v[128:131], v[188:191], v[220:223]
  v_mfma_f32_16x16x32_bf16 v[208:211], v[152:155], v[160:163], v[208:211]
  v_mfma_f32_16x16x32_bf16 v[212:215], v[152:155], v[164:167], v[212:215]
  v_mfma_f32_16x16x32_bf16 v[216:219], v[152:155], v[168:171], v[216:219]
  v_mfma_f32_16x16x32_bf16 v[220:223], v[152:155], v[172:175], v[220:223]
  s_mov_b32 s26, 702464
  buffer_load_dwordx4 v[32:35], v248, s[48:51], s26 offen sc1
  ds_write_b128 v10, v[192:195] offset:0
  ds_write_b128 v10, v[196:199] offset:1024
  ds_write_b128 v10, v[200:203] offset:2048
  ds_write_b128 v10, v[204:207] offset:3072
  s_waitcnt lgkmcnt(4)
  v_mfma_f32_16x16x32_bf16 v[208:211], v[88:91], v[96:99], v[208:211]
  v_mfma_f32_16x16x32_bf16 v[212:215], v[88:91], v[100:103], v[212:215]
  v_mfma_f32_16x16x32_bf16 v[216:219], v[88:91], v[104:107], v[216:219]
  v_mfma_f32_16x16x32_bf16 v[220:223], v[88:91], v[108:111], v[220:223]
  v_mfma_f32_16x16x32_bf16 v[216:219], v[92:95], v[96:99], v[216:219]
  v_mfma_f32_16x16x32_bf16 v[220:223], v[92:95], v[100:103], v[220:223]
  v_mfma_f32_16x16x32_bf16 v[208:211], v[80:83], v[112:115], v[208:211]
  v_mfma_f32_16x16x32_bf16 v[212:215], v[80:83], v[116:119], v[212:215]
  v_mfma_f32_16x16x32_bf16 v[216:219], v[80:83], v[120:123], v[216:219]
  v_mfma_f32_16x16x32_bf16 v[220:223], v[80:83], v[124:127], v[220:223]
  v_mfma_f32_16x16x32_bf16 v[216:219], v[84:87], v[112:115], v[216:219]
  v_mfma_f32_16x16x32_bf16 v[220:223], v[84:87], v[116:119], v[220:223]
  s_nop 2
  ds_write_b128 v10, v[208:211] offset:4096
  ds_write_b128 v10, v[212:215] offset:5120
  s_nop 1
  ds_write_b128 v10, v[216:219] offset:6144
  ds_write_b128 v10, v[220:223] offset:7168
L_CVE:
  s_mov_b32 s71, 702720
  buffer_load_dwordx2 v[38:39], v248, s[48:51], s71 offen sc1
  s_waitcnt lgkmcnt(0)
  s_barrier
  ds_read_b64 v[64:65], v16 offset:0
  ds_read_b64 v[66:67], v16 offset:8192
  ds_read_b64 v[68:69], v16 offset:16384
  ds_read_b64 v[70:71], v16 offset:24576
  ds_read_b64 v[72:73], v16 offset:4096
  ds_read_b64 v[74:75], v16 offset:12288
  ds_read_b64 v[76:77], v16 offset:20480
  ds_read_b64 v[78:79], v16 offset:28672
  s_waitcnt lgkmcnt(4)
  v_fmac_f32 v224, s80, v64
  v_fmac_f32 v228, s80, v65
  v_fmac_f32 v225, s81, v66
  v_fmac_f32 v229, s81, v67
  v_fmac_f32 v226, s82, v68
  v_fmac_f32 v230, s82, v69
  v_fmac_f32 v227, s83, v70
  v_fmac_f32 v231, s83, v71
  v_cvt_pk_bf16_f32 v80, v224, v225
  v_cvt_pk_bf16_f32 v81, v226, v227
  v_cvt_pk_bf16_f32 v82, v228, v229
  v_cvt_pk_bf16_f32 v83, v230, v231
  buffer_store_dwordx4 v[80:83], v17, s[44:47], s64 offen sc1
  s_waitcnt lgkmcnt(0)
  v_fmac_f32 v232, s80, v72
  v_fmac_f32 v236, s80, v73
  v_fmac_f32 v233, s81, v74
  v_fmac_f32 v237, s81, v75
  v_fmac_f32 v234, s82, v76
  v_fmac_f32 v238, s82, v77
  v_fmac_f32 v235, s83, v78
  v_fmac_f32 v239, s83, v79
  v_cvt_pk_bf16_f32 v84, v232, v233
  v_cvt_pk_bf16_f32 v85, v234, v235
  v_cvt_pk_bf16_f32 v86, v236, v237
  v_cvt_pk_bf16_f32 v87, v238, v239
  buffer_store_dwordx4 v[84:87], v17, s[44:47], s65 offen sc1
  s_waitcnt vmcnt(2)
  v_cmp_ne_u64 vcc, s[42:43], v[34:35]
  s_cbranch_vccz L_CT2
L_ERc:
  s_mov_b32 s26, 702464
  buffer_load_dwordx4 v[32:35], v248, s[48:51], s26 offen sc1
  s_waitcnt vmcnt(0)
  v_cmp_ne_u64 vcc, s[42:43], v[34:35]
  s_cbranch_vccz L_EDc
  s_add_u32 s95, s95, 1
  s_cmp_gt_u32 s95, 262144
  s_cbranch_scc1 L_EDc
  s_sleep 4
  s_branch L_ERc
L_EDc:
L_CT2:
  s_add_u32 m0, s21, 69632
  s_add_u32 s89, s21, s22
  s_add_u32 s89, s89, 69632
  buffer_load_dwordx4 v249, s[44:47], s89 offen sc1 lds
  s_add_u32 m0, s21, 77824
  s_add_u32 s89, s21, s22
  s_add_u32 s89, s89, 77824
  buffer_load_dwordx4 v249, s[44:47], s89 offen sc1 lds
  s_add_u32 m0, s21, 86016
  s_add_u32 s89, s21, s22
  s_add_u32 s89, s89, 86016
  buffer_load_dwordx4 v249, s[44:47], s89 offen sc1 lds
  s_add_u32 m0, s21, 94208
  s_add_u32 s89, s21, s22
  s_add_u32 s89, s89, 94208
  buffer_load_dwordx4 v249, s[44:47], s89 offen sc1 lds
  s_cmp_eq_u32 s62, 0
  s_cbranch_scc1 L_CT3
L_CT4:
  s_cmp_ge_u32 s68, 69632
  s_cbranch_scc1 L_CT3
  s_mov_b32 m0, s68
  s_add_u32 s89, s68, s22
  s_add_u32 s68, s68, 4096
  buffer_load_dwordx4 v249, s[44:47], s89 offen sc1 lds
  s_branch L_CT4
L_CT3:
  v_readfirstlane_b32 s98, v32
  s_branch L_G1H
L_HELPER:
  s_sub_u32 s59, s2, 160
  s_mov_b32 s86, 0
  s_sub_u32 s66, s59, 20
  s_add_u32 s69, s59, 76
  s_cmp_lt_u32 s59, 20
  s_cselect_b32 s66, s69, s66
  s_lshr_b32 s67, s66, 1
  s_add_u32 s69, s67, 30
  s_sub_u32 s70, s67, 20
  s_cmp_lt_u32 s67, 50
  s_cselect_b32 s70, s70, s67
  s_cmp_lt_u32 s67, 20
  s_cselect_b32 s67, s69, s70
  s_and_b32 s68, s66, 1
  s_mul_i32 s69, s68, 320
  v_lshrrev_b32 v6, 3, v0
  v_add_u32 v6, s69, v6
  v_lshlrev_b32 v7, 1, v6
  s_movk_i32 s70, 7680
  v_mul_lo_u32 v6, v6, s70
  v_and_b32 v13, 7, v0
  v_lshl_add_u32 v6, v13, 4, v6
  s_lshl_b32 s70, s67, 7
  v_add_u32 v6, s70, v6
  global_load_ushort v52, v7, s[32:33] offset:0
  global_load_ushort v53, v7, s[32:33] offset:128
  global_load_ushort v54, v7, s[32:33] offset:256
  global_load_ushort v55, v7, s[32:33] offset:384
  global_load_ushort v56, v7, s[32:33] offset:512
  global_load_dwordx4 v[32:35], v6, s[34:35] nt
  v_add_u32 v6, 491520, v6
  global_load_dwordx4 v[36:39], v6, s[34:35] nt
  v_add_u32 v6, 491520, v6
  global_load_dwordx4 v[40:43], v6, s[34:35] nt
  v_add_u32 v6, 491520, v6
  global_load_dwordx4 v[44:47], v6, s[34:35] nt
  v_add_u32 v6, 491520, v6
  global_load_dwordx4 v[48:51], v6, s[34:35] nt
  s_sub_u32 s69, s59, 84
  s_cmp_lt_u32 s69, 4
  s_cbranch_scc0 L_H1
  s_barrier
  s_add_u32 s66, s59, 12
  s_lshr_b32 s84, s66, 1
  s_add_u32 s69, s84, 30
  s_sub_u32 s70, s84, 20
  s_cmp_lt_u32 s84, 50
  s_cselect_b32 s70, s70, s84
  s_cmp_lt_u32 s84, 20
  s_cselect_b32 s84, s69, s70
  s_and_b32 s85, s66, 1
  s_mul_i32 s69, s85, 320
  v_lshrrev_b32 v6, 3, v0
  v_add_u32 v6, s69, v6
  v_lshlrev_b32 v7, 1, v6
  s_movk_i32 s70, 7680
  v_mul_lo_u32 v6, v6, s70
  v_and_b32 v13, 7, v0
  v_lshl_add_u32 v6, v13, 4, v6
  s_lshl_b32 s70, s84, 7
  v_add_u32 v6, s70, v6
  global_load_ushort v152, v7, s[32:33] offset:0
  global_load_ushort v153, v7, s[32:33] offset:128
  global_load_ushort v154, v7, s[32:33] offset:256
  global_load_ushort v155, v7, s[32:33] offset:384
  global_load_ushort v156, v7, s[32:33] offset:512
  global_load_dwordx4 v[132:135], v6, s[34:35] nt
  v_add_u32 v6, 491520, v6
  global_load_dwordx4 v[136:139], v6, s[34:35] nt
  v_add_u32 v6, 491520, v6
  global_load_dwordx4 v[140:143], v6, s[34:35] nt
  v_add_u32 v6, 491520, v6
  global_load_dwordx4 v[144:147], v6, s[34:35] nt
  v_add_u32 v6, 491520, v6
  global_load_dwordx4 v[148:151], v6, s[34:35] nt
L_H1:
  s_mov_b32 s62, 0
  s_movk_i32 s63, 1280
  s_mov_b32 s50, 819200
  s_mov_b32 s51, 0x20000
  s_cmp_ge_u32 s59, 30
  s_cbranch_scc1 L_R2
  s_cmp_ge_u32 s59, 20
  s_cbranch_scc1 L_R1
  s_and_b32 s62, s59, 1
  s_mul_i32 s62, s62, 10
  s_mov_b32 s64, 5
  s_lshr_b32 s61, s59, 1
  s_mov_b32 s60, 0
  s_mov_b32 s48, s24
  s_mov_b32 s49, s25
  s_mov_b32 s65, 4194304
  s_branch L_R4
L_R1:
  s_mov_b32 s60, 1
  s_sub_u32 s61, s59, 20
  s_mov_b32 s64, 10
  s_mov_b32 s48, s26
  s_mov_b32 s49, s27
  s_mov_b32 s65, 5242880
  s_branch L_R4
L_R2:
  s_mov_b32 s50, 1966080
  s_cmp_ge_u32 s59, 54
  s_cbranch_scc1 L_R3
  s_mov_b32 s60, 2
  s_sub_u32 s61, s59, 30
  s_mov_b32 s48, s28
  s_mov_b32 s49, s29
  s_movk_i32 s63, 3072
  s_mov_b32 s64, 10
  s_mov_b32 s65, 6291456
  s_branch L_R4
L_R3:
  s_mov_b32 s60, 3
  s_sub_u32 s62, s59, 54
  s_mul_hi_u32 s61, s62, 0x55555556
  s_mul_i32 s64, s61, 3
  s_sub_u32 s62, s62, s64
  s_lshl_b32 s62, s62, 4
  s_mov_b32 s48, s30
  s_mov_b32 s49, s31
  s_cmp_lt_u32 s59, 84
  s_cselect_b32 s64, 8, 0
  s_mov_b32 s65, 8388608
L_R4:
  v_lshrrev_b32 v6, 3, v0
  v_mul_lo_u32 v15, v6, s63
  v_and_b32 v13, 7, v0
  v_and_b32 v14, 6, v6
  v_xor_b32 v13, v13, v14
  v_lshl_add_u32 v15, v13, 4, v15
  s_lshl_b32 s80, s61, 7
  s_mul_i32 s81, s62, s63
  s_lshl_b32 s81, s81, 5
  s_add_u32 s80, s80, s81
  s_lshl_b32 s81, s63, 6
  s_lshl_b32 s82, s3, 10
  s_mov_b32 s83, s64
  s_waitcnt lgkmcnt(0)
  s_add_u32 s42, s42, 0x9e3779b9
  s_add_u32 s43, s43, 0x85ebca6b
  s_sub_u32 s69, s59, 84
  s_cmp_lt_u32 s69, 4
  s_cbranch_scc0 L_H2
  s_waitcnt vmcnt(10)
  s_branch L_MODB
L_H2:
  s_cmp_ge_u32 s59, 20
  s_cbranch_scc1 L_MOD
  s_barrier
  s_cmp_eq_u32 s83, 0
  s_cbranch_scc1 LRG_9
  s_mov_b32 m0, s82
  s_add_u32 s82, s82, 8192
  buffer_load_dwordx4 v15, s[48:51], s80 offen nt lds
  s_add_u32 s80, s80, s81
  s_sub_u32 s83, s83, 1
LRG_9:
  s_cmp_eq_u32 s83, 0
  s_cbranch_scc1 LRG_10
  s_mov_b32 m0, s82
  s_add_u32 s82, s82, 8192
  buffer_load_dwordx4 v15, s[48:51], s80 offen nt lds
  s_add_u32 s80, s80, s81
  s_sub_u32 s83, s83, 1
LRG_10:
  s_cmp_eq_u32 s83, 0
  s_cbranch_scc1 LRG_11
  s_mov_b32 m0, s82
  s_add_u32 s82, s82, 8192
  buffer_load_dwordx4 v15, s[48:51], s80 offen nt lds
  s_add_u32 s80, s80, s81
  s_sub_u32 s83, s83, 1
LRG_11:
  s_cmp_eq_u32 s83, 0
  s_cbranch_scc1 LRG_12
  s_mov_b32 m0, s82
  s_add_u32 s82, s82, 8192
  buffer_load_dwordx4 v15, s[48:51], s80 offen nt lds
  s_add_u32 s80, s80, s81
  s_sub_u32 s83, s83, 1
LRG_12:
  s_cmp_eq_u32 s83, 0
  s_cbranch_scc1 LRG_13
  s_mov_b32 m0, s82
  s_add_u32 s82, s82, 8192
  buffer_load_dwordx4 v15, s[48:51], s80 offen nt lds
  s_add_u32 s80, s80, s81
  s_sub_u32 s83, s83, 1
LRG_13:
  s_waitcnt vmcnt(5)
  s_branch L_MODB
L_MOD:
  s_waitcnt vmcnt(0)
L_MODB:
  v_lshlrev_b32 v52, 16, v52
  v_lshlrev_b32 v53, 16, v53
  v_lshlrev_b32 v54, 16, v54
  v_lshlrev_b32 v55, 16, v55
  v_lshlrev_b32 v56, 16, v56
  v_mul_f32 v16, 0xbfb8aa3b, v52
  v_mul_f32 v17, 0xbfb8aa3b, v53
  v_mul_f32 v18, 0xbfb8aa3b, v54
  v_mul_f32 v19, 0xbfb8aa3b, v55
  v_mul_f32 v20, 0xbfb8aa3b, v56
  v_exp_f32 v16, v16
  v_exp_f32 v17, v17
  v_exp_f32 v18, v18
  v_exp_f32 v19, v19
  v_exp_f32 v20, v20
  v_add_f32 v16, 1.0, v16
  v_add_f32 v17, 1.0, v17
  v_add_f32 v18, 1.0, v18
  v_add_f32 v19, 1.0, v19
  v_add_f32 v20, 1.0, v20
  v_rcp_f32 v16, v16
  v_rcp_f32 v17, v17
  v_rcp_f32 v18, v18
  v_rcp_f32 v19, v19
  v_rcp_f32 v20, v20
  v_mul_f32 v52, v52, v16
  v_mul_f32 v53, v53, v17
  v_mul_f32 v54, v54, v18
  v_mul_f32 v55, v55, v19
  v_mul_f32 v56, v56, v20
  v_cvt_pk_bf16_f32 v52, v52, v52
  v_and_b32 v52, 0xffff0000, v52
  v_cvt_pk_bf16_f32 v53, v53, v53
  v_and_b32 v53, 0xffff0000, v53
  v_cvt_pk_bf16_f32 v54, v54, v54
  v_and_b32 v54, 0xffff0000, v54
  v_cvt_pk_bf16_f32 v55, v55, v55
  v_and_b32 v55, 0xffff0000, v55
  v_cvt_pk_bf16_f32 v56, v56, v56
  v_and_b32 v56, 0xffff0000, v56
  s_cmp_eq_u32 s83, 0
  s_cbranch_scc1 LRG_14
  s_mov_b32 m0, s82
  s_add_u32 s82, s82, 8192
  buffer_load_dwordx4 v15, s[48:51], s80 offen nt lds
  s_add_u32 s80, s80, s81
  s_sub_u32 s83, s83, 1
LRG_14:
  v_lshlrev_b32 v16, 16, v32
  v_and_b32 v17, 0xffff0000, v32
  v_mul_f32 v60, v16, v52
  v_mul_f32 v61, v17, v52
  v_lshlrev_b32 v16, 16, v33
  v_and_b32 v17, 0xffff0000, v33
  v_mul_f32 v62, v16, v52
  v_mul_f32 v63, v17, v52
  v_lshlrev_b32 v16, 16, v34
  v_and_b32 v17, 0xffff0000, v34
  v_mul_f32 v64, v16, v52
  v_mul_f32 v65, v17, v52
  v_lshlrev_b32 v16, 16, v35
  v_and_b32 v17, 0xffff0000, v35
  v_mul_f32 v66, v16, v52
  v_mul_f32 v67, v17, v52
  v_lshlrev_b32 v16, 16, v36
  v_and_b32 v17, 0xffff0000, v36
  v_fmac_f32 v60, v16, v53
  v_fmac_f32 v61, v17, v53
  v_lshlrev_b32 v16, 16, v37
  v_and_b32 v17, 0xffff0000, v37
  v_fmac_f32 v62, v16, v53
  v_fmac_f32 v63, v17, v53
  v_lshlrev_b32 v16, 16, v38
  v_and_b32 v17, 0xffff0000, v38
  v_fmac_f32 v64, v16, v53
  v_fmac_f32 v65, v17, v53
  v_lshlrev_b32 v16, 16, v39
  v_and_b32 v17, 0xffff0000, v39
  v_fmac_f32 v66, v16, v53
  v_fmac_f32 v67, v17, v53
  v_lshlrev_b32 v16, 16, v40
  v_and_b32 v17, 0xffff0000, v40
  v_fmac_f32 v60, v16, v54
  v_fmac_f32 v61, v17, v54
  v_lshlrev_b32 v16, 16, v41
  v_and_b32 v17, 0xffff0000, v41
  v_fmac_f32 v62, v16, v54
  v_fmac_f32 v63, v17, v54
  s_cmp_eq_u32 s83, 0
  s_cbranch_scc1 LRG_15
  s_mov_b32 m0, s82
  s_add_u32 s82, s82, 8192
  buffer_load_dwordx4 v15, s[48:51], s80 offen nt lds
  s_add_u32 s80, s80, s81
  s_sub_u32 s83, s83, 1
LRG_15:
  v_lshlrev_b32 v16, 16, v42
  v_and_b32 v17, 0xffff0000, v42
  v_fmac_f32 v64, v16, v54
  v_fmac_f32 v65, v17, v54
  v_lshlrev_b32 v16, 16, v43
  v_and_b32 v17, 0xffff0000, v43
  v_fmac_f32 v66, v16, v54
  v_fmac_f32 v67, v17, v54
  v_lshlrev_b32 v16, 16, v44
  v_and_b32 v17, 0xffff0000, v44
  v_fmac_f32 v60, v16, v55
  v_fmac_f32 v61, v17, v55
  v_lshlrev_b32 v16, 16, v45
  v_and_b32 v17, 0xffff0000, v45
  v_fmac_f32 v62, v16, v55
  v_fmac_f32 v63, v17, v55
  v_lshlrev_b32 v16, 16, v46
  v_and_b32 v17, 0xffff0000, v46
  v_fmac_f32 v64, v16, v55
  v_fmac_f32 v65, v17, v55
  v_lshlrev_b32 v16, 16, v47
  v_and_b32 v17, 0xffff0000, v47
  v_fmac_f32 v66, v16, v55
  v_fmac_f32 v67, v17, v55
  v_lshlrev_b32 v16, 16, v48
  v_and_b32 v17, 0xffff0000, v48
  v_fmac_f32 v60, v16, v56
  v_fmac_f32 v61, v17, v56
  v_lshlrev_b32 v16, 16, v49
  v_and_b32 v17, 0xffff0000, v49
  v_fmac_f32 v62, v16, v56
  v_fmac_f32 v63, v17, v56
  v_lshlrev_b32 v16, 16, v50
  v_and_b32 v17, 0xffff0000, v50
  v_fmac_f32 v64, v16, v56
  v_fmac_f32 v65, v17, v56
  v_lshlrev_b32 v16, 16, v51
  v_and_b32 v17, 0xffff0000, v51
  v_fmac_f32 v66, v16, v56
  v_fmac_f32 v67, v17, v56
  v_permlane32_swap_b32 v60, v64
  v_permlane32_swap_b32 v61, v65
  v_permlane32_swap_b32 v62, v66
  v_permlane32_swap_b32 v63, v67
  v_add_f32 v60, v60, v64
  v_add_f32 v61, v61, v65
  v_add_f32 v62, v62, v66
  v_add_f32 v63, v63, v67
  s_nop 0
  v_permlane16_swap_b32 v60, v62
  v_permlane16_swap_b32 v61, v63
  v_add_f32 v60, v60, v62
  v_add_f32 v61, v61, v63
  s_nop 0
  v_add_f32_dpp v60, v60, v60 row_ror:8 row_mask:0xf bank_mask:0xf
  v_add_f32_dpp v61, v61, v61 row_ror:8 row_mask:0xf bank_mask:0xf
  v_and_b32 v16, 7, v1
  v_lshlrev_b32 v16, 5, v16
  v_lshl_add_u32 v16, v3, 3, v16
  s_lshl_b32 s70, s3, 8
  s_and_b32 s71, s86, 1
  s_lshl_b32 s71, s71, 11
  s_add_u32 s71, s71, 131072
  s_add_u32 s70, s70, s71
  v_add_u32 v16, s70, v16
  ds_write_b64 v16, v[60:61]
  s_waitcnt lgkmcnt(0)
  s_barrier
  s_cmp_lg_u32 s3, 0
  s_cbranch_scc1 L_MOD2
  v_lshl_add_u32 v16, v5, 3, s71
  ds_read_b64 v[64:65], v16 offset:0
  ds_read_b64 v[66:67], v16 offset:256
  ds_read_b64 v[68:69], v16 offset:512
  ds_read_b64 v[70:71], v16 offset:768
  ds_read_b64 v[72:73], v16 offset:1024
  ds_read_b64 v[74:75], v16 offset:1280
  ds_read_b64 v[76:77], v16 offset:1536
  ds_read_b64 v[78:79], v16 offset:1792
  s_waitcnt lgkmcnt(0)
  v_pk_add_f32 v[64:65], v[64:65], v[66:67]
  v_pk_add_f32 v[64:65], v[64:65], v[68:69]
  v_pk_add_f32 v[64:65], v[64:65], v[70:71]
  v_pk_add_f32 v[64:65], v[64:65], v[72:73]
  v_pk_add_f32 v[64:65], v[64:65], v[74:75]
  v_pk_add_f32 v[64:65], v[64:65], v[76:77]
  v_pk_add_f32 v[64:65], v[64:65], v[78:79]
  v_mov_b32 v66, s42
  v_mov_b32 v67, s43
  v_lshlrev_b32 v17, 4, v5
  s_mul_i32 s70, s68, 30720
  s_lshl_b32 s71, s67, 9
  s_add_u32 s70, s70, s71
  s_add_u32 s70, s70, 147456
  s_mov_b32 exec_hi, 0
  buffer_store_dwordx4 v[64:67], v17, s[44:47], s70 offen sc1
  s_mov_b64 exec, -1
L_MOD2:
  s_cmp_lg_u32 s3, 7
  s_cbranch_scc1 LX_16
  s_and_b32 s88, s2, 7
  s_lshl_b32 s88, s88, 5
  s_lshr_b32 s89, s2, 3
  s_add_u32 s88, s88, s89
  s_lshl_b32 s88, s88, 4
  s_add_u32 s88, s88, 32768
  s_and_b32 s96, s96, 15
  v_mov_b32 v8, s96
  v_mov_b32 v9, 0
  v_mov_b32 v10, s42
  v_mov_b32 v11, s43
  s_mov_b64 exec, 1
  buffer_store_dwordx4 v[8:11], v248, s[44:47], s88 offen sc1
  s_mov_b64 exec, -1
LX_16:
  s_barrier
  s_cmp_eq_u32 s83, 0
  s_cbranch_scc1 LRG_17
  s_mov_b32 m0, s82
  s_add_u32 s82, s82, 8192
  buffer_load_dwordx4 v15, s[48:51], s80 offen nt lds
  s_add_u32 s80, s80, s81
  s_sub_u32 s83, s83, 1
LRG_17:
  s_cmp_eq_u32 s83, 0
  s_cbranch_scc1 LRG_18
  s_mov_b32 m0, s82
  s_add_u32 s82, s82, 8192
  buffer_load_dwordx4 v15, s[48:51], s80 offen nt lds
  s_add_u32 s80, s80, s81
  s_sub_u32 s83, s83, 1
LRG_18:
  s_cmp_eq_u32 s83, 0
  s_cbranch_scc1 LRG_19
  s_mov_b32 m0, s82
  s_add_u32 s82, s82, 8192
  buffer_load_dwordx4 v15, s[48:51], s80 offen nt lds
  s_add_u32 s80, s80, s81
  s_sub_u32 s83, s83, 1
LRG_19:
  s_cmp_eq_u32 s83, 0
  s_cbranch_scc1 LRG_20
  s_mov_b32 m0, s82
  s_add_u32 s82, s82, 8192
  buffer_load_dwordx4 v15, s[48:51], s80 offen nt lds
  s_add_u32 s80, s80, s81
  s_sub_u32 s83, s83, 1
LRG_20:
  s_cmp_eq_u32 s83, 0
  s_cbranch_scc1 LRG_21
  s_mov_b32 m0, s82
  s_add_u32 s82, s82, 8192
  buffer_load_dwordx4 v15, s[48:51], s80 offen nt lds
  s_add_u32 s80, s80, s81
  s_sub_u32 s83, s83, 1
LRG_21:
  s_cmp_eq_u32 s83, 0
  s_cbranch_scc1 LRG_22
  s_mov_b32 m0, s82
  s_add_u32 s82, s82, 8192
  buffer_load_dwordx4 v15, s[48:51], s80 offen nt lds
  s_add_u32 s80, s80, s81
  s_sub_u32 s83, s83, 1
LRG_22:
  s_cmp_eq_u32 s83, 0
  s_cbranch_scc1 LRG_23
  s_mov_b32 m0, s82
  s_add_u32 s82, s82, 8192
  buffer_load_dwordx4 v15, s[48:51], s80 offen nt lds
  s_add_u32 s80, s80, s81
  s_sub_u32 s83, s83, 1
LRG_23:
  s_cmp_eq_u32 s83, 0
  s_cbranch_scc1 LRG_24
  s_mov_b32 m0, s82
  s_add_u32 s82, s82, 8192
  buffer_load_dwordx4 v15, s[48:51], s80 offen nt lds
  s_add_u32 s80, s80, s81
  s_sub_u32 s83, s83, 1
LRG_24:
  s_cmp_lt_u32 s59, 84
  s_cbranch_scc1 L_REP
  s_add_u32 s86, s86, 1
  s_cmp_eq_u32 s86, 3
  s_cbranch_scc1 L_HDONE
  s_mul_i32 s66, s86, 12
  s_add_u32 s66, s66, s59
  s_cmp_lt_u32 s66, 100
  s_cbranch_scc1 L_MOD4
  s_lshr_b32 s67, s66, 1
  s_add_u32 s69, s67, 30
  s_sub_u32 s70, s67, 20
  s_cmp_lt_u32 s67, 50
  s_cselect_b32 s70, s70, s67
  s_cmp_lt_u32 s67, 20
  s_cselect_b32 s67, s69, s70
  s_and_b32 s68, s66, 1
  s_mul_i32 s69, s68, 320
  v_lshrrev_b32 v6, 3, v0
  v_add_u32 v6, s69, v6
  v_lshlrev_b32 v7, 1, v6
  s_movk_i32 s70, 7680
  v_mul_lo_u32 v6, v6, s70
  v_and_b32 v13, 7, v0
  v_lshl_add_u32 v6, v13, 4, v6
  s_lshl_b32 s70, s67, 7
  v_add_u32 v6, s70, v6
  global_load_ushort v52, v7, s[32:33] offset:0
  global_load_ushort v53, v7, s[32:33] offset:128
  global_load_ushort v54, v7, s[32:33] offset:256
  global_load_ushort v55, v7, s[32:33] offset:384
  global_load_ushort v56, v7, s[32:33] offset:512
  global_load_dwordx4 v[32:35], v6, s[34:35] nt
  v_add_u32 v6, 491520, v6
  global_load_dwordx4 v[36:39], v6, s[34:35] nt
  v_add_u32 v6, 491520, v6
  global_load_dwordx4 v[40:43], v6, s[34:35] nt
  v_add_u32 v6, 491520, v6
  global_load_dwordx4 v[44:47], v6, s[34:35] nt
  v_add_u32 v6, 491520, v6
  global_load_dwordx4 v[48:51], v6, s[34:35] nt
  s_branch L_MOD
L_MOD4:
  s_waitcnt vmcnt(0)
  s_mov_b32 s67, s84
  s_mov_b32 s68, s85
  v_mov_b32 v32, v132
  v_mov_b32 v33, v133
  v_mov_b32 v34, v134
  v_mov_b32 v35, v135
  v_mov_b32 v36, v136
  v_mov_b32 v37, v137
  v_mov_b32 v38, v138
  v_mov_b32 v39, v139
  v_mov_b32 v40, v140
  v_mov_b32 v41, v141
  v_mov_b32 v42, v142
  v_mov_b32 v43, v143
  v_mov_b32 v44, v144
  v_mov_b32 v45, v145
  v_mov_b32 v46, v146
  v_mov_b32 v47, v147
  v_mov_b32 v48, v148
  v_mov_b32 v49, v149
  v_mov_b32 v50, v150
  v_mov_b32 v51, v151
  v_mov_b32 v52, v152
  v_mov_b32 v53, v153
  v_mov_b32 v54, v154
  v_mov_b32 v55, v155
  v_mov_b32 v56, v156
  s_branch L_MOD
L_REP:
  s_and_b32 s74, s3, 3
  s_lshr_b32 s75, s3, 2
  s_lshl_b32 s76, s61, 2
  s_add_u32 s76, s76, s74
  s_add_u32 s85, s62, s75
  s_cmp_eq_u32 s60, 2
  s_cbranch_scc1 L_R6
  s_mul_hi_u32 s77, s76, 0x33333334
  s_mul_i32 s78, s77, 5
  s_sub_u32 s78, s76, s78
  s_add_u32 s79, s78, 4
  s_cmp_ge_u32 s79, 5
  s_cselect_b32 s80, 5, 0
  s_sub_u32 s79, s79, s80
  s_bitcmp1_b32 s77, 0
  s_cselect_b32 s78, s79, s78
  s_cmp_eq_u32 s60, 3
  s_cselect_b32 s79, 48, 20
  s_mul_i32 s77, s77, s79
  s_add_u32 s77, s77, s85
  s_mul_i32 s77, s77, 5
  s_add_u32 s77, s77, s78
  s_movk_i32 s81, 10240
  s_branch L_R7
L_R6:
  s_mul_hi_u32 s77, s76, 0x2aaaaaab
  s_mul_i32 s78, s77, 6
  s_sub_u32 s78, s76, s78
  s_mul_i32 s77, s77, 20
  s_add_u32 s77, s77, s85
  s_mul_i32 s77, s77, 6
  s_add_u32 s77, s77, s78
  s_movk_i32 s81, 12288
L_R7:
  s_lshl_b32 s77, s77, 10
  s_add_u32 s77, s77, s65
  v_lshrrev_b32 v16, 2, v2
  v_and_b32 v17, 3, v2
  v_lshl_add_u32 v18, v3, 2, v16
  v_and_b32 v19, 6, v18
  v_lshrrev_b32 v20, 1, v17
  s_lshl_b32 s70, s74, 1
  v_add_u32 v20, s70, v20
  v_xor_b32 v20, v20, v19
  v_lshlrev_b32 v18, 7, v18
  v_lshl_add_u32 v18, v20, 4, v18
  v_and_b32 v17, 1, v17
  v_lshl_add_u32 v18, v17, 3, v18
  s_lshl_b32 s70, s75, 12
  v_add_u32 v18, s70, v18
  v_mov_b32 v40, 0x3f803f80
  v_mov_b32 v41, 0x3f803f80
  v_mov_b32 v42, 0x3f803f80
  v_mov_b32 v43, 0x3f803f80
  v_mov_b32 v44, 0
  v_mov_b32 v45, 0
  v_mov_b32 v46, 0
  v_mov_b32 v47, 0
  v_mov_b32 v48, 0
  v_mov_b32 v49, 0
  v_mov_b32 v50, 0
  v_mov_b32 v51, 0
  v_add_u32 v19, 49152, v18
  s_waitcnt vmcnt(0) lgkmcnt(0)
  s_barrier
  ds_read_b64_tr_b16 v[96:97], v18 offset:0
  ds_read_b64_tr_b16 v[98:99], v18 offset:2048
  ds_read_b64_tr_b16 v[100:101], v18 offset:8192
  ds_read_b64_tr_b16 v[102:103], v18 offset:10240
  ds_read_b64_tr_b16 v[104:105], v18 offset:16384
  ds_read_b64_tr_b16 v[106:107], v18 offset:18432
  ds_read_b64_tr_b16 v[108:109], v18 offset:24576
  ds_read_b64_tr_b16 v[110:111], v18 offset:26624
  ds_read_b64_tr_b16 v[112:113], v18 offset:32768
  ds_read_b64_tr_b16 v[114:115], v18 offset:34816
  ds_read_b64_tr_b16 v[116:117], v18 offset:40960
  ds_read_b64_tr_b16 v[118:119], v18 offset:43008
  ds_read_b64_tr_b16 v[120:121], v19 offset:0
  ds_read_b64_tr_b16 v[122:123], v19 offset:2048
  ds_read_b64_tr_b16 v[124:125], v19 offset:8192
  ds_read_b64_tr_b16 v[126:127], v19 offset:10240
  ds_read_b64_tr_b16 v[128:129], v19 offset:16384
  ds_read_b64_tr_b16 v[130:131], v19 offset:18432
  ds_read_b64_tr_b16 v[132:133], v19 offset:24576
  ds_read_b64_tr_b16 v[134:135], v19 offset:26624
  s_cmp_lg_u32 s60, 0
  s_cbranch_scc1 L_R11
  s_waitcnt lgkmcnt(0)
  v_lshlrev_b32 v144, 16, v96
  v_and_b32 v145, 0xffff0000, v96
  v_lshlrev_b32 v146, 16, v97
  v_and_b32 v147, 0xffff0000, v97
  v_lshlrev_b32 v148, 16, v98
  v_and_b32 v149, 0xffff0000, v98
  v_lshlrev_b32 v150, 16, v99
  v_and_b32 v151, 0xffff0000, v99
  v_lshlrev_b32 v152, 16, v100
  v_and_b32 v153, 0xffff0000, v100
  v_lshlrev_b32 v154, 16, v101
  v_and_b32 v155, 0xffff0000, v101
  v_lshlrev_b32 v156, 16, v102
  v_and_b32 v157, 0xffff0000, v102
  v_lshlrev_b32 v158, 16, v103
  v_and_b32 v159, 0xffff0000, v103
  v_lshlrev_b32 v160, 16, v104
  v_and_b32 v161, 0xffff0000, v104
  v_lshlrev_b32 v162, 16, v105
  v_and_b32 v163, 0xffff0000, v105
  v_lshlrev_b32 v164, 16, v106
  v_and_b32 v165, 0xffff0000, v106
  v_lshlrev_b32 v166, 16, v107
  v_and_b32 v167, 0xffff0000, v107
  v_lshlrev_b32 v168, 16, v108
  v_and_b32 v169, 0xffff0000, v108
  v_lshlrev_b32 v170, 16, v109
  v_and_b32 v171, 0xffff0000, v109
  v_lshlrev_b32 v172, 16, v110
  v_and_b32 v173, 0xffff0000, v110
  v_lshlrev_b32 v174, 16, v111
  v_and_b32 v175, 0xffff0000, v111
  v_lshlrev_b32 v176, 16, v112
  v_and_b32 v177, 0xffff0000, v112
  v_lshlrev_b32 v178, 16, v113
  v_and_b32 v179, 0xffff0000, v113
  v_lshlrev_b32 v180, 16, v114
  v_and_b32 v181, 0xffff0000, v114
  v_lshlrev_b32 v182, 16, v115
  v_and_b32 v183, 0xffff0000, v115
  v_min_u32 v21, 319, v0
  v_lshlrev_b32 v22, 4, v21
  s_mov_b32 s70, 162816
  s_mov_b32 s71, 193536
  s_mov_b32 s72, 167936
  s_mov_b32 s73, 198656
  s_branch L_R8A
L_R8:
  s_mov_b64 exec, vcc
L_R8A:
  buffer_load_dwordx4 v[64:67], v22, s[44:47], s70 offen sc1
  buffer_load_dwordx4 v[68:71], v22, s[44:47], s71 offen sc1
  buffer_load_dwordx4 v[72:75], v22, s[44:47], s72 offen sc1
  buffer_load_dwordx4 v[76:79], v22, s[44:47], s73 offen sc1
  s_mov_b64 exec, -1
  s_waitcnt vmcnt(0)
  v_cmp_ne_u64 vcc, s[42:43], v[66:67]
  v_cmp_ne_u64 s[92:93], s[42:43], v[70:71]
  s_nop 0
  s_or_b64 vcc, vcc, s[92:93]
  v_cmp_ne_u64 s[92:93], s[42:43], v[74:75]
  s_nop 0
  s_or_b64 vcc, vcc, s[92:93]
  v_cmp_ne_u64 s[92:93], s[42:43], v[78:79]
  s_nop 0
  s_or_b64 vcc, vcc, s[92:93]
  s_cbranch_vccz L_R8D
  s_add_u32 s95, s95, 1
  s_cmp_gt_u32 s95, 262144
  s_cbranch_scc1 L_R8D
  s_sleep 1
  s_branch L_R8
L_R8D:
  v_add_f32 v64, v64, v68
  v_add_f32 v65, v65, v69
  v_cvt_pk_bf16_f32 v64, v64, v64
  v_and_b32 v64, 0xffff0000, v64
  v_cvt_pk_bf16_f32 v65, v65, v65
  v_and_b32 v65, 0xffff0000, v65
  v_add_f32 v72, v72, v76
  v_add_f32 v73, v73, v77
  v_cvt_pk_bf16_f32 v72, v72, v72
  v_and_b32 v72, 0xffff0000, v72
  v_cvt_pk_bf16_f32 v73, v73, v73
  v_and_b32 v73, 0xffff0000, v73
  v_add_f32 v72, 1.0, v72
  v_add_f32 v73, 1.0, v73
  v_cvt_pk_bf16_f32 v72, v72, v72
  v_and_b32 v72, 0xffff0000, v72
  v_cvt_pk_bf16_f32 v73, v73, v73
  v_and_b32 v73, 0xffff0000, v73
  v_cvt_pk_bf16_f32 v66, v64, v65
  v_lshlrev_b32 v23, 3, v21
  v_lshlrev_b32 v24, 2, v21
  v_add_u32 v25, 131072, v23
  v_add_u32 v24, 131072, v24
  ds_write_b64 v25, v[72:73] offset:4096
  ds_write_b32 v24, v66 offset:6656
  ds_write_b32 v24, v40 offset:7936
  s_cmp_lg_u32 s59, 0
  s_cbranch_scc1 L_R8E
  s_mov_b32 s70, 400896
  s_mov_b32 s71, 403456
  buffer_store_dwordx2 v[72:73], v23, s[44:47], s70 offen sc1
  buffer_store_dwordx2 v[64:65], v23, s[44:47], s71 offen sc1
L_R8E:
  s_lshl_b32 s70, s85, 7
  s_add_u32 s70, s70, 135168
  v_lshl_add_u32 v26, v3, 4, s70
  v_mov_b32 v27, 137728
  v_mov_b32 v28, 139008
  v_cmp_eq_u32 vcc, 0, v2
  s_nop 1
  v_cndmask_b32 v27, v27, v28, vcc
  v_lshl_add_u32 v27, v3, 3, v27
  s_lshl_b32 s70, s85, 6
  v_add_u32 v27, s70, v27
  s_waitcnt lgkmcnt(0)
  s_barrier
  ds_read_b128 v[184:187], v26 offset:0
  ds_read_b128 v[188:191], v26 offset:64
  ds_read_b128 v[192:195], v26 offset:256
  ds_read_b128 v[196:199], v26 offset:320
  ds_read_b128 v[200:203], v26 offset:512
  ds_read_b128 v[204:207], v26 offset:576
  ds_read_b128 v[208:211], v26 offset:768
  ds_read_b128 v[212:215], v26 offset:832
  ds_read_b128 v[216:219], v26 offset:1024
  ds_read_b128 v[220:223], v26 offset:1088
  ds_read_b64 v[116:117], v27 offset:0
  ds_read_b64 v[118:119], v27 offset:32
  ds_read_b64 v[120:121], v27 offset:128
  ds_read_b64 v[122:123], v27 offset:160
  ds_read_b64 v[124:125], v27 offset:256
  ds_read_b64 v[126:127], v27 offset:288
  ds_read_b64 v[128:129], v27 offset:384
  ds_read_b64 v[130:131], v27 offset:416
  ds_read_b64 v[132:133], v27 offset:512
  ds_read_b64 v[134:135], v27 offset:544
  s_waitcnt lgkmcnt(0)
  v_mfma_f32_16x16x32_bf16 v[48:51], v[96:99], v[116:119], v[48:51]
  v_mfma_f32_16x16x32_bf16 v[48:51], v[100:103], v[120:123], v[48:51]
  v_mfma_f32_16x16x32_bf16 v[48:51], v[104:107], v[124:127], v[48:51]
  v_mfma_f32_16x16x32_bf16 v[48:51], v[108:111], v[128:131], v[48:51]
  v_mfma_f32_16x16x32_bf16 v[48:51], v[112:115], v[132:135], v[48:51]
  v_pk_mul_f32 v[144:145], v[144:145], v[184:185]
  v_cvt_pk_bf16_f32 v96, v144, v145
  v_pk_mul_f32 v[146:147], v[146:147], v[186:187]
  v_cvt_pk_bf16_f32 v97, v146, v147
  v_pk_mul_f32 v[148:149], v[148:149], v[188:189]
  v_cvt_pk_bf16_f32 v98, v148, v149
  v_pk_mul_f32 v[150:151], v[150:151], v[190:191]
  v_cvt_pk_bf16_f32 v99, v150, v151
  v_pk_mul_f32 v[152:153], v[152:153], v[192:193]
  v_cvt_pk_bf16_f32 v100, v152, v153
  v_pk_mul_f32 v[154:155], v[154:155], v[194:195]
  v_cvt_pk_bf16_f32 v101, v154, v155
  v_pk_mul_f32 v[156:157], v[156:157], v[196:197]
  v_cvt_pk_bf16_f32 v102, v156, v157
  v_pk_mul_f32 v[158:159], v[158:159], v[198:199]
  v_cvt_pk_bf16_f32 v103, v158, v159
  v_pk_mul_f32 v[160:161], v[160:161], v[200:201]
  v_cvt_pk_bf16_f32 v104, v160, v161
  v_pk_mul_f32 v[162:163], v[162:163], v[202:203]
  v_cvt_pk_bf16_f32 v105, v162, v163
  v_pk_mul_f32 v[164:165], v[164:165], v[204:205]
  v_cvt_pk_bf16_f32 v106, v164, v165
  v_pk_mul_f32 v[166:167], v[166:167], v[206:207]
  v_cvt_pk_bf16_f32 v107, v166, v167
  v_pk_mul_f32 v[168:169], v[168:169], v[208:209]
  v_cvt_pk_bf16_f32 v108, v168, v169
  v_pk_mul_f32 v[170:171], v[170:171], v[210:211]
  v_cvt_pk_bf16_f32 v109, v170, v171
  v_pk_mul_f32 v[172:173], v[172:173], v[212:213]
  v_cvt_pk_bf16_f32 v110, v172, v173
  v_pk_mul_f32 v[174:175], v[174:175], v[214:215]
  v_cvt_pk_bf16_f32 v111, v174, v175
  v_pk_mul_f32 v[176:177], v[176:177], v[216:217]
  v_cvt_pk_bf16_f32 v112, v176, v177
  v_pk_mul_f32 v[178:179], v[178:179], v[218:219]
  v_cvt_pk_bf16_f32 v113, v178, v179
  v_pk_mul_f32 v[180:181], v[180:181], v[220:221]
  v_cvt_pk_bf16_f32 v114, v180, v181
  v_pk_mul_f32 v[182:183], v[182:183], v[222:223]
  v_cvt_pk_bf16_f32 v115, v182, v183
L_R11:
  s_waitcnt lgkmcnt(0)
  buffer_store_dwordx4 v[96:99], v249, s[44:47], s77 offen sc1
  s_add_u32 s77, s77, s81
  v_mfma_f32_16x16x32_bf16 v[44:47], v[96:99], v[40:43], v[44:47]
  buffer_store_dwordx4 v[100:103], v249, s[44:47], s77 offen sc1
  s_add_u32 s77, s77, s81
  v_mfma_f32_16x16x32_bf16 v[44:47], v[100:103], v[40:43], v[44:47]
  buffer_store_dwordx4 v[104:107], v249, s[44:47], s77 offen sc1
  s_add_u32 s77, s77, s81
  v_mfma_f32_16x16x32_bf16 v[44:47], v[104:107], v[40:43], v[44:47]
  buffer_store_dwordx4 v[108:111], v249, s[44:47], s77 offen sc1
  s_add_u32 s77, s77, s81
  v_mfma_f32_16x16x32_bf16 v[44:47], v[108:111], v[40:43], v[44:47]
  buffer_store_dwordx4 v[112:115], v249, s[44:47], s77 offen sc1
  s_add_u32 s77, s77, s81
  v_mfma_f32_16x16x32_bf16 v[44:47], v[112:115], v[40:43], v[44:47]
  s_cmp_eq_u32 s64, 5
  s_cbranch_scc1 L_R11B
  buffer_store_dwordx4 v[116:119], v249, s[44:47], s77 offen sc1
  s_add_u32 s77, s77, s81
  v_mfma_f32_16x16x32_bf16 v[44:47], v[116:119], v[40:43], v[44:47]
  buffer_store_dwordx4 v[120:123], v249, s[44:47], s77 offen sc1
  s_add_u32 s77, s77, s81
  v_mfma_f32_16x16x32_bf16 v[44:47], v[120:123], v[40:43], v[44:47]
  buffer_store_dwordx4 v[124:127], v249, s[44:47], s77 offen sc1
  s_add_u32 s77, s77, s81
  v_mfma_f32_16x16x32_bf16 v[44:47], v[124:127], v[40:43], v[44:47]
  s_cmp_eq_u32 s64, 8
  s_cbranch_scc1 L_R11B
  buffer_store_dwordx4 v[128:131], v249, s[44:47], s77 offen sc1
  s_add_u32 s77, s77, s81
  v_mfma_f32_16x16x32_bf16 v[44:47], v[128:131], v[40:43], v[44:47]
  buffer_store_dwordx4 v[132:135], v249, s[44:47], s77 offen sc1
  s_add_u32 s77, s77, s81
  v_mfma_f32_16x16x32_bf16 v[44:47], v[132:135], v[40:43], v[44:47]
L_R11B:
  s_cmp_ge_u32 s59, 20
  s_cbranch_scc1 L_R14
  s_waitcnt vmcnt(0)
  s_barrier
  s_cmp_lg_u32 s3, 5
  s_cbranch_scc1 L_R14
  s_mov_b32 s70, 1835008
  v_mul_lo_u32 v18, v1, s70
  v_mov_b32 v20, s42
  v_mov_b32 v21, s43
  s_lshl_b32 s71, s59, 7
  s_add_u32 s71, s71, 11993088
  s_mov_b64 exec, 0xff
  buffer_store_dwordx2 v[20:21], v18, s[44:47], s71 offen sc1
  s_mov_b64 exec, -1
L_R14:
  s_bitcmp1_b32 s60, 0
  s_cbranch_scc1 L_R13
  s_lshl_b32 s70, s74, 11
  s_add_u32 s70, s70, 140544
  v_add_u32 v16, s70, v249
  s_cmp_eq_u32 s75, 0
  s_cbranch_scc1 L_R12
  ds_write_b128 v16, v[44:47]
  ds_write_b128 v16, v[48:51] offset:1024
L_R12:
  s_waitcnt lgkmcnt(0)
  s_barrier
  s_cmp_lg_u32 s75, 0
  s_cbranch_scc1 L_R13
  ds_read_b128 v[56:59], v16
  ds_read_b128 v[60:63], v16 offset:1024
  s_waitcnt lgkmcnt(0)
  v_add_f32 v44, v44, v56
  v_add_f32 v45, v45, v57
  v_add_f32 v46, v46, v58
  v_add_f32 v47, v47, v59
  v_add_f32 v48, v48, v60
  v_add_f32 v49, v49, v61
  v_add_f32 v50, v50, v62
  v_add_f32 v51, v51, v63
  s_lshl_b32 s70, s76, 6
  s_cmp_lg_u32 s62, 0
  s_cselect_b32 s71, 32768, 0
  s_add_u32 s70, s70, s71
  v_lshlrev_b32 v16, 4, v3
  s_cmp_eq_u32 s60, 0
  s_mov_b32 s71, 408576
  s_cselect_b32 s71, 393216, s71
  s_add_u32 s71, s71, s70
  v_cmp_eq_u32 vcc, 0, v2
  s_nop 0
  s_mov_b64 exec, vcc
  buffer_store_dwordx4 v[44:47], v16, s[44:47], s71 offen sc1
  s_cmp_lg_u32 s60, 0
  s_cbranch_scc1 L_R12B
  s_add_u32 s71, s70, 398336
  buffer_store_dwordx4 v[48:51], v16, s[44:47], s71 offen sc1
  s_lshl_b64 exec, exec, 1
  s_add_u32 s71, s70, 395776
  buffer_store_dwordx4 v[48:51], v16, s[44:47], s71 offen sc1
L_R12B:
  s_mov_b64 exec, -1
L_R13:
  s_lshl_b32 s64, s59, 6
  s_add_u32 s64, s64, 262144
  s_waitcnt vmcnt(0)
  s_barrier
  s_cmp_lg_u32 s3, 0
  s_cbranch_scc1 LS_25
  v_mov_b32 v16, s42
  v_mov_b32 v17, s43
  s_mov_b64 exec, 1
  buffer_store_dwordx2 v[16:17], v248, s[44:47], s64 offen sc1
  s_mov_b64 exec, -1
LS_25:
L_HGB:
L_HDONE:
  s_cmp_lg_u32 s2, 247
  s_cbranch_scc1 L_G
  s_cmp_gt_u32 s3, 0
  s_cbranch_scc1 L_G
  s_mov_b32 s70, 32768
L_NR:
  buffer_load_dwordx4 v[64:67], v249, s[44:47], s70 offen offset:0 sc1
  buffer_load_dwordx4 v[68:71], v249, s[44:47], s70 offen offset:1024 sc1
  buffer_load_dwordx4 v[72:75], v249, s[44:47], s70 offen offset:2048 sc1
  buffer_load_dwordx4 v[76:79], v249, s[44:47], s70 offen offset:3072 sc1
  s_waitcnt vmcnt(0)
  v_cmp_ne_u64 vcc, s[42:43], v[66:67]
  v_cmp_ne_u64 s[92:93], s[42:43], v[70:71]
  s_nop 0
  s_or_b64 vcc, vcc, s[92:93]
  v_cmp_ne_u64 s[92:93], s[42:43], v[74:75]
  s_nop 0
  s_or_b64 vcc, vcc, s[92:93]
  v_cmp_ne_u64 s[92:93], s[42:43], v[78:79]
  s_nop 0
  s_or_b64 vcc, vcc, s[92:93]
  s_cbranch_vccz L_ND
  s_add_u32 s95, s95, 1
  s_cmp_gt_u32 s95, 262144
  s_cbranch_scc1 L_ND
  s_sleep 8
  s_branch L_NR
L_ND:
  v_mov_b32 v16, s42
  v_mov_b32 v17, s43
  s_mov_b64 exec, 1
  s_mov_b32 s70, 26214144
  buffer_store_dword v16, v248, s[44:47], 0 offen sc1
  buffer_store_dword v17, v248, s[44:47], s70 offen sc1
  s_mov_b64 exec, -1
L_G:
  s_and_b32 s8, s2, 7
  s_lshl_b32 s8, s8, 5
  s_lshr_b32 s88, s2, 3
  s_add_u32 s8, s8, s88
  s_lshr_b32 s9, s8, 3
  s_and_b32 s10, s8, 7
  s_lshr_b32 s11, s10, 2
  s_add_u32 s11, s11, 1
  s_sub_u32 s88, 0, s11
  s_bitcmp1_b32 s10, 1
  s_cselect_b32 s11, s88, s11
  s_mul_i32 s13, s10, 80
  s_and_b32 s88, s10, 1
  s_lshl_b32 s89, s88, 4
  s_add_u32 s12, s13, s89
  s_xor_b32 s89, s88, 1
  s_lshl_b32 s89, s89, 6
  s_add_u32 s13, s13, s89
  s_lshr_b32 s89, s10, 1
  s_mul_i32 s89, s89, 5
  s_mul_i32 s14, s88, 3
  s_add_u32 s14, s14, s89
  s_lshl_b32 s14, s14, 10
  s_add_u32 s89, s89, 2
  s_lshl_b32 s89, s89, 10
  s_lshl_b32 s88, s88, 3
  s_add_u32 s15, s89, s88
  s_and_b32 s16, s8, 31
  s_lshr_b32 s17, s16, 3
  s_and_b32 s19, s8, 15
  s_mul_i32 s18, s17, 72
  s_lshl_b32 s88, s9, 6
  s_sub_u32 s18, s18, s88
  s_add_u32 s18, s18, 2
  s_and_b32 s88, s2, 7
  s_mul_i32 s88, s88, 1835008
  s_add_u32 s88, s88, 10485760
  s_add_u32 s48, s40, s88
  s_addc_u32 s49, s41, 0
  s_mov_b32 s50, 1835008
  s_mov_b32 s51, 0x20000
  s_lshl_b32 s21, s3, 10
  s_mul_i32 s22, s10, 102400
  s_add_u32 s23, s22, 5242880
  s_add_u32 s22, s22, 4194304
  s_mul_i32 s24, s19, 122880
  s_add_u32 s24, s24, 6291456
  s_mul_i32 s25, s10, 245760
  s_add_u32 s25, s25, 8388608
  s_and_b32 s88, s17, 1
  s_mul_i32 s88, s88, 122880
  s_add_u32 s25, s25, s88
  s_and_b32 s26, s8, 0xe0
  s_lshl_b32 s26, s26, 4
  s_add_u32 s26, s26, 32768
  s_mov_b32 s27, 262144
  s_and_b32 s96, s96, 15
  s_sub_u32 s72, s16, 21
  v_mov_b32 v24, -1
  v_mov_b32 v25, -1
  v_mov_b32 v26, -1
  v_mov_b32 v27, -1
  s_cmp_lg_u32 s16, 20
  s_cbranch_scc1 L_GL
  s_cmp_lg_u32 s3, 7
  s_cbranch_scc1 L_GL
  s_mov_b32 s70, 268288
  v_add_u32 v72, 0, v1
  v_min_u32 v72, 159, v72
  v_lshlrev_b32 v72, 6, v72
  v_add_u32 v73, 64, v1
  v_min_u32 v73, 159, v73
  v_lshlrev_b32 v73, 6, v73
  v_add_u32 v74, 128, v1
  v_min_u32 v74, 159, v74
  v_lshlrev_b32 v74, 6, v74
LP_26:
  buffer_load_dwordx2 v[64:65], v72, s[44:47], s70 offen sc1
  buffer_load_dwordx2 v[66:67], v73, s[44:47], s70 offen sc1
  buffer_load_dwordx2 v[68:69], v74, s[44:47], s70 offen sc1
  s_waitcnt vmcnt(0)
  v_cmp_ne_u64 vcc, s[42:43], v[64:65]
  v_cmp_ne_u64 s[92:93], s[42:43], v[66:67]
  s_nop 0
  s_or_b64 vcc, vcc, s[92:93]
  v_cmp_ne_u64 s[92:93], s[42:43], v[68:69]
  s_nop 0
  s_or_b64 vcc, vcc, s[92:93]
  s_cbranch_vccz LD_27
  s_add_u32 s95, s95, 1
  s_cmp_gt_u32 s95, 262144
  s_cbranch_scc1 LD_27
  s_sleep 4
  s_branch LP_26
LD_27:
  v_and_b32 v40, 31, v1
  v_lshlrev_b32 v40, 4, v40
  v_min_u32 v41, 19, v1
  v_lshlrev_b32 v41, 6, v41
L_LD1:
  buffer_load_dwordx4 v[32:35], v40, s[44:47], s26 offen sc1
  buffer_load_dwordx2 v[36:37], v41, s[44:47], s27 offen sc1
  s_waitcnt vmcnt(0)
  v_cmp_ne_u64 vcc, s[42:43], v[34:35]
  v_cmp_ne_u64 s[92:93], s[42:43], v[36:37]
  s_nop 0
  s_or_b64 vcc, vcc, s[92:93]
  s_cbranch_vccz L_LD2
  s_add_u32 s95, s95, 1
  s_cmp_gt_u32 s95, 262144
  s_cbranch_scc1 L_LD2
  s_sleep 2
  s_branch L_LD1
L_LD2:
  v_cmp_ne_u32 vcc, s96, v32
  s_nop 0
  s_cmp_eq_u64 vcc, 0
  s_cselect_b32 s70, 1, 0
  v_mov_b32 v44, s70
  v_mov_b32 v45, 0
  v_mov_b32 v46, s42
  v_mov_b32 v47, s43
  s_mov_b32 s71, 702464
  s_mov_b64 exec, 1
  buffer_store_dwordx4 v[44:47], v248, s[48:51], s71 offen sc1
  s_mov_b64 exec, -1
L_GL:
  s_cmp_lg_u32 s3, 0
  s_cbranch_scc1 L_HW2
L_HW1:
  s_mul_i32 s66, s10, 80
  s_lshr_b32 s66, s66, 6
  s_lshl_b32 s66, s66, 8
  s_add_u32 s66, s66, 1507328
  v_and_b32 v44, 3, v1
  v_lshlrev_b32 v44, 7, v44
  buffer_load_dwordx2 v[36:37], v44, s[48:51], s66 offen sc1
  s_waitcnt vmcnt(0)
  v_cmp_ne_u64 vcc, s[42:43], v[36:37]
  s_cbranch_vccz L_HW2
  s_add_u32 s95, s95, 1
  s_cmp_gt_u32 s95, 262144
  s_cbranch_scc1 L_HW2
  s_sleep 4
  s_branch L_HW1
L_HW2:
  s_barrier
  s_add_u32 m0, s21, 0
  s_add_u32 s89, s21, s22
  s_add_u32 s89, s89, 0
  buffer_load_dwordx4 v249, s[44:47], s89 offen sc1 lds
  s_add_u32 m0, s21, 8192
  s_add_u32 s89, s21, s22
  s_add_u32 s89, s89, 8192
  buffer_load_dwordx4 v249, s[44:47], s89 offen sc1 lds
  s_add_u32 m0, s21, 16384
  s_add_u32 s89, s21, s22
  s_add_u32 s89, s89, 16384
  buffer_load_dwordx4 v249, s[44:47], s89 offen sc1 lds
  s_add_u32 m0, s21, 24576
  s_add_u32 s89, s21, s22
  s_add_u32 s89, s89, 24576
  buffer_load_dwordx4 v249, s[44:47], s89 offen sc1 lds
  s_add_u32 m0, s21, 32768
  s_add_u32 s89, s21, s22
  s_add_u32 s89, s89, 32768
  buffer_load_dwordx4 v249, s[44:47], s89 offen sc1 lds
  s_add_u32 m0, s21, 40960
  s_add_u32 s89, s21, s22
  s_add_u32 s89, s89, 40960
  buffer_load_dwordx4 v249, s[44:47], s89 offen sc1 lds
  s_add_u32 m0, s21, 49152
  s_add_u32 s89, s21, s22
  s_add_u32 s89, s89, 49152
  buffer_load_dwordx4 v249, s[44:47], s89 offen sc1 lds
  s_add_u32 m0, s21, 57344
  s_add_u32 s89, s21, s22
  s_add_u32 s89, s89, 57344
  buffer_load_dwordx4 v249, s[44:47], s89 offen sc1 lds
  s_add_u32 m0, s21, 65536
  s_add_u32 s89, s21, s22
  s_add_u32 s89, s89, 65536
  buffer_load_dwordx4 v249, s[44:47], s89 offen sc1 lds
  s_add_u32 m0, s21, 73728
  s_add_u32 s89, s21, s22
  s_add_u32 s89, s89, 73728
  buffer_load_dwordx4 v249, s[44:47], s89 offen sc1 lds
  s_add_u32 m0, s21, 81920
  s_add_u32 s89, s21, s22
  s_add_u32 s89, s89, 81920
  buffer_load_dwordx4 v249, s[44:47], s89 offen sc1 lds
  s_add_u32 m0, s21, 90112
  s_add_u32 s89, s21, s22
  s_add_u32 s89, s89, 90112
  buffer_load_dwordx4 v249, s[44:47], s89 offen sc1 lds
  s_min_u32 s87, s21, 3072
  s_add_u32 m0, s87, 98304
  s_add_u32 s89, s87, s22
  s_add_u32 s89, s89, 98304
  buffer_load_dwordx4 v249, s[44:47], s89 offen sc1 lds
  s_cmp_lg_u32 s16, 20
  s_cbranch_scc1 L_GL2
  s_cmp_lg_u32 s3, 7
  s_cbranch_scc1 L_GL2
  s_mov_b32 s70, 263424
  v_add_u32 v72, 0, v1
  v_min_u32 v72, 63, v72
  v_lshlrev_b32 v72, 6, v72
LP_28:
  buffer_load_dwordx2 v[64:65], v72, s[44:47], s70 offen sc1
  s_waitcnt vmcnt(0)
  v_cmp_ne_u64 vcc, s[42:43], v[64:65]
  s_cbranch_vccz LD_29
  s_add_u32 s95, s95, 1
  s_cmp_gt_u32 s95, 262144
  s_cbranch_scc1 LD_29
  s_sleep 2
  s_branch LP_28
LD_29:
  s_mov_b64 exec, 1
  buffer_store_dwordx2 v[46:47], v248, s[48:51], s71 offen offset:256 sc1
  s_mov_b64 exec, -1
L_GL2:
L_ERh:
  s_mov_b32 s26, 702464
  buffer_load_dwordx4 v[32:35], v248, s[48:51], s26 offen sc1
  s_waitcnt vmcnt(0)
  v_cmp_ne_u64 vcc, s[42:43], v[34:35]
  s_cbranch_vccz L_EDh
  s_add_u32 s95, s95, 1
  s_cmp_gt_u32 s95, 262144
  s_cbranch_scc1 L_EDh
  s_sleep 3
  s_branch L_ERh
L_EDh:
  v_readfirstlane_b32 s98, v32
  s_mov_b32 s71, 702720
  buffer_load_dwordx2 v[38:39], v248, s[48:51], s71 offen sc1
  s_waitcnt vmcnt(0)
L_G1H:
  v_mov_b32 v250, 0xbdd2d3e8
  v_mov_b32 v251, 0xbdd2d3e8
  v_mov_b32 v252, 0xc0135761
  v_mov_b32 v253, 0xc0135761
  s_and_b32 s72, s3, 1
  s_lshr_b32 s73, s3, 1
  s_and_b32 s74, s73, 1
  s_lshr_b32 s75, s73, 1
  s_lshl_b32 s76, s75, 5
  s_add_u32 s76, s76, s12
  v_min_u32 v4, 8, v2
  v_mul_u32_u24 v5, 21846, v4
  v_lshrrev_b32 v5, 16, v5
  v_mul_u32_u24 v13, 3, v5
  v_sub_u32 v4, v4, v13
  v_mul_u32_u24 v4, 2560, v4
  v_cmp_eq_u32 vcc, 2, v5
  v_lshl_add_u32 v5, v5, 4, s76
  v_mov_b32 v13, s13
  v_cndmask_b32 v5, v5, v13, vcc
  v_lshl_add_u32 v5, v3, 2, v5
  v_lshl_add_u32 v13, v5, 2, v4
  v_and_b32 v5, 31, v1
  v_lshlrev_b32 v6, 4, v5
  v_lshrrev_b32 v7, 2, v0
  v_bfe_u32 v40, v0, 4, 2
  v_and_b32 v41, 3, v0
  v_xor_b32 v40, v40, v41
  v_mul_u32_u24 v7, 17024, v7
  v_lshl_add_u32 v7, v40, 4, v7
  s_lshl_b32 s78, s8, 6
  s_add_u32 s78, s78, 1048704
  s_add_u32 s79, s78, 2179072
  v_subrev_u32 v40, 128, v0
  v_min_u32 v40, 159, v40
  v_mul_u32_u24 v40, 17024, v40
  s_lshl_b32 s56, s9, 9
  s_mul_i32 s77, s10, 528
  s_add_u32 s56, s56, s77
  s_add_u32 s56, s56, 1048688
  v_lshrrev_b32 v42, 5, v1
  v_bfe_u32 v11, v5, 2, 2
  s_and_b32 s94, s3, 3
  v_xor_b32 v11, s94, v11
  v_lshlrev_b32 v41, 6, v5
  v_lshl_add_u32 v41, v11, 4, v41
  v_lshl_add_u32 v41, v42, 3, v41
  v_add_u32 v41, 102400, v41
  v_lshl_add_u32 v56, v42, 3, v6
  v_add_u32 v56, 112640, v56
  s_lshl_b32 s77, s10, 3
  s_lshl_b32 s94, s94, 1
  s_add_u32 s77, s77, s94
  s_add_u32 s77, s77, 2
  s_mul_i32 s94, s17, 72
  s_add_u32 s77, s77, s94
  s_lshl_b32 s77, s77, 4
  s_add_u32 s77, s77, 688128
  s_mul_i32 s59, s10, 66
  s_add_u32 s59, s59, s94
  s_lshl_b32 s59, s59, 4
  s_add_u32 s59, s59, 688128
  v_lshlrev_b32 v42, 4, v42
  s_lshl_b32 s57, s9, 6
  s_lshl_b32 s58, s72, 5
  s_add_u32 s57, s57, s58
  s_sub_u32 s57, s57, s11
  v_mul_u32_u24 v14, 17024, v3
  v_lshl_add_u32 v14, v2, 4, v14
  s_lshl_b32 s58, s57, 3
  s_add_u32 s58, s58, 1048704
  s_mul_i32 s87, s74, 1361920
  s_add_u32 s58, s58, s87
  s_mul_i32 s87, s74, 51200
  v_add_u32 v15, s87, v249
  s_mov_b32 s35, s58
  v_lshl_add_u32 v43, v2, 1, s57
  v_add_u32 v43, s74, v43
  s_movk_i32 s94, 2048
  v_cmp_gt_u32 s[84:85], s94, v43
  v_add_lshl_u32 v43, v43, s18, 4
  s_mul_i32 s86, s72, 16384
  s_add_u32 s86, s86, 123904
  v_add_u32 v12, s86, v249
  s_lshl_b32 s28, s17, 2
  s_lshl_b32 s87, s72, 1
  s_add_u32 s28, s28, s87
  s_add_u32 s28, s28, s74
  s_mul_i32 s28, s28, 20480
  s_lshl_b32 s29, s75, 10
  s_add_u32 s29, s29, s14
  s_add_u32 s29, s29, s28
  s_add_u32 s28, s28, s15
  v_and_b32 v246, 7, v1
  v_lshlrev_b32 v246, 7, v246
  v_mov_b32 v4, s29
  v_mov_b32 v11, s28
  v_cmp_gt_u32 vcc, 8, v2
  s_nop 1
  v_cndmask_b32 v4, v11, v4, vcc
  v_add_u32 v246, v246, v4
  v_cmp_gt_u32 vcc, 16, v1
  v_add_u32 v4, 688128, v43
  s_nop 0
  v_cndmask_b32 v246, v4, v246, vcc
  s_lshr_b32 s33, s16, 4
  s_lshl_b32 s33, s33, 3
  s_add_u32 s33, s33, s3
  s_mul_i32 s33, s33, 49152
  s_mul_i32 s87, s19, 3072
  s_add_u32 s33, s33, s87
  s_add_u32 s33, s33, 720896
  s_add_u32 s86, s21, 102400
  v_add_u32 v11, s86, v249
L_G1:
  s_mov_b32 s70, 393216
  s_mov_b32 s71, 425984
  buffer_load_dwordx4 v[184:187], v13, s[44:47], s70 offen sc1
  buffer_load_dwordx4 v[188:191], v13, s[44:47], s71 offen sc1
  s_cmp_gt_u32 s3, 4
  s_cbranch_scc1 L_G1A
  s_add_u32 m0, s21, 115712
  s_add_u32 s70, s21, 400896
  buffer_load_dwordx4 v249, s[44:47], s70 offen sc1 lds
L_G1A:
  v_mov_b32 v8, v40
  v_mov_b32 v9, v41
  v_mov_b32 v10, v42
  v_mov_b32 v220, v43
  s_mov_b32 s80, s56
  s_mov_b32 s82, s58
  s_mov_b32 s83, s59
  v_cmp_ne_u64 s[56:57], s[42:43], v[38:39]
  s_cmp_lt_u32 s3, 2
  s_cselect_b32 s79, s79, s78
  s_sub_u32 s94, s3, 2
  s_cmp_lt_u32 s10, 2
  s_cselect_b32 s86, 3, 0
  s_cmp_lt_u32 s94, s86
  s_cselect_b32 s79, s80, s79
  s_cselect_b64 vcc, -1, 0
  v_cndmask_b32 v8, v7, v8, vcc
  buffer_load_dwordx4 v[96:99], v7, s[44:47], s78 offen sc1
  s_cmp_eq_u32 s79, s78
  s_cbranch_scc1 L_S1
  buffer_load_dwordx4 v[100:103], v8, s[44:47], s79 offen sc1
  s_waitcnt vmcnt(0)
LC_30:
  v_max3_u32 v223, v96, v97, v98
  v_max3_u32 v223, v223, v99, v100
  v_max3_u32 v223, v223, v101, v102
  v_max_u32 v223, v223, v103
  v_cmp_eq_u32 vcc, -1, v223
  s_cbranch_vccnz LR_31
LK_32:
  ds_write_b128 v11, v[100:103] offset:8192
  s_branch L_S2
L_S1:
  s_waitcnt vmcnt(0)
LC_33:
  v_max3_u32 v223, v96, v97, v98
  v_max_u32 v223, v223, v99
  v_cmp_eq_u32 vcc, -1, v223
  s_cbranch_vccnz LR_34
LK_35:
L_S2:
  ds_write_b128 v11, v[96:99]
  v_pk_add_f32 v[184:185], v[184:185], v[188:189]
  v_pk_add_f32 v[186:187], v[186:187], v[190:191]
  v_mov_b32 v222, 121856
  ds_write_b32 v222, v248
  v_add_u32 v13, 115712, v6
  s_mov_b32 s70, 688128
  s_waitcnt lgkmcnt(0)
  s_barrier
  s_cmp_lt_u32 s3, 4
  s_cbranch_scc1 L_S4
  s_setprio 1
  buffer_load_dword v247, v246, s[48:51], 0 offen sc1
  ds_read_b64 v[224:225], v9 offset:0
  ds_read_b64 v[226:227], v9 offset:2048
  ds_read_b64 v[228:229], v9 offset:4096
  ds_read_b64 v[230:231], v9 offset:6144
  ds_read_b64 v[232:233], v9 offset:8192
  ds_read_b128 v[16:19], v13 offset:0
  ds_read_b128 v[36:39], v13 offset:2560
  ds_read_b128 v[20:23], v13 offset:512
  ds_read_b128 v[40:43], v13 offset:3072
  ds_read_b128 v[24:27], v13 offset:1024
  ds_read_b128 v[44:47], v13 offset:3584
  ds_read_b128 v[28:31], v13 offset:1536
  ds_read_b128 v[48:51], v13 offset:4096
  ds_read_b128 v[32:35], v13 offset:2048
  ds_read_b128 v[52:55], v13 offset:4608
L_S3:
  s_waitcnt lgkmcnt(0)
  v_and_b32 v243, 0xffff0000, v233
  v_lshlrev_b32 v242, 16, v233
  v_and_b32 v241, 0xffff0000, v232
  v_lshlrev_b32 v240, 16, v232
  v_and_b32 v239, 0xffff0000, v231
  v_lshlrev_b32 v238, 16, v231
  v_and_b32 v237, 0xffff0000, v230
  v_lshlrev_b32 v236, 16, v230
  v_and_b32 v235, 0xffff0000, v229
  v_lshlrev_b32 v234, 16, v229
  v_and_b32 v233, 0xffff0000, v228
  v_lshlrev_b32 v232, 16, v228
  v_and_b32 v231, 0xffff0000, v227
  v_lshlrev_b32 v230, 16, v227
  v_and_b32 v229, 0xffff0000, v226
  v_lshlrev_b32 v228, 16, v226
  v_and_b32 v227, 0xffff0000, v225
  v_lshlrev_b32 v226, 16, v225
  v_and_b32 v225, 0xffff0000, v224
  v_lshlrev_b32 v224, 16, v224
  v_pk_mul_f32 v[4:5], v[224:225], v[224:225]
  v_pk_add_f32 v[60:61], v[224:225], v[226:227]
  v_pk_fma_f32 v[4:5], v[226:227], v[226:227], v[4:5]
  v_pk_add_f32 v[60:61], v[60:61], v[228:229]
  v_pk_fma_f32 v[4:5], v[228:229], v[228:229], v[4:5]
  v_pk_add_f32 v[60:61], v[60:61], v[230:231]
  v_pk_fma_f32 v[4:5], v[230:231], v[230:231], v[4:5]
  v_pk_add_f32 v[60:61], v[60:61], v[232:233]
  v_pk_fma_f32 v[4:5], v[232:233], v[232:233], v[4:5]
  v_pk_add_f32 v[60:61], v[60:61], v[234:235]
  v_pk_fma_f32 v[4:5], v[234:235], v[234:235], v[4:5]
  v_pk_add_f32 v[60:61], v[60:61], v[236:237]
  v_pk_fma_f32 v[4:5], v[236:237], v[236:237], v[4:5]
  v_pk_add_f32 v[60:61], v[60:61], v[238:239]
  v_pk_fma_f32 v[4:5], v[238:239], v[238:239], v[4:5]
  v_pk_add_f32 v[60:61], v[60:61], v[240:241]
  v_pk_fma_f32 v[4:5], v[240:241], v[240:241], v[4:5]
  v_pk_add_f32 v[60:61], v[60:61], v[242:243]
  v_pk_fma_f32 v[4:5], v[242:243], v[242:243], v[4:5]
  v_add_f32 v60, v60, v61
  v_add_f32 v61, v4, v5
  s_nop 0
  v_add_f32_dpp v60, v60, v60 quad_perm:[1,0,3,2] row_mask:0xf bank_mask:0xf
  v_add_f32_dpp v61, v61, v61 quad_perm:[1,0,3,2] row_mask:0xf bank_mask:0xf
  s_nop 0
  v_add_f32_dpp v60, v60, v60 quad_perm:[2,3,0,1] row_mask:0xf bank_mask:0xf
  v_add_f32_dpp v61, v61, v61 quad_perm:[2,3,0,1] row_mask:0xf bank_mask:0xf
  s_nop 0
  v_add_f32_dpp v60, v60, v60 row_half_mirror row_mask:0xf bank_mask:0xf
  v_add_f32_dpp v61, v61, v61 row_half_mirror row_mask:0xf bank_mask:0xf
  s_nop 0
  v_add_f32_dpp v60, v60, v60 row_mirror row_mask:0xf bank_mask:0xf
  v_add_f32_dpp v61, v61, v61 row_mirror row_mask:0xf bank_mask:0xf
  v_mov_b32 v4, v60
  v_mov_b32 v5, v61
  s_nop 0
  v_permlane16_swap_b32 v60, v4
  v_permlane16_swap_b32 v61, v5
  v_add_f32 v60, v60, v4
  v_add_f32 v61, v61, v5
  v_mul_f32 v60, 0x3acccccd, v60
  v_mul_f32 v61, 0x3acccccd, v61
  v_fma_f32 v61, -v60, v60, v61
  v_max_f32 v61, 0, v61
  v_cvt_pk_bf16_f32 v61, v61, v61
  v_and_b32 v61, 0xffff0000, v61
  v_add_f32 v61, 0x3727c5ac, v61
  v_cvt_pk_bf16_f32 v61, v61, v61
  v_and_b32 v61, 0xffff0000, v61
  v_sqrt_f32 v61, v61
  s_nop 0
  v_cvt_pk_bf16_f32 v61, v61, v61
  v_and_b32 v61, 0xffff0000, v61
  v_cvt_pk_bf16_f32 v60, v60, v60
  v_and_b32 v60, 0xffff0000, v60
  v_rcp_f32 v6, v61
  s_nop 0
  v_mul_f32 v8, v60, v6
  v_pk_fma_f32 v[224:225], v[224:225], v[6:7], v[8:9] op_sel_hi:[1,0,0] neg_lo:[0,0,1] neg_hi:[0,0,1]
  v_pk_fma_f32 v[226:227], v[226:227], v[6:7], v[8:9] op_sel_hi:[1,0,0] neg_lo:[0,0,1] neg_hi:[0,0,1]
  v_pk_fma_f32 v[228:229], v[228:229], v[6:7], v[8:9] op_sel_hi:[1,0,0] neg_lo:[0,0,1] neg_hi:[0,0,1]
  v_pk_fma_f32 v[230:231], v[230:231], v[6:7], v[8:9] op_sel_hi:[1,0,0] neg_lo:[0,0,1] neg_hi:[0,0,1]
  v_pk_fma_f32 v[232:233], v[232:233], v[6:7], v[8:9] op_sel_hi:[1,0,0] neg_lo:[0,0,1] neg_hi:[0,0,1]
  v_pk_fma_f32 v[234:235], v[234:235], v[6:7], v[8:9] op_sel_hi:[1,0,0] neg_lo:[0,0,1] neg_hi:[0,0,1]
  v_pk_fma_f32 v[236:237], v[236:237], v[6:7], v[8:9] op_sel_hi:[1,0,0] neg_lo:[0,0,1] neg_hi:[0,0,1]
  v_pk_fma_f32 v[238:239], v[238:239], v[6:7], v[8:9] op_sel_hi:[1,0,0] neg_lo:[0,0,1] neg_hi:[0,0,1]
  v_pk_fma_f32 v[240:241], v[240:241], v[6:7], v[8:9] op_sel_hi:[1,0,0] neg_lo:[0,0,1] neg_hi:[0,0,1]
  v_pk_fma_f32 v[242:243], v[242:243], v[6:7], v[8:9] op_sel_hi:[1,0,0] neg_lo:[0,0,1] neg_hi:[0,0,1]
  v_pk_fma_f32 v[224:225], v[224:225], v[16:17], v[36:37]
  v_pk_fma_f32 v[226:227], v[226:227], v[18:19], v[38:39]
  v_pk_fma_f32 v[228:229], v[228:229], v[20:21], v[40:41]
  v_pk_fma_f32 v[230:231], v[230:231], v[22:23], v[42:43]
  v_pk_fma_f32 v[232:233], v[232:233], v[24:25], v[44:45]
  v_pk_fma_f32 v[234:235], v[234:235], v[26:27], v[46:47]
  v_pk_fma_f32 v[236:237], v[236:237], v[28:29], v[48:49]
  v_pk_fma_f32 v[238:239], v[238:239], v[30:31], v[50:51]
  v_pk_fma_f32 v[240:241], v[240:241], v[32:33], v[52:53]
  v_pk_fma_f32 v[242:243], v[242:243], v[34:35], v[54:55]
  v_pk_mul_f32 v[4:5], v[224:225], v[224:225]
  v_pk_add_f32 v[62:63], v[224:225], v[226:227]
  v_pk_fma_f32 v[4:5], v[226:227], v[226:227], v[4:5]
  v_pk_add_f32 v[62:63], v[62:63], v[228:229]
  v_pk_fma_f32 v[4:5], v[228:229], v[228:229], v[4:5]
  v_pk_add_f32 v[62:63], v[62:63], v[230:231]
  v_pk_fma_f32 v[4:5], v[230:231], v[230:231], v[4:5]
  v_pk_add_f32 v[62:63], v[62:63], v[232:233]
  v_pk_fma_f32 v[4:5], v[232:233], v[232:233], v[4:5]
  v_pk_add_f32 v[62:63], v[62:63], v[234:235]
  v_pk_fma_f32 v[4:5], v[234:235], v[234:235], v[4:5]
  v_pk_add_f32 v[62:63], v[62:63], v[236:237]
  v_pk_fma_f32 v[4:5], v[236:237], v[236:237], v[4:5]
  v_pk_add_f32 v[62:63], v[62:63], v[238:239]
  v_pk_fma_f32 v[4:5], v[238:239], v[238:239], v[4:5]
  v_pk_add_f32 v[62:63], v[62:63], v[240:241]
  v_pk_fma_f32 v[4:5], v[240:241], v[240:241], v[4:5]
  v_pk_add_f32 v[62:63], v[62:63], v[242:243]
  v_pk_fma_f32 v[4:5], v[242:243], v[242:243], v[4:5]
  v_add_f32 v62, v62, v63
  v_add_f32 v63, v4, v5
  s_nop 0
  v_add_f32_dpp v62, v62, v62 quad_perm:[1,0,3,2] row_mask:0xf bank_mask:0xf
  v_add_f32_dpp v63, v63, v63 quad_perm:[1,0,3,2] row_mask:0xf bank_mask:0xf
  s_nop 0
  v_add_f32_dpp v62, v62, v62 quad_perm:[2,3,0,1] row_mask:0xf bank_mask:0xf
  v_add_f32_dpp v63, v63, v63 quad_perm:[2,3,0,1] row_mask:0xf bank_mask:0xf
  s_nop 0
  v_add_f32_dpp v62, v62, v62 row_half_mirror row_mask:0xf bank_mask:0xf
  v_add_f32_dpp v63, v63, v63 row_half_mirror row_mask:0xf bank_mask:0xf
  s_nop 0
  v_add_f32_dpp v62, v62, v62 row_mirror row_mask:0xf bank_mask:0xf
  v_add_f32_dpp v63, v63, v63 row_mirror row_mask:0xf bank_mask:0xf
  v_mov_b32 v4, v62
  v_mov_b32 v5, v63
  s_nop 0
  v_permlane16_swap_b32 v62, v4
  v_permlane16_swap_b32 v63, v5
  v_add_f32 v62, v62, v4
  v_add_f32 v63, v63, v5
  v_mul_f32 v62, 0x3acccccd, v62
  v_mul_f32 v63, 0x3acccccd, v63
  v_fma_f32 v63, -v62, v62, v63
  v_max_f32 v63, 0, v63
  v_cvt_pk_bf16_f32 v63, v63, v63
  v_and_b32 v63, 0xffff0000, v63
  v_add_f32 v63, 0x3727c5ac, v63
  v_cvt_pk_bf16_f32 v63, v63, v63
  v_and_b32 v63, 0xffff0000, v63
  v_sqrt_f32 v63, v63
  s_nop 0
  v_cvt_pk_bf16_f32 v63, v63, v63
  v_and_b32 v63, 0xffff0000, v63
  v_cvt_pk_bf16_f32 v60, v60, v61
  v_cvt_pk_bf16_f32 v61, v62, v63
  v_mov_b32 v62, s42
  v_mov_b32 v63, s43
  s_mov_b32 exec_lo, 1
  s_mov_b32 exec_hi, 1
  s_cmp_eq_u32 s98, 0
  s_cbranch_scc1 LQ_36
  buffer_store_dwordx4 v[60:63], v10, s[48:51], s77 offen
  s_branch LQ_37
LQ_36:
  buffer_store_dwordx4 v[60:63], v10, s[48:51], s77 offen sc1
LQ_37:
  s_mov_b64 exec, -1
  s_cmp_lg_u32 s3, 7
  s_cbranch_scc1 L_S5
  s_cmp_gt_u32 s10, 1
  s_cbranch_scc1 L_S5
  s_cmp_eq_u32 s77, s83
  s_cbranch_scc1 L_S5
  s_mov_b32 s77, s83
  ds_read_b64 v[224:225], v56 offset:0
  ds_read_b64 v[226:227], v56 offset:512
  ds_read_b64 v[228:229], v56 offset:1024
  ds_read_b64 v[230:231], v56 offset:1536
  ds_read_b64 v[232:233], v56 offset:2048
  s_branch L_S3
L_S4:
  buffer_load_dwordx4 v[16:19], v14, s[44:47], s82 offen sc1
  s_add_u32 s82, s82, 68096
  buffer_load_dwordx4 v[20:23], v14, s[44:47], s82 offen sc1
  s_add_u32 s82, s82, 68096
  buffer_load_dwordx4 v[24:27], v14, s[44:47], s82 offen sc1
  s_add_u32 s82, s82, 68096
  buffer_load_dwordx4 v[28:31], v14, s[44:47], s82 offen sc1
  s_add_u32 s82, s82, 68096
  buffer_load_dwordx4 v[32:35], v14, s[44:47], s82 offen sc1
  s_add_u32 s82, s82, 68096
  buffer_load_dwordx4 v[36:39], v14, s[44:47], s82 offen sc1
  s_add_u32 s82, s82, 68096
  buffer_load_dwordx4 v[40:43], v14, s[44:47], s82 offen sc1
  s_add_u32 s82, s82, 68096
  buffer_load_dwordx4 v[44:47], v14, s[44:47], s82 offen sc1
  s_add_u32 s82, s82, 68096
  buffer_load_dwordx4 v[48:51], v14, s[44:47], s82 offen sc1
  s_add_u32 s82, s82, 68096
  buffer_load_dwordx4 v[52:55], v14, s[44:47], s82 offen sc1
  s_add_u32 s82, s82, 68096
  ds_read_b128 v[144:147], v15 offset:0
  ds_read_b128 v[148:151], v15 offset:1024
  ds_read_b128 v[152:155], v15 offset:2048
  ds_read_b128 v[156:159], v15 offset:3072
  ds_read_b128 v[160:163], v15 offset:4096
  s_waitcnt vmcnt(8)
LC_38:
  v_max3_u32 v223, v16, v17, v18
  v_max3_u32 v223, v223, v19, v20
  v_max3_u32 v223, v223, v21, v22
  v_max_u32 v223, v223, v23
  v_cmp_eq_u32 vcc, -1, v223
  s_cbranch_vccnz LR_39
LK_40:
  v_swap_b32 v18, v20
  v_swap_b32 v19, v21
  buffer_load_dwordx4 v[56:59], v14, s[44:47], s82 offen sc1
  s_add_u32 s82, s82, 68096
  buffer_load_dwordx4 v[60:63], v14, s[44:47], s82 offen sc1
  s_add_u32 s82, s82, 68096
  s_waitcnt lgkmcnt(0)
  s_nop 1
  v_mfma_f32_16x16x32_bf16 v[104:107], v[144:147], v[16:19], 0
  ds_read_b128 v[164:167], v15 offset:5120
  v_mfma_f32_16x16x32_bf16 v[108:111], v[144:147], v[20:23], 0
  ds_read_b128 v[168:171], v15 offset:6144
  v_mfma_f32_16x16x32_bf16 v[112:115], v[148:151], v[16:19], 0
  ds_read_b128 v[172:175], v15 offset:7168
  v_mfma_f32_16x16x32_bf16 v[116:119], v[148:151], v[20:23], 0
  ds_read_b128 v[176:179], v15 offset:8192
  v_mfma_f32_16x16x32_bf16 v[120:123], v[152:155], v[16:19], 0
  ds_read_b128 v[180:183], v15 offset:9216
  v_mfma_f32_16x16x32_bf16 v[124:127], v[152:155], v[20:23], 0
  s_waitcnt vmcnt(8)
LC_41:
  v_max3_u32 v223, v24, v25, v26
  v_max3_u32 v223, v223, v27, v28
  v_max3_u32 v223, v223, v29, v30
  v_max_u32 v223, v223, v31
  v_cmp_eq_u32 vcc, -1, v223
  s_cbranch_vccnz LR_42
LK_43:
  v_mfma_f32_16x16x32_bf16 v[128:131], v[156:159], v[16:19], 0
  v_swap_b32 v26, v28
  v_mfma_f32_16x16x32_bf16 v[132:135], v[156:159], v[20:23], 0
  v_swap_b32 v27, v29
  v_mfma_f32_16x16x32_bf16 v[136:139], v[160:163], v[16:19], 0
  v_mfma_f32_16x16x32_bf16 v[140:143], v[160:163], v[20:23], 0
  buffer_load_dwordx4 v[64:67], v14, s[44:47], s82 offen sc1
  s_add_u32 s82, s82, 68096
  buffer_load_dwordx4 v[68:71], v14, s[44:47], s82 offen sc1
  s_add_u32 s82, s82, 68096
  s_waitcnt lgkmcnt(0)
  s_nop 1
  v_mfma_f32_16x16x32_bf16 v[104:107], v[164:167], v[24:27], v[104:107]
  ds_read_b128 v[144:147], v15 offset:10240
  v_mfma_f32_16x16x32_bf16 v[108:111], v[164:167], v[28:31], v[108:111]
  ds_read_b128 v[148:151], v15 offset:11264
  v_mfma_f32_16x16x32_bf16 v[112:115], v[168:171], v[24:27], v[112:115]
  ds_read_b128 v[152:155], v15 offset:12288
  v_mfma_f32_16x16x32_bf16 v[116:119], v[168:171], v[28:31], v[116:119]
  ds_read_b128 v[156:159], v15 offset:13312
  v_mfma_f32_16x16x32_bf16 v[120:123], v[172:175], v[24:27], v[120:123]
  ds_read_b128 v[160:163], v15 offset:14336
  v_mfma_f32_16x16x32_bf16 v[124:127], v[172:175], v[28:31], v[124:127]
  s_waitcnt vmcnt(8)
LC_44:
  v_max3_u32 v223, v32, v33, v34
  v_max3_u32 v223, v223, v35, v36
  v_max3_u32 v223, v223, v37, v38
  v_max_u32 v223, v223, v39
  v_cmp_eq_u32 vcc, -1, v223
  s_cbranch_vccnz LR_45
LK_46:
  v_mfma_f32_16x16x32_bf16 v[128:131], v[176:179], v[24:27], v[128:131]
  v_swap_b32 v34, v36
  v_mfma_f32_16x16x32_bf16 v[132:135], v[176:179], v[28:31], v[132:135]
  v_swap_b32 v35, v37
  v_mfma_f32_16x16x32_bf16 v[136:139], v[180:183], v[24:27], v[136:139]
  v_mfma_f32_16x16x32_bf16 v[140:143], v[180:183], v[28:31], v[140:143]
  buffer_load_dwordx4 v[72:75], v14, s[44:47], s82 offen sc1
  s_add_u32 s82, s82, 68096
  buffer_load_dwordx4 v[76:79], v14, s[44:47], s82 offen sc1
  s_add_u32 s82, s82, 68096
  s_waitcnt lgkmcnt(0)
  s_nop 1
  v_mfma_f32_16x16x32_bf16 v[104:107], v[144:147], v[32:35], v[104:107]
  ds_read_b128 v[164:167], v15 offset:15360
  v_mfma_f32_16x16x32_bf16 v[108:111], v[144:147], v[36:39], v[108:111]
  ds_read_b128 v[168:171], v15 offset:16384
  v_mfma_f32_16x16x32_bf16 v[112:115], v[148:151], v[32:35], v[112:115]
  ds_read_b128 v[172:175], v15 offset:17408
  v_mfma_f32_16x16x32_bf16 v[116:119], v[148:151], v[36:39], v[116:119]
  ds_read_b128 v[176:179], v15 offset:18432
  v_mfma_f32_16x16x32_bf16 v[120:123], v[152:155], v[32:35], v[120:123]
  ds_read_b128 v[180:183], v15 offset:19456
  v_mfma_f32_16x16x32_bf16 v[124:127], v[152:155], v[36:39], v[124:127]
  s_waitcnt vmcnt(8)
LC_47:
  v_max3_u32 v223, v40, v41, v42
  v_max3_u32 v223, v223, v43, v44
  v_max3_u32 v223, v223, v45, v46
  v_max_u32 v223, v223, v47
  v_cmp_eq_u32 vcc, -1, v223
  s_cbranch_vccnz LR_48
LK_49:
  v_mfma_f32_16x16x32_bf16 v[128:131], v[156:159], v[32:35], v[128:131]
  v_swap_b32 v42, v44
  v_mfma_f32_16x16x32_bf16 v[132:135], v[156:159], v[36:39], v[132:135]
  v_swap_b32 v43, v45
  v_mfma_f32_16x16x32_bf16 v[136:139], v[160:163], v[32:35], v[136:139]
  v_mfma_f32_16x16x32_bf16 v[140:143], v[160:163], v[36:39], v[140:143]
  buffer_load_dwordx4 v[80:83], v14, s[44:47], s82 offen sc1
  s_add_u32 s82, s82, 68096
  buffer_load_dwordx4 v[84:87], v14, s[44:47], s82 offen sc1
  s_add_u32 s82, s82, 68096
  s_waitcnt lgkmcnt(0)
  s_nop 1
  v_mfma_f32_16x16x32_bf16 v[104:107], v[164:167], v[40:43], v[104:107]
  ds_read_b128 v[144:147], v15 offset:20480
  v_mfma_f32_16x16x32_bf16 v[108:111], v[164:167], v[44:47], v[108:111]
  ds_read_b128 v[148:151], v15 offset:21504
  v_mfma_f32_16x16x32_bf16 v[112:115], v[168:171], v[40:43], v[112:115]
  ds_read_b128 v[152:155], v15 offset:22528
  v_mfma_f32_16x16x32_bf16 v[116:119], v[168:171], v[44:47], v[116:119]
  ds_read_b128 v[156:159], v15 offset:23552
  v_mfma_f32_16x16x32_bf16 v[120:123], v[172:175], v[40:43], v[120:123]
  ds_read_b128 v[160:163], v15 offset:24576
  v_mfma_f32_16x16x32_bf16 v[124:127], v[172:175], v[44:47], v[124:127]
  s_waitcnt vmcnt(8)
LC_50:
  v_max3_u32 v223, v48, v49, v50
  v_max3_u32 v223, v223, v51, v52
  v_max3_u32 v223, v223, v53, v54
  v_max_u32 v223, v223, v55
  v_cmp_eq_u32 vcc, -1, v223
  s_cbranch_vccnz LR_51
LK_52:
  v_mfma_f32_16x16x32_bf16 v[128:131], v[176:179], v[40:43], v[128:131]
  v_swap_b32 v50, v52
  v_mfma_f32_16x16x32_bf16 v[132:135], v[176:179], v[44:47], v[132:135]
  v_swap_b32 v51, v53
  v_mfma_f32_16x16x32_bf16 v[136:139], v[180:183], v[40:43], v[136:139]
  v_mfma_f32_16x16x32_bf16 v[140:143], v[180:183], v[44:47], v[140:143]
  buffer_load_dwordx4 v[88:91], v14, s[44:47], s82 offen sc1
  s_add_u32 s82, s82, 68096
  buffer_load_dwordx4 v[92:95], v14, s[44:47], s82 offen sc1
  s_waitcnt lgkmcnt(0)
  v_mov_b32 v4, 1
  s_mov_b64 exec, 1
  ds_add_u32 v222, v4
  s_mov_b64 exec, -1
  s_nop 0
  v_mfma_f32_16x16x32_bf16 v[104:107], v[144:147], v[48:51], v[104:107]
  ds_read_b128 v[164:167], v15 offset:25600
  v_mfma_f32_16x16x32_bf16 v[108:111], v[144:147], v[52:55], v[108:111]
  ds_read_b128 v[168:171], v15 offset:26624
  v_mfma_f32_16x16x32_bf16 v[112:115], v[148:151], v[48:51], v[112:115]
  ds_read_b128 v[172:175], v15 offset:27648
  v_mfma_f32_16x16x32_bf16 v[116:119], v[148:151], v[52:55], v[116:119]
  ds_read_b128 v[176:179], v15 offset:28672
  v_mfma_f32_16x16x32_bf16 v[120:123], v[152:155], v[48:51], v[120:123]
  ds_read_b128 v[180:183], v15 offset:29696
  v_mfma_f32_16x16x32_bf16 v[124:127], v[152:155], v[52:55], v[124:127]
  s_waitcnt vmcnt(8)
LC_53:
  v_max3_u32 v223, v56, v57, v58
  v_max3_u32 v223, v223, v59, v60
  v_max3_u32 v223, v223, v61, v62
  v_max_u32 v223, v223, v63
  v_cmp_eq_u32 vcc, -1, v223
  s_cbranch_vccnz LR_54
LK_55:
  v_mfma_f32_16x16x32_bf16 v[128:131], v[156:159], v[48:51], v[128:131]
  v_swap_b32 v58, v60
  v_mfma_f32_16x16x32_bf16 v[132:135], v[156:159], v[52:55], v[132:135]
  v_swap_b32 v59, v61
  v_mfma_f32_16x16x32_bf16 v[136:139], v[160:163], v[48:51], v[136:139]
  v_mfma_f32_16x16x32_bf16 v[140:143], v[160:163], v[52:55], v[140:143]
  buffer_load_dword v247, v246, s[48:51], 0 offen sc1
  s_waitcnt lgkmcnt(0)
  s_nop 1
  v_mfma_f32_16x16x32_bf16 v[104:107], v[164:167], v[56:59], v[104:107]
  ds_read_b128 v[144:147], v15 offset:30720
  v_mfma_f32_16x16x32_bf16 v[108:111], v[164:167], v[60:63], v[108:111]
  ds_read_b128 v[148:151], v15 offset:31744
  v_mfma_f32_16x16x32_bf16 v[112:115], v[168:171], v[56:59], v[112:115]
  ds_read_b128 v[152:155], v15 offset:32768
  v_mfma_f32_16x16x32_bf16 v[116:119], v[168:171], v[60:63], v[116:119]
  ds_read_b128 v[156:159], v15 offset:33792
  v_mfma_f32_16x16x32_bf16 v[120:123], v[172:175], v[56:59], v[120:123]
  ds_read_b128 v[160:163], v15 offset:34816
  v_mfma_f32_16x16x32_bf16 v[124:127], v[172:175], v[60:63], v[124:127]
  s_waitcnt vmcnt(7)
LC_56:
  v_max3_u32 v223, v64, v65, v66
  v_max3_u32 v223, v223, v67, v68
  v_max3_u32 v223, v223, v69, v70
  v_max_u32 v223, v223, v71
  v_cmp_eq_u32 vcc, -1, v223
  s_cbranch_vccnz LR_57
LK_58:
  v_mfma_f32_16x16x32_bf16 v[128:131], v[176:179], v[56:59], v[128:131]
  v_swap_b32 v66, v68
  v_mfma_f32_16x16x32_bf16 v[132:135], v[176:179], v[60:63], v[132:135]
  v_swap_b32 v67, v69
  v_mfma_f32_16x16x32_bf16 v[136:139], v[180:183], v[56:59], v[136:139]
  v_mfma_f32_16x16x32_bf16 v[140:143], v[180:183], v[60:63], v[140:143]
  s_waitcnt lgkmcnt(0)
  s_nop 1
  v_mfma_f32_16x16x32_bf16 v[104:107], v[144:147], v[64:67], v[104:107]
  ds_read_b128 v[164:167], v15 offset:35840
  v_mfma_f32_16x16x32_bf16 v[108:111], v[144:147], v[68:71], v[108:111]
  ds_read_b128 v[168:171], v15 offset:36864
  v_mfma_f32_16x16x32_bf16 v[112:115], v[148:151], v[64:67], v[112:115]
  ds_read_b128 v[172:175], v15 offset:37888
  v_mfma_f32_16x16x32_bf16 v[116:119], v[148:151], v[68:71], v[116:119]
  ds_read_b128 v[176:179], v15 offset:38912
  v_mfma_f32_16x16x32_bf16 v[120:123], v[152:155], v[64:67], v[120:123]
  ds_read_b128 v[180:183], v15 offset:39936
  v_mfma_f32_16x16x32_bf16 v[124:127], v[152:155], v[68:71], v[124:127]
  s_waitcnt vmcnt(5)
LC_59:
  v_max3_u32 v223, v72, v73, v74
  v_max3_u32 v223, v223, v75, v76
  v_max3_u32 v223, v223, v77, v78
  v_max_u32 v223, v223, v79
  v_cmp_eq_u32 vcc, -1, v223
  s_cbranch_vccnz LR_60
LK_61:
  v_mfma_f32_16x16x32_bf16 v[128:131], v[156:159], v[64:67], v[128:131]
  v_swap_b32 v74, v76
  v_mfma_f32_16x16x32_bf16 v[132:135], v[156:159], v[68:71], v[132:135]
  v_swap_b32 v75, v77
  v_mfma_f32_16x16x32_bf16 v[136:139], v[160:163], v[64:67], v[136:139]
  v_mfma_f32_16x16x32_bf16 v[140:143], v[160:163], v[68:71], v[140:143]
  s_waitcnt lgkmcnt(0)
  s_nop 1
  v_mfma_f32_16x16x32_bf16 v[104:107], v[164:167], v[72:75], v[104:107]
  ds_read_b128 v[144:147], v15 offset:40960
  v_mfma_f32_16x16x32_bf16 v[108:111], v[164:167], v[76:79], v[108:111]
  ds_read_b128 v[148:151], v15 offset:41984
  v_mfma_f32_16x16x32_bf16 v[112:115], v[168:171], v[72:75], v[112:115]
  ds_read_b128 v[152:155], v15 offset:43008
  v_mfma_f32_16x16x32_bf16 v[116:119], v[168:171], v[76:79], v[116:119]
  ds_read_b128 v[156:159], v15 offset:44032
  v_mfma_f32_16x16x32_bf16 v[120:123], v[172:175], v[72:75], v[120:123]
  ds_read_b128 v[160:163], v15 offset:45056
  v_mfma_f32_16x16x32_bf16 v[124:127], v[172:175], v[76:79], v[124:127]
  s_waitcnt vmcnt(3)
LC_62:
  v_max3_u32 v223, v80, v81, v82
  v_max3_u32 v223, v223, v83, v84
  v_max3_u32 v223, v223, v85, v86
  v_max_u32 v223, v223, v87
  v_cmp_eq_u32 vcc, -1, v223
  s_cbranch_vccnz LR_63
LK_64:
  v_mfma_f32_16x16x32_bf16 v[128:131], v[176:179], v[72:75], v[128:131]
  v_swap_b32 v82, v84
  v_mfma_f32_16x16x32_bf16 v[132:135], v[176:179], v[76:79], v[132:135]
  v_swap_b32 v83, v85
  v_mfma_f32_16x16x32_bf16 v[136:139], v[180:183], v[72:75], v[136:139]
  v_mfma_f32_16x16x32_bf16 v[140:143], v[180:183], v[76:79], v[140:143]
  s_waitcnt lgkmcnt(0)
  s_nop 1
  v_mfma_f32_16x16x32_bf16 v[104:107], v[144:147], v[80:83], v[104:107]
  ds_read_b128 v[164:167], v15 offset:46080
  v_mfma_f32_16x16x32_bf16 v[108:111], v[144:147], v[84:87], v[108:111]
  ds_read_b128 v[168:171], v15 offset:47104
  v_mfma_f32_16x16x32_bf16 v[112:115], v[148:151], v[80:83], v[112:115]
  ds_read_b128 v[172:175], v15 offset:48128
  v_mfma_f32_16x16x32_bf16 v[116:119], v[148:151], v[84:87], v[116:119]
  ds_read_b128 v[176:179], v15 offset:49152
  v_mfma_f32_16x16x32_bf16 v[120:123], v[152:155], v[80:83], v[120:123]
  ds_read_b128 v[180:183], v15 offset:50176
  v_mfma_f32_16x16x32_bf16 v[124:127], v[152:155], v[84:87], v[124:127]
  s_waitcnt vmcnt(1)
LC_65:
  v_max3_u32 v223, v88, v89, v90
  v_max3_u32 v223, v223, v91, v92
  v_max3_u32 v223, v223, v93, v94
  v_max_u32 v223, v223, v95
  v_cmp_eq_u32 vcc, -1, v223
  s_cbranch_vccnz LR_66
LK_67:
  v_mfma_f32_16x16x32_bf16 v[128:131], v[156:159], v[80:83], v[128:131]
  v_swap_b32 v90, v92
  v_mfma_f32_16x16x32_bf16 v[132:135], v[156:159], v[84:87], v[132:135]
  v_swap_b32 v91, v93
  v_mfma_f32_16x16x32_bf16 v[136:139], v[160:163], v[80:83], v[136:139]
  v_mfma_f32_16x16x32_bf16 v[140:143], v[160:163], v[84:87], v[140:143]
  s_waitcnt lgkmcnt(0)
  s_nop 1
  v_mfma_f32_16x16x32_bf16 v[104:107], v[164:167], v[88:91], v[104:107]
  v_mfma_f32_16x16x32_bf16 v[108:111], v[164:167], v[92:95], v[108:111]
  v_mfma_f32_16x16x32_bf16 v[112:115], v[168:171], v[88:91], v[112:115]
  v_mfma_f32_16x16x32_bf16 v[116:119], v[168:171], v[92:95], v[116:119]
  v_mfma_f32_16x16x32_bf16 v[120:123], v[172:175], v[88:91], v[120:123]
  v_mfma_f32_16x16x32_bf16 v[124:127], v[172:175], v[92:95], v[124:127]
  v_mfma_f32_16x16x32_bf16 v[128:131], v[176:179], v[88:91], v[128:131]
  v_mfma_f32_16x16x32_bf16 v[132:135], v[176:179], v[92:95], v[132:135]
  v_mfma_f32_16x16x32_bf16 v[136:139], v[180:183], v[88:91], v[136:139]
  v_mfma_f32_16x16x32_bf16 v[140:143], v[180:183], v[92:95], v[140:143]
  s_cmp_lg_u32 s74, 0
  s_cbranch_scc1 L_G1W
  ds_write_b128 v12, v[108:111] offset:1024
  ds_write_b128 v12, v[116:119] offset:3072
  ds_write_b128 v12, v[120:123] offset:4096
  ds_write_b128 v12, v[124:127] offset:6144
  ds_write_b128 v12, v[128:131] offset:8192
  ds_write_b128 v12, v[132:135] offset:10240
  ds_write_b128 v12, v[136:139] offset:12288
  ds_write_b128 v12, v[140:143] offset:14336
  s_branch L_FC2
L_G1W:
  ds_write_b128 v12, v[104:107] offset:0
  ds_write_b128 v12, v[112:115] offset:2048
  ds_write_b128 v12, v[120:123] offset:5120
  ds_write_b128 v12, v[124:127] offset:7168
  ds_write_b128 v12, v[128:131] offset:9216
  ds_write_b128 v12, v[132:135] offset:11264
  ds_write_b128 v12, v[136:139] offset:13312
  ds_write_b128 v12, v[140:143] offset:15360
  s_branch L_FC2
L_S5:
  s_setprio 0
  s_cmp_eq_u64 s[56:57], 0
  s_cbranch_scc1 L_FC3
  s_mov_b32 s71, 702720
  v_add_u32 v72, 0, v1
  v_min_u32 v72, 0, v72
  v_lshlrev_b32 v72, 6, v72
LP_68:
  buffer_load_dwordx2 v[64:65], v72, s[48:51], s71 offen sc1
  s_waitcnt vmcnt(0)
  v_cmp_ne_u64 vcc, s[42:43], v[64:65]
  s_cbranch_vccz LD_69
  s_add_u32 s95, s95, 1
  s_cmp_gt_u32 s95, 262144
  s_cbranch_scc1 LD_69
  s_sleep 2
  s_branch LP_68
LD_69:
L_FC3:
L_W2P:
  ds_read_b32 v4, v222
  s_waitcnt lgkmcnt(0)
  v_cmp_gt_u32 vcc, 4, v4
  s_cbranch_vccz L_W2Q
  s_sleep 1
  s_branch L_W2P
L_W2Q:
  s_and_b32 s94, s21, 0xc00
  s_add_u32 m0, s94, 0
  s_add_u32 s89, s94, s23
  s_add_u32 s89, s89, 0
  buffer_load_dwordx4 v249, s[44:47], s89 offen sc1 lds
  s_add_u32 m0, s94, 4096
  s_add_u32 s89, s94, s23
  s_add_u32 s89, s89, 4096
  buffer_load_dwordx4 v249, s[44:47], s89 offen sc1 lds
  s_add_u32 m0, s94, 8192
  s_add_u32 s89, s94, s23
  s_add_u32 s89, s89, 8192
  buffer_load_dwordx4 v249, s[44:47], s89 offen sc1 lds
  s_add_u32 m0, s94, 12288
  s_add_u32 s89, s94, s23
  s_add_u32 s89, s89, 12288
  buffer_load_dwordx4 v249, s[44:47], s89 offen sc1 lds
  s_add_u32 m0, s94, 16384
  s_add_u32 s89, s94, s23
  s_add_u32 s89, s89, 16384
  buffer_load_dwordx4 v249, s[44:47], s89 offen sc1 lds
  s_add_u32 m0, s94, 20480
  s_add_u32 s89, s94, s23
  s_add_u32 s89, s89, 20480
  buffer_load_dwordx4 v249, s[44:47], s89 offen sc1 lds
  s_add_u32 m0, s94, 51200
  s_add_u32 s89, s94, s23
  s_add_u32 s89, s89, 51200
  buffer_load_dwordx4 v249, s[44:47], s89 offen sc1 lds
  s_add_u32 m0, s94, 55296
  s_add_u32 s89, s94, s23
  s_add_u32 s89, s89, 55296
  buffer_load_dwordx4 v249, s[44:47], s89 offen sc1 lds
  s_add_u32 m0, s94, 59392
  s_add_u32 s89, s94, s23
  s_add_u32 s89, s89, 59392
  buffer_load_dwordx4 v249, s[44:47], s89 offen sc1 lds
  s_add_u32 m0, s94, 63488
  s_add_u32 s89, s94, s23
  s_add_u32 s89, s89, 63488
  buffer_load_dwordx4 v249, s[44:47], s89 offen sc1 lds
  s_add_u32 m0, s94, 67584
  s_add_u32 s89, s94, s23
  s_add_u32 s89, s89, 67584
  buffer_load_dwordx4 v249, s[44:47], s89 offen sc1 lds
  s_add_u32 m0, s94, 71680
  s_add_u32 s89, s94, s23
  s_add_u32 s89, s89, 71680
  buffer_load_dwordx4 v249, s[44:47], s89 offen sc1 lds
L_FC2:
  buffer_load_dwordx4 v[224:227], v220, s[48:51], s70 offen sc1
  s_waitcnt lgkmcnt(0)
  s_barrier
  s_cmp_lg_u32 s73, 0
  s_cbranch_scc1 L_G1V0
  ds_read_b128 v[68:71], v12 offset:0
  ds_read_b128 v[76:79], v12 offset:2048
  s_add_u32 m0, s21, 24576
  s_add_u32 s89, s21, s23
  s_add_u32 s89, s89, 24576
  buffer_load_dwordx4 v249, s[44:47], s89 offen sc1 lds
  s_add_u32 m0, s21, 32768
  s_add_u32 s89, s21, s23
  s_add_u32 s89, s89, 32768
  buffer_load_dwordx4 v249, s[44:47], s89 offen sc1 lds
  s_waitcnt lgkmcnt(1)
  v_pk_add_f32 v[40:41], v[104:105], v[68:69]
  v_pk_add_f32 v[42:43], v[106:107], v[70:71]
  s_waitcnt lgkmcnt(0)
  v_pk_add_f32 v[44:45], v[112:113], v[76:77]
  v_pk_add_f32 v[46:47], v[114:115], v[78:79]
  s_branch L_G1R
L_G1V0:
  s_cmp_lg_u32 s73, 1
  s_cbranch_scc1 L_G1V1
  ds_read_b128 v[64:67], v12 offset:1024
  ds_read_b128 v[72:75], v12 offset:3072
  s_add_u32 m0, s21, 24576
  s_add_u32 s89, s21, s23
  s_add_u32 s89, s89, 24576
  buffer_load_dwordx4 v249, s[44:47], s89 offen sc1 lds
  s_add_u32 m0, s21, 32768
  s_add_u32 s89, s21, s23
  s_add_u32 s89, s89, 32768
  buffer_load_dwordx4 v249, s[44:47], s89 offen sc1 lds
  s_waitcnt lgkmcnt(1)
  v_pk_add_f32 v[40:41], v[64:65], v[108:109]
  v_pk_add_f32 v[42:43], v[66:67], v[110:111]
  s_waitcnt lgkmcnt(0)
  v_pk_add_f32 v[44:45], v[72:73], v[116:117]
  v_pk_add_f32 v[46:47], v[74:75], v[118:119]
  s_branch L_G1R
L_G1V1:
  s_cmp_lg_u32 s73, 2
  s_cbranch_scc1 L_G1V2
  ds_read_b128 v[64:67], v12 offset:4096
  ds_read_b128 v[68:71], v12 offset:5120
  ds_read_b128 v[72:75], v12 offset:8192
  ds_read_b128 v[76:79], v12 offset:9216
  ds_read_b128 v[80:83], v12 offset:12288
  ds_read_b128 v[84:87], v12 offset:13312
  s_add_u32 m0, s21, 24576
  s_add_u32 s89, s21, s23
  s_add_u32 s89, s89, 24576
  buffer_load_dwordx4 v249, s[44:47], s89 offen sc1 lds
  s_add_u32 m0, s21, 32768
  s_add_u32 s89, s21, s23
  s_add_u32 s89, s89, 32768
  buffer_load_dwordx4 v249, s[44:47], s89 offen sc1 lds
  s_waitcnt lgkmcnt(4)
  v_pk_add_f32 v[40:41], v[64:65], v[68:69]
  v_pk_add_f32 v[42:43], v[66:67], v[70:71]
  s_waitcnt lgkmcnt(2)
  v_pk_add_f32 v[44:45], v[72:73], v[76:77]
  v_pk_add_f32 v[46:47], v[74:75], v[78:79]
  s_waitcnt lgkmcnt(0)
  v_pk_add_f32 v[48:49], v[80:81], v[84:85]
  v_pk_add_f32 v[50:51], v[82:83], v[86:87]
  s_branch L_G1R
L_G1V2:
  ds_read_b128 v[64:67], v12 offset:6144
  ds_read_b128 v[68:71], v12 offset:7168
  ds_read_b128 v[72:75], v12 offset:10240
  ds_read_b128 v[76:79], v12 offset:11264
  ds_read_b128 v[80:83], v12 offset:14336
  ds_read_b128 v[84:87], v12 offset:15360
  s_add_u32 m0, s21, 24576
  s_add_u32 s89, s21, s23
  s_add_u32 s89, s89, 24576
  buffer_load_dwordx4 v249, s[44:47], s89 offen sc1 lds
  s_add_u32 m0, s21, 32768
  s_add_u32 s89, s21, s23
  s_add_u32 s89, s89, 32768
  buffer_load_dwordx4 v249, s[44:47], s89 offen sc1 lds
  s_waitcnt lgkmcnt(4)
  v_pk_add_f32 v[40:41], v[64:65], v[68:69]
  v_pk_add_f32 v[42:43], v[66:67], v[70:71]
  s_waitcnt lgkmcnt(2)
  v_pk_add_f32 v[44:45], v[72:73], v[76:77]
  v_pk_add_f32 v[46:47], v[74:75], v[78:79]
  s_waitcnt lgkmcnt(0)
  v_pk_add_f32 v[48:49], v[80:81], v[84:85]
  v_pk_add_f32 v[50:51], v[82:83], v[86:87]
L_G1R:
  s_waitcnt vmcnt(2)
  s_branch L_G1GC
L_G1GR:
  buffer_load_dwordx4 v[224:227], v220, s[48:51], s70 offen sc1
  s_waitcnt vmcnt(0)
L_G1GC:
  v_cmp_ne_u64 vcc, s[42:43], v[226:227]
  s_cbranch_vccz L_G1GD
  s_add_u32 s95, s95, 1
  s_cmp_gt_u32 s95, 262144
  s_cbranch_scc1 L_G1GD
  s_sleep 1
  s_branch L_G1GR
L_G1GD:
  v_lshlrev_b32 v16, 16, v224
  v_and_b32 v17, 0xffff0000, v224
  v_lshlrev_b32 v18, 16, v225
  v_and_b32 v19, 0xffff0000, v225
  v_rcp_f32 v17, v17
  v_rcp_f32 v22, v19
  s_nop 0
  v_mul_f32 v20, v17, v22
  v_mul_f32 v21, -v20, v16
  v_mul_f32 v23, -v22, v18
  v_pk_mul_f32 v[40:41], v[40:41], v[20:21] op_sel_hi:[1,0]
  v_pk_mul_f32 v[42:43], v[42:43], v[20:21] op_sel_hi:[1,0]
  s_add_u32 m0, s21, 40960
  s_add_u32 s89, s21, s23
  s_add_u32 s89, s89, 40960
  buffer_load_dwordx4 v249, s[44:47], s89 offen sc1 lds
  v_fmac_f32_dpp v40, v184, v21 row_newbcast:0 row_mask:0xf bank_mask:0xf
  v_fmac_f32_dpp v41, v185, v21 row_newbcast:0 row_mask:0xf bank_mask:0xf
  v_fmac_f32_dpp v42, v186, v21 row_newbcast:0 row_mask:0xf bank_mask:0xf
  v_fmac_f32_dpp v43, v187, v21 row_newbcast:0 row_mask:0xf bank_mask:0xf
  v_fmac_f32_dpp v40, v184, v22 row_newbcast:1 row_mask:0xf bank_mask:0xf
  v_fmac_f32_dpp v41, v185, v22 row_newbcast:1 row_mask:0xf bank_mask:0xf
  v_fmac_f32_dpp v42, v186, v22 row_newbcast:1 row_mask:0xf bank_mask:0xf
  v_fmac_f32_dpp v43, v187, v22 row_newbcast:1 row_mask:0xf bank_mask:0xf
  v_fmac_f32_dpp v40, v184, v23 row_newbcast:2 row_mask:0xf bank_mask:0xf
  v_fmac_f32_dpp v41, v185, v23 row_newbcast:2 row_mask:0xf bank_mask:0xf
  v_fmac_f32_dpp v42, v186, v23 row_newbcast:2 row_mask:0xf bank_mask:0xf
  s_min_u32 s87, s21, 1024
  s_add_u32 m0, s87, 49152
  s_add_u32 s89, s87, s23
  s_add_u32 s89, s89, 49152
  buffer_load_dwordx4 v249, s[44:47], s89 offen sc1 lds
  v_fmac_f32_dpp v43, v187, v23 row_newbcast:2 row_mask:0xf bank_mask:0xf
  v_pk_mul_f32 v[44:45], v[44:45], v[20:21] op_sel_hi:[1,0]
  v_pk_mul_f32 v[46:47], v[46:47], v[20:21] op_sel_hi:[1,0]
  v_fmac_f32_dpp v44, v184, v21 row_newbcast:3 row_mask:0xf bank_mask:0xf
  v_fmac_f32_dpp v45, v185, v21 row_newbcast:3 row_mask:0xf bank_mask:0xf
  v_fmac_f32_dpp v46, v186, v21 row_newbcast:3 row_mask:0xf bank_mask:0xf
  v_fmac_f32_dpp v47, v187, v21 row_newbcast:3 row_mask:0xf bank_mask:0xf
  v_fmac_f32_dpp v44, v184, v22 row_newbcast:4 row_mask:0xf bank_mask:0xf
  v_fmac_f32_dpp v45, v185, v22 row_newbcast:4 row_mask:0xf bank_mask:0xf
  v_fmac_f32_dpp v46, v186, v22 row_newbcast:4 row_mask:0xf bank_mask:0xf
  v_fmac_f32_dpp v47, v187, v22 row_newbcast:4 row_mask:0xf bank_mask:0xf
  s_add_u32 m0, s21, 75776
  s_add_u32 s89, s21, s23
  s_add_u32 s89, s89, 75776
  buffer_load_dwordx4 v249, s[44:47], s89 offen sc1 lds
  v_fmac_f32_dpp v44, v184, v23 row_newbcast:5 row_mask:0xf bank_mask:0xf
  v_fmac_f32_dpp v45, v185, v23 row_newbcast:5 row_mask:0xf bank_mask:0xf
  v_fmac_f32_dpp v46, v186, v23 row_newbcast:5 row_mask:0xf bank_mask:0xf
  v_fmac_f32_dpp v47, v187, v23 row_newbcast:5 row_mask:0xf bank_mask:0xf
  v_pk_mul_f32 v[64:65], v[40:41], v[40:41]
  v_pk_mul_f32 v[66:67], v[42:43], v[42:43]
  v_pk_mul_f32 v[68:69], v[44:45], v[44:45]
  v_pk_mul_f32 v[70:71], v[46:47], v[46:47]
  v_pk_fma_f32 v[64:65], v[64:65], v[250:251], v[252:253]
  v_pk_fma_f32 v[66:67], v[66:67], v[250:251], v[252:253]
  v_pk_fma_f32 v[68:69], v[68:69], v[250:251], v[252:253]
  s_add_u32 m0, s21, 83968
  s_add_u32 s89, s21, s23
  s_add_u32 s89, s89, 83968
  buffer_load_dwordx4 v249, s[44:47], s89 offen sc1 lds
  v_pk_fma_f32 v[70:71], v[70:71], v[250:251], v[252:253]
  v_pk_mul_f32 v[64:65], v[64:65], v[40:41]
  v_pk_mul_f32 v[66:67], v[66:67], v[42:43]
  v_pk_mul_f32 v[68:69], v[68:69], v[44:45]
  v_pk_mul_f32 v[70:71], v[70:71], v[46:47]
  v_exp_f32 v64, v64
  v_exp_f32 v65, v65
  v_exp_f32 v66, v66
  v_exp_f32 v67, v67
  v_exp_f32 v68, v68
  v_exp_f32 v69, v69
  s_add_u32 m0, s21, 92160
  s_add_u32 s89, s21, s23
  s_add_u32 s89, s89, 92160
  buffer_load_dwordx4 v249, s[44:47], s89 offen sc1 lds
  v_exp_f32 v70, v70
  v_exp_f32 v71, v71
  v_pk_add_f32 v[64:65], v[64:65], 1.0 op_sel_hi:[1,0]
  v_pk_add_f32 v[66:67], v[66:67], 1.0 op_sel_hi:[1,0]
  v_pk_add_f32 v[68:69], v[68:69], 1.0 op_sel_hi:[1,0]
  v_pk_add_f32 v[70:71], v[70:71], 1.0 op_sel_hi:[1,0]
  v_rcp_f32 v64, v64
  v_rcp_f32 v65, v65
  v_rcp_f32 v66, v66
  v_rcp_f32 v67, v67
  v_rcp_f32 v68, v68
  s_min_u32 s87, s21, 1024
  s_add_u32 m0, s87, 100352
  s_add_u32 s89, s87, s23
  s_add_u32 s89, s89, 100352
  buffer_load_dwordx4 v249, s[44:47], s89 offen sc1 lds
  v_rcp_f32 v69, v69
  v_rcp_f32 v70, v70
  v_rcp_f32 v71, v71
  v_pk_mul_f32 v[40:41], v[40:41], v[64:65]
  v_pk_mul_f32 v[42:43], v[42:43], v[66:67]
  v_pk_mul_f32 v[44:45], v[44:45], v[68:69]
  v_pk_mul_f32 v[46:47], v[46:47], v[70:71]
  v_cvt_pk_bf16_f32 v28, v40, v41
  v_cndmask_b32 v28, 0, v28, s[84:85]
  v_cvt_pk_bf16_f32 v29, v42, v43
  v_cndmask_b32 v29, 0, v29, s[84:85]
  v_cvt_pk_bf16_f32 v30, v44, v45
  v_cndmask_b32 v30, 0, v30, s[84:85]
  v_cvt_pk_bf16_f32 v31, v46, v47
  v_cndmask_b32 v31, 0, v31, s[84:85]
  s_cmp_eq_u32 s98, 0
  s_cbranch_scc1 LQ_70
  buffer_store_dwordx4 v[28:31], v249, s[48:51], s29 offen
  s_branch LQ_71
LQ_70:
  buffer_store_dwordx4 v[28:31], v249, s[48:51], s29 offen sc1
LQ_71:
  s_cmp_eq_u32 s75, 0
  s_cbranch_scc1 L_G1E
  v_pk_mul_f32 v[48:49], v[48:49], v[20:21] op_sel_hi:[1,0]
  v_pk_mul_f32 v[50:51], v[50:51], v[20:21] op_sel_hi:[1,0]
  v_fmac_f32_dpp v48, v184, v21 row_newbcast:6 row_mask:0xf bank_mask:0xf
  v_fmac_f32_dpp v49, v185, v21 row_newbcast:6 row_mask:0xf bank_mask:0xf
  v_fmac_f32_dpp v50, v186, v21 row_newbcast:6 row_mask:0xf bank_mask:0xf
  v_fmac_f32_dpp v51, v187, v21 row_newbcast:6 row_mask:0xf bank_mask:0xf
  v_fmac_f32_dpp v48, v184, v22 row_newbcast:7 row_mask:0xf bank_mask:0xf
  v_fmac_f32_dpp v49, v185, v22 row_newbcast:7 row_mask:0xf bank_mask:0xf
  v_fmac_f32_dpp v50, v186, v22 row_newbcast:7 row_mask:0xf bank_mask:0xf
  v_fmac_f32_dpp v51, v187, v22 row_newbcast:7 row_mask:0xf bank_mask:0xf
  v_fmac_f32_dpp v48, v184, v23 row_newbcast:8 row_mask:0xf bank_mask:0xf
  v_fmac_f32_dpp v49, v185, v23 row_newbcast:8 row_mask:0xf bank_mask:0xf
  v_fmac_f32_dpp v50, v186, v23 row_newbcast:8 row_mask:0xf bank_mask:0xf
  v_fmac_f32_dpp v51, v187, v23 row_newbcast:8 row_mask:0xf bank_mask:0xf
  v_pk_mul_f32 v[64:65], v[48:49], v[48:49]
  v_pk_mul_f32 v[66:67], v[50:51], v[50:51]
  v_pk_fma_f32 v[64:65], v[64:65], v[250:251], v[252:253]
  v_pk_fma_f32 v[66:67], v[66:67], v[250:251], v[252:253]
  v_pk_mul_f32 v[64:65], v[64:65], v[48:49]
  v_pk_mul_f32 v[66:67], v[66:67], v[50:51]
  v_exp_f32 v64, v64
  v_exp_f32 v65, v65
  v_exp_f32 v66, v66
  v_exp_f32 v67, v67
  v_pk_add_f32 v[64:65], v[64:65], 1.0 op_sel_hi:[1,0]
  v_pk_add_f32 v[66:67], v[66:67], 1.0 op_sel_hi:[1,0]
  v_rcp_f32 v64, v64
  v_rcp_f32 v65, v65
  v_rcp_f32 v66, v66
  v_rcp_f32 v67, v67
  v_pk_mul_f32 v[48:49], v[48:49], v[64:65]
  v_pk_mul_f32 v[50:51], v[50:51], v[66:67]
  v_cvt_pk_bf16_f32 v32, v48, v49
  v_cndmask_b32 v32, 0, v32, s[84:85]
  v_cvt_pk_bf16_f32 v33, v50, v51
  v_cndmask_b32 v33, 0, v33, s[84:85]
  s_cmp_eq_u32 s98, 0
  s_cbranch_scc1 LQ_72
  buffer_store_dwordx2 v[32:33], v249, s[48:51], s28 offen
  s_branch LQ_73
LQ_72:
  buffer_store_dwordx2 v[32:33], v249, s[48:51], s28 offen sc1
LQ_73:
L_G1E:
  s_lshl_b32 s86, s17, 2
  s_lshl_b32 s87, s72, 1
  s_add_u32 s86, s86, s87
  s_add_u32 s86, s86, s74
  s_lshl_b32 s86, s86, 4
  s_lshl_b32 s87, s10, 1
  s_add_u32 s86, s86, s87
  s_add_u32 s86, s86, s75
  s_lshl_b32 s86, s86, 4
  s_add_u32 s86, s86, 696320
  v_mov_b32 v16, s42
  v_mov_b32 v17, s43
  s_waitcnt vmcnt(0)
  s_mov_b64 exec, 1
  s_cmp_eq_u32 s98, 0
  s_cbranch_scc1 LQ_74
  buffer_store_dwordx2 v[16:17], v248, s[48:51], s86 offen
  s_branch LQ_75
LQ_74:
  buffer_store_dwordx2 v[16:17], v248, s[48:51], s86 offen sc1
LQ_75:
  s_mov_b64 exec, -1
  s_and_b32 s72, s3, 3
  s_lshr_b32 s73, s3, 2
  s_lshl_b32 s76, s73, 5
  s_add_u32 s76, s76, s12
  s_lshl_b32 s77, s9, 6
  s_lshr_b32 s78, s72, 1
  s_lshl_b32 s78, s78, 5
  s_add_u32 s77, s77, s78
  s_and_b32 s78, s72, 1
  s_add_u32 s77, s77, s78
  v_lshl_add_u32 v221, v2, 1, s77
  v_add_lshl_u32 v220, v221, s18, 4
  s_lshl_b32 s79, s17, 2
  s_add_u32 s79, s79, s72
  s_mul_i32 s80, s79, 20480
  s_mul_i32 s81, s73, 10240
  s_add_u32 s81, s81, s80
  s_mul_i32 s83, s73, 51200
  v_add_u32 v14, s83, v249
  s_lshl_b32 s71, s17, 9
  s_add_u32 s71, s71, 696320
  v_min_u32 v4, 5, v2
  v_lshrrev_b32 v5, 1, v4
  v_mul_u32_u24 v13, 2, v5
  v_sub_u32 v4, v4, v13
  v_mul_u32_u24 v4, 2560, v4
  v_cmp_eq_u32 vcc, 2, v5
  v_lshl_add_u32 v5, v5, 4, s76
  v_mov_b32 v13, s13
  v_cndmask_b32 v5, v5, v13, vcc
  v_lshl_add_u32 v5, v3, 2, v5
  v_lshl_add_u32 v13, v5, 2, v4
  s_mov_b32 s86, 400896
  buffer_load_dwordx4 v[208:211], v13, s[44:47], s86 offen sc1
  v_mul_u32_u24 v5, 17024, v3
  v_lshl_add_u32 v5, v221, 3, v5
  s_mul_i32 s86, s76, 4256
  s_add_u32 s86, s86, 1048704
  buffer_load_dwordx2 v[232:233], v5, s[44:47], s86 offen sc1
  s_add_u32 s86, s86, 68096
  buffer_load_dwordx2 v[234:235], v5, s[44:47], s86 offen sc1
  s_mul_i32 s86, s13, 4256
  s_add_u32 s86, s86, 1048704
  buffer_load_dwordx2 v[236:237], v5, s[44:47], s86 offen sc1
  s_add_u32 s30, s80, 0
  s_lshl_b32 s31, s73, 10
  s_add_u32 s31, s31, s14
  s_add_u32 s31, s31, s30
  s_add_u32 s30, s30, s15
  v_lshlrev_b32 v12, 7, v2
  v_lshrrev_b32 v11, 1, v3
  v_lshl_add_u32 v12, v11, 2, v12
  s_lshl_b32 s32, s79, 11
  s_lshl_b32 s87, s10, 4
  s_add_u32 s32, s32, s87
  s_lshl_b32 s87, s73, 3
  s_add_u32 s32, s32, s87
  s_add_u32 s32, s32, 655360
  v_and_b32 v246, 7, v1
  v_lshlrev_b32 v246, 7, v246
  v_mov_b32 v4, s31
  v_mov_b32 v11, s30
  v_cmp_gt_u32 vcc, 8, v2
  s_nop 1
  v_cndmask_b32 v4, v11, v4, vcc
  v_add_u32 v246, v246, v4
  v_cmp_gt_u32 vcc, 16, v1
  v_add_u32 v4, s32, v12
  s_nop 0
  v_cndmask_b32 v246, v4, v246, vcc
  v_min_u32 v10, 3, v1
  v_lshlrev_b32 v10, 7, v10
  s_lshl_b32 s27, s16, 3
  s_add_u32 s27, s27, s3
  s_mul_i32 s27, s27, 7680
  s_add_u32 s27, s27, 8388608
  s_lshl_b32 s71, s79, 8
  s_lshl_b32 s86, s73, 7
  s_add_u32 s71, s71, s86
  s_add_u32 s71, s71, 696320
  v_add_u32 v48, 0, v1
  v_min_u32 v48, 7, v48
  v_lshlrev_b32 v48, 4, v48
  buffer_load_dwordx2 v[40:41], v48, s[48:51], s71 offen sc1
  s_waitcnt vmcnt(0) lgkmcnt(0)
  s_barrier
  s_branch LP_78
LP_76:
  buffer_load_dwordx2 v[40:41], v48, s[48:51], s71 offen sc1
  s_waitcnt vmcnt(0)
LP_78:
  v_cmp_ne_u64 vcc, s[42:43], v[40:41]
  s_cbranch_vccz LD_77
  s_add_u32 s95, s95, 1
  s_cmp_gt_u32 s95, 262144
  s_cbranch_scc1 LD_77
  s_sleep 1
  s_branch LP_76
LD_77:
  buffer_load_dwordx4 v[64:67], v249, s[48:51], s81 offen offset:0 sc1
  buffer_load_dwordx4 v[68:71], v249, s[48:51], s81 offen offset:1024 sc1
  buffer_load_dwordx4 v[72:75], v249, s[48:51], s81 offen offset:2048 sc1
  buffer_load_dwordx4 v[76:79], v249, s[48:51], s81 offen offset:3072 sc1
  s_add_u32 s81, s81, 4096
  buffer_load_dwordx4 v[80:83], v249, s[48:51], s81 offen offset:0 sc1
  ds_read_b128 v[124:127], v14 offset:0
  ds_read_b128 v[128:131], v14 offset:1024
  ds_read_b128 v[132:135], v14 offset:2048
  ds_read_b128 v[136:139], v14 offset:3072
  ds_read_b128 v[140:143], v14 offset:4096
  ds_read_b128 v[144:147], v14 offset:5120
  ds_read_b128 v[148:151], v14 offset:6144
  ds_read_b128 v[152:155], v14 offset:7168
  ds_read_b128 v[156:159], v14 offset:8192
  ds_read_b128 v[160:163], v14 offset:9216
  buffer_load_dwordx4 v[84:87], v249, s[48:51], s81 offen offset:1024 sc1
  s_waitcnt vmcnt(5) lgkmcnt(5)
  v_mfma_f32_16x16x32_bf16 v[104:107], v[124:127], v[64:67], 0
  ds_read_b128 v[164:167], v14 offset:10240
  v_mfma_f32_16x16x32_bf16 v[108:111], v[128:131], v[64:67], 0
  ds_read_b128 v[168:171], v14 offset:11264
  v_mfma_f32_16x16x32_bf16 v[112:115], v[132:135], v[64:67], 0
  ds_read_b128 v[172:175], v14 offset:12288
  v_mfma_f32_16x16x32_bf16 v[116:119], v[136:139], v[64:67], 0
  ds_read_b128 v[176:179], v14 offset:13312
  v_mfma_f32_16x16x32_bf16 v[120:123], v[140:143], v[64:67], 0
  ds_read_b128 v[180:183], v14 offset:14336
  buffer_load_dwordx4 v[88:91], v249, s[48:51], s81 offen offset:2048 sc1
  s_waitcnt vmcnt(5) lgkmcnt(5)
  v_mfma_f32_16x16x32_bf16 v[104:107], v[144:147], v[68:71], v[104:107]
  ds_read_b128 v[124:127], v14 offset:15360
  v_mfma_f32_16x16x32_bf16 v[108:111], v[148:151], v[68:71], v[108:111]
  ds_read_b128 v[128:131], v14 offset:16384
  v_mfma_f32_16x16x32_bf16 v[112:115], v[152:155], v[68:71], v[112:115]
  ds_read_b128 v[132:135], v14 offset:17408
  v_mfma_f32_16x16x32_bf16 v[116:119], v[156:159], v[68:71], v[116:119]
  ds_read_b128 v[136:139], v14 offset:18432
  v_mfma_f32_16x16x32_bf16 v[120:123], v[160:163], v[68:71], v[120:123]
  ds_read_b128 v[140:143], v14 offset:19456
  buffer_load_dwordx4 v[92:95], v249, s[48:51], s81 offen offset:3072 sc1
  s_waitcnt vmcnt(5) lgkmcnt(5)
  v_mfma_f32_16x16x32_bf16 v[104:107], v[164:167], v[72:75], v[104:107]
  ds_read_b128 v[144:147], v14 offset:20480
  v_mfma_f32_16x16x32_bf16 v[108:111], v[168:171], v[72:75], v[108:111]
  ds_read_b128 v[148:151], v14 offset:21504
  v_mfma_f32_16x16x32_bf16 v[112:115], v[172:175], v[72:75], v[112:115]
  ds_read_b128 v[152:155], v14 offset:22528
  v_mfma_f32_16x16x32_bf16 v[116:119], v[176:179], v[72:75], v[116:119]
  ds_read_b128 v[156:159], v14 offset:23552
  v_mfma_f32_16x16x32_bf16 v[120:123], v[180:183], v[72:75], v[120:123]
  ds_read_b128 v[160:163], v14 offset:24576
  s_add_u32 s81, s81, 4096
  buffer_load_dwordx4 v[96:99], v249, s[48:51], s81 offen offset:0 sc1
  s_waitcnt vmcnt(5) lgkmcnt(5)
  v_mfma_f32_16x16x32_bf16 v[104:107], v[124:127], v[76:79], v[104:107]
  ds_read_b128 v[164:167], v14 offset:25600
  v_mfma_f32_16x16x32_bf16 v[108:111], v[128:131], v[76:79], v[108:111]
  ds_read_b128 v[168:171], v14 offset:26624
  v_mfma_f32_16x16x32_bf16 v[112:115], v[132:135], v[76:79], v[112:115]
  ds_read_b128 v[172:175], v14 offset:27648
  v_mfma_f32_16x16x32_bf16 v[116:119], v[136:139], v[76:79], v[116:119]
  ds_read_b128 v[176:179], v14 offset:28672
  v_mfma_f32_16x16x32_bf16 v[120:123], v[140:143], v[76:79], v[120:123]
  ds_read_b128 v[180:183], v14 offset:29696
  buffer_load_dwordx4 v[100:103], v249, s[48:51], s81 offen offset:1024 sc1
  s_waitcnt vmcnt(5) lgkmcnt(5)
  v_mfma_f32_16x16x32_bf16 v[104:107], v[144:147], v[80:83], v[104:107]
  ds_read_b128 v[124:127], v14 offset:30720
  v_mfma_f32_16x16x32_bf16 v[108:111], v[148:151], v[80:83], v[108:111]
  ds_read_b128 v[128:131], v14 offset:31744
  v_mfma_f32_16x16x32_bf16 v[112:115], v[152:155], v[80:83], v[112:115]
  ds_read_b128 v[132:135], v14 offset:32768
  v_mfma_f32_16x16x32_bf16 v[116:119], v[156:159], v[80:83], v[116:119]
  ds_read_b128 v[136:139], v14 offset:33792
  v_mfma_f32_16x16x32_bf16 v[120:123], v[160:163], v[80:83], v[120:123]
  ds_read_b128 v[140:143], v14 offset:34816
  buffer_load_dwordx4 v[224:227], v220, s[48:51], s70 offen sc1
  buffer_load_dword v247, v246, s[48:51], 0 offen sc1
  s_add_u32 m0, s21, 122880
  s_add_u32 s89, s21, s24
  s_add_u32 s89, s89, 81920
  buffer_load_dwordx4 v249, s[44:47], s89 offen sc1 lds
  s_waitcnt vmcnt(7) lgkmcnt(5)
  v_mfma_f32_16x16x32_bf16 v[104:107], v[164:167], v[84:87], v[104:107]
  ds_read_b128 v[144:147], v14 offset:35840
  v_mfma_f32_16x16x32_bf16 v[108:111], v[168:171], v[84:87], v[108:111]
  ds_read_b128 v[148:151], v14 offset:36864
  v_mfma_f32_16x16x32_bf16 v[112:115], v[172:175], v[84:87], v[112:115]
  ds_read_b128 v[152:155], v14 offset:37888
  v_mfma_f32_16x16x32_bf16 v[116:119], v[176:179], v[84:87], v[116:119]
  ds_read_b128 v[156:159], v14 offset:38912
  v_mfma_f32_16x16x32_bf16 v[120:123], v[180:183], v[84:87], v[120:123]
  ds_read_b128 v[160:163], v14 offset:39936
  s_add_u32 m0, s21, 131072
  s_add_u32 s89, s21, s24
  s_add_u32 s89, s89, 90112
  buffer_load_dwordx4 v249, s[44:47], s89 offen sc1 lds
  s_waitcnt vmcnt(7) lgkmcnt(5)
  v_mfma_f32_16x16x32_bf16 v[104:107], v[124:127], v[88:91], v[104:107]
  ds_read_b128 v[164:167], v14 offset:40960
  v_mfma_f32_16x16x32_bf16 v[108:111], v[128:131], v[88:91], v[108:111]
  ds_read_b128 v[168:171], v14 offset:41984
  v_mfma_f32_16x16x32_bf16 v[112:115], v[132:135], v[88:91], v[112:115]
  ds_read_b128 v[172:175], v14 offset:43008
  v_mfma_f32_16x16x32_bf16 v[116:119], v[136:139], v[88:91], v[116:119]
  ds_read_b128 v[176:179], v14 offset:44032
  v_mfma_f32_16x16x32_bf16 v[120:123], v[140:143], v[88:91], v[120:123]
  ds_read_b128 v[180:183], v14 offset:45056
  s_add_u32 m0, s21, 139264
  s_add_u32 s89, s21, s24
  s_add_u32 s89, s89, 98304
  buffer_load_dwordx4 v249, s[44:47], s89 offen sc1 lds
  s_waitcnt vmcnt(7) lgkmcnt(5)
  v_mfma_f32_16x16x32_bf16 v[104:107], v[144:147], v[92:95], v[104:107]
  ds_read_b128 v[124:127], v14 offset:46080
  v_mfma_f32_16x16x32_bf16 v[108:111], v[148:151], v[92:95], v[108:111]
  ds_read_b128 v[128:131], v14 offset:47104
  v_mfma_f32_16x16x32_bf16 v[112:115], v[152:155], v[92:95], v[112:115]
  ds_read_b128 v[132:135], v14 offset:48128
  v_mfma_f32_16x16x32_bf16 v[116:119], v[156:159], v[92:95], v[116:119]
  ds_read_b128 v[136:139], v14 offset:49152
  v_mfma_f32_16x16x32_bf16 v[120:123], v[160:163], v[92:95], v[120:123]
  ds_read_b128 v[140:143], v14 offset:50176
  s_add_u32 m0, s21, 147456
  s_add_u32 s89, s21, s24
  s_add_u32 s89, s89, 106496
  buffer_load_dwordx4 v249, s[44:47], s89 offen sc1 lds
  s_waitcnt vmcnt(7) lgkmcnt(5)
  v_mfma_f32_16x16x32_bf16 v[104:107], v[164:167], v[96:99], v[104:107]
  v_mfma_f32_16x16x32_bf16 v[108:111], v[168:171], v[96:99], v[108:111]
  v_mfma_f32_16x16x32_bf16 v[112:115], v[172:175], v[96:99], v[112:115]
  v_mfma_f32_16x16x32_bf16 v[116:119], v[176:179], v[96:99], v[116:119]
  v_mfma_f32_16x16x32_bf16 v[120:123], v[180:183], v[96:99], v[120:123]
  s_add_u32 m0, s21, 155648
  s_add_u32 s89, s21, s24
  s_add_u32 s89, s89, 114688
  buffer_load_dwordx4 v249, s[44:47], s89 offen sc1 lds
  s_waitcnt vmcnt(7) lgkmcnt(0)
  v_mfma_f32_16x16x32_bf16 v[104:107], v[124:127], v[100:103], v[104:107]
  v_mfma_f32_16x16x32_bf16 v[108:111], v[128:131], v[100:103], v[108:111]
  v_mfma_f32_16x16x32_bf16 v[112:115], v[132:135], v[100:103], v[112:115]
  v_mfma_f32_16x16x32_bf16 v[116:119], v[136:139], v[100:103], v[116:119]
  v_mfma_f32_16x16x32_bf16 v[120:123], v[140:143], v[100:103], v[120:123]
  s_lshl_b32 s86, s79, 4
  s_lshl_b32 s87, s10, 1
  s_add_u32 s86, s86, s87
  s_add_u32 s86, s86, s73
  s_lshl_b32 s86, s86, 4
  s_add_u32 s86, s86, 708608
  v_mov_b32 v16, s42
  v_mov_b32 v17, s43
  s_waitcnt vmcnt(63)
  s_mov_b64 exec, 1
  s_cmp_eq_u32 s98, 0
  s_cbranch_scc1 LQ_79
  buffer_store_dwordx2 v[16:17], v248, s[48:51], s86 offen
  s_branch LQ_80
LQ_79:
  buffer_store_dwordx2 v[16:17], v248, s[48:51], s86 offen sc1
LQ_80:
  s_mov_b64 exec, -1
  s_mul_i32 s86, s72, 5120
  s_add_u32 s86, s86, 102400
  v_add_u32 v16, s86, v249
  s_cmp_lg_u32 s73, 0
  s_cbranch_scc1 L_G2W
  ds_write_b128 v16, v[112:115] offset:2048
  ds_write_b128 v16, v[116:119] offset:3072
  s_waitcnt vmcnt(7)
LH_82:
  v_cmp_ne_u64 vcc, s[42:43], v[226:227]
  s_cbranch_vccnz LH_81
LH_83:
LC_84:
  v_max3_u32 v223, v232, v233, v234
  v_max3_u32 v223, v223, v235, v236
  v_max_u32 v223, v223, v237
  v_cmp_eq_u32 vcc, -1, v223
  s_cbranch_vccnz LR_85
LK_86:
  v_lshlrev_b32 v18, 16, v224
  v_and_b32 v19, 0xffff0000, v224
  v_rcp_f32 v19, v19
  s_nop 0
  v_mul_f32 v24, v18, v19
  v_lshlrev_b32 v20, 16, v232
  v_and_b32 v21, 0xffff0000, v232
  v_lshlrev_b32 v22, 16, v233
  v_and_b32 v23, 0xffff0000, v233
  v_pk_fma_f32 v[20:21], v[20:21], v[18:19], v[24:25] op_sel:[0,1,0] op_sel_hi:[1,1,0] neg_lo:[0,0,1] neg_hi:[0,0,1]
  s_add_u32 s89, s21, s24
  s_add_u32 s89, s89, 0
  buffer_load_dwordx4 v[52:55], v249, s[44:47], s89 offen sc1
  v_pk_fma_f32 v[22:23], v[22:23], v[18:19], v[24:25] op_sel:[0,1,0] op_sel_hi:[1,1,0] neg_lo:[0,0,1] neg_hi:[0,0,1]
  v_mov_b32_dpp v184, v208 row_newbcast:1 row_mask:0xf bank_mask:0xf
  v_fmac_f32_dpp v184, v208, v20 row_newbcast:0 row_mask:0xf bank_mask:0xf
  v_mov_b32_dpp v185, v209 row_newbcast:1 row_mask:0xf bank_mask:0xf
  v_fmac_f32_dpp v185, v209, v21 row_newbcast:0 row_mask:0xf bank_mask:0xf
  v_mov_b32_dpp v186, v210 row_newbcast:1 row_mask:0xf bank_mask:0xf
  v_fmac_f32_dpp v186, v210, v22 row_newbcast:0 row_mask:0xf bank_mask:0xf
  v_mov_b32_dpp v187, v211 row_newbcast:1 row_mask:0xf bank_mask:0xf
  v_fmac_f32_dpp v187, v211, v23 row_newbcast:0 row_mask:0xf bank_mask:0xf
  s_add_u32 s89, s21, s24
  s_add_u32 s89, s89, 8192
  buffer_load_dwordx4 v[56:59], v249, s[44:47], s89 offen sc1
  v_lshlrev_b32 v20, 16, v234
  v_and_b32 v21, 0xffff0000, v234
  v_lshlrev_b32 v22, 16, v235
  v_and_b32 v23, 0xffff0000, v235
  v_pk_fma_f32 v[20:21], v[20:21], v[18:19], v[24:25] op_sel:[0,1,0] op_sel_hi:[1,1,0] neg_lo:[0,0,1] neg_hi:[0,0,1]
  v_pk_fma_f32 v[22:23], v[22:23], v[18:19], v[24:25] op_sel:[0,1,0] op_sel_hi:[1,1,0] neg_lo:[0,0,1] neg_hi:[0,0,1]
  v_mov_b32_dpp v192, v208 row_newbcast:3 row_mask:0xf bank_mask:0xf
  v_fmac_f32_dpp v192, v208, v20 row_newbcast:2 row_mask:0xf bank_mask:0xf
  v_mov_b32_dpp v193, v209 row_newbcast:3 row_mask:0xf bank_mask:0xf
  s_add_u32 s89, s21, s24
  s_add_u32 s89, s89, 16384
  buffer_load_dwordx4 v[60:63], v249, s[44:47], s89 offen sc1
  v_fmac_f32_dpp v193, v209, v21 row_newbcast:2 row_mask:0xf bank_mask:0xf
  v_mov_b32_dpp v194, v210 row_newbcast:3 row_mask:0xf bank_mask:0xf
  v_fmac_f32_dpp v194, v210, v22 row_newbcast:2 row_mask:0xf bank_mask:0xf
  v_mov_b32_dpp v195, v211 row_newbcast:3 row_mask:0xf bank_mask:0xf
  v_fmac_f32_dpp v195, v211, v23 row_newbcast:2 row_mask:0xf bank_mask:0xf
  v_lshlrev_b32 v20, 16, v236
  v_and_b32 v21, 0xffff0000, v236
  v_lshlrev_b32 v22, 16, v237
  v_and_b32 v23, 0xffff0000, v237
  s_add_u32 s89, s21, s24
  s_add_u32 s89, s89, 24576
  buffer_load_dwordx4 v[212:215], v249, s[44:47], s89 offen sc1
  v_pk_fma_f32 v[20:21], v[20:21], v[18:19], v[24:25] op_sel:[0,1,0] op_sel_hi:[1,1,0] neg_lo:[0,0,1] neg_hi:[0,0,1]
  v_pk_fma_f32 v[22:23], v[22:23], v[18:19], v[24:25] op_sel:[0,1,0] op_sel_hi:[1,1,0] neg_lo:[0,0,1] neg_hi:[0,0,1]
  v_mov_b32_dpp v200, v208 row_newbcast:5 row_mask:0xf bank_mask:0xf
  v_fmac_f32_dpp v200, v208, v20 row_newbcast:4 row_mask:0xf bank_mask:0xf
  v_mov_b32_dpp v201, v209 row_newbcast:5 row_mask:0xf bank_mask:0xf
  v_fmac_f32_dpp v201, v209, v21 row_newbcast:4 row_mask:0xf bank_mask:0xf
  v_mov_b32_dpp v202, v210 row_newbcast:5 row_mask:0xf bank_mask:0xf
  v_fmac_f32_dpp v202, v210, v22 row_newbcast:4 row_mask:0xf bank_mask:0xf
  v_mov_b32_dpp v203, v211 row_newbcast:5 row_mask:0xf bank_mask:0xf
  v_fmac_f32_dpp v203, v211, v23 row_newbcast:4 row_mask:0xf bank_mask:0xf
  s_waitcnt lgkmcnt(0)
  s_barrier
  ds_read_b128 v[64:67], v16 offset:0
  ds_read_b128 v[68:71], v16 offset:1024
  ds_read_b128 v[72:75], v16 offset:4096
  s_waitcnt lgkmcnt(2)
  v_pk_add_f32 v[40:41], v[104:105], v[64:65]
  v_pk_add_f32 v[42:43], v[106:107], v[66:67]
  s_waitcnt lgkmcnt(1)
  v_pk_add_f32 v[44:45], v[108:109], v[68:69]
  v_pk_add_f32 v[46:47], v[110:111], v[70:71]
  s_waitcnt lgkmcnt(0)
  v_pk_add_f32 v[48:49], v[120:121], v[72:73]
  v_pk_add_f32 v[50:51], v[122:123], v[74:75]
  s_branch L_G2R
L_G2W:
  ds_write_b128 v16, v[104:107] offset:0
  ds_write_b128 v16, v[108:111] offset:1024
  ds_write_b128 v16, v[120:123] offset:4096
  s_waitcnt vmcnt(7)
LH_88:
  v_cmp_ne_u64 vcc, s[42:43], v[226:227]
  s_cbranch_vccnz LH_87
LH_89:
LC_90:
  v_max3_u32 v223, v232, v233, v234
  v_max3_u32 v223, v223, v235, v236
  v_max_u32 v223, v223, v237
  v_cmp_eq_u32 vcc, -1, v223
  s_cbranch_vccnz LR_91
LK_92:
  v_lshlrev_b32 v18, 16, v224
  v_and_b32 v19, 0xffff0000, v224
  v_rcp_f32 v19, v19
  s_nop 0
  v_mul_f32 v24, v18, v19
  v_lshlrev_b32 v20, 16, v232
  v_and_b32 v21, 0xffff0000, v232
  v_lshlrev_b32 v22, 16, v233
  v_and_b32 v23, 0xffff0000, v233
  v_pk_fma_f32 v[20:21], v[20:21], v[18:19], v[24:25] op_sel:[0,1,0] op_sel_hi:[1,1,0] neg_lo:[0,0,1] neg_hi:[0,0,1]
  s_add_u32 s89, s21, s24
  s_add_u32 s89, s89, 0
  buffer_load_dwordx4 v[52:55], v249, s[44:47], s89 offen sc1
  v_pk_fma_f32 v[22:23], v[22:23], v[18:19], v[24:25] op_sel:[0,1,0] op_sel_hi:[1,1,0] neg_lo:[0,0,1] neg_hi:[0,0,1]
  v_mov_b32_dpp v184, v208 row_newbcast:1 row_mask:0xf bank_mask:0xf
  v_fmac_f32_dpp v184, v208, v20 row_newbcast:0 row_mask:0xf bank_mask:0xf
  v_mov_b32_dpp v185, v209 row_newbcast:1 row_mask:0xf bank_mask:0xf
  v_fmac_f32_dpp v185, v209, v21 row_newbcast:0 row_mask:0xf bank_mask:0xf
  v_mov_b32_dpp v186, v210 row_newbcast:1 row_mask:0xf bank_mask:0xf
  v_fmac_f32_dpp v186, v210, v22 row_newbcast:0 row_mask:0xf bank_mask:0xf
  v_mov_b32_dpp v187, v211 row_newbcast:1 row_mask:0xf bank_mask:0xf
  v_fmac_f32_dpp v187, v211, v23 row_newbcast:0 row_mask:0xf bank_mask:0xf
  s_add_u32 s89, s21, s24
  s_add_u32 s89, s89, 8192
  buffer_load_dwordx4 v[56:59], v249, s[44:47], s89 offen sc1
  v_lshlrev_b32 v20, 16, v234
  v_and_b32 v21, 0xffff0000, v234
  v_lshlrev_b32 v22, 16, v235
  v_and_b32 v23, 0xffff0000, v235
  v_pk_fma_f32 v[20:21], v[20:21], v[18:19], v[24:25] op_sel:[0,1,0] op_sel_hi:[1,1,0] neg_lo:[0,0,1] neg_hi:[0,0,1]
  v_pk_fma_f32 v[22:23], v[22:23], v[18:19], v[24:25] op_sel:[0,1,0] op_sel_hi:[1,1,0] neg_lo:[0,0,1] neg_hi:[0,0,1]
  v_mov_b32_dpp v192, v208 row_newbcast:3 row_mask:0xf bank_mask:0xf
  v_fmac_f32_dpp v192, v208, v20 row_newbcast:2 row_mask:0xf bank_mask:0xf
  v_mov_b32_dpp v193, v209 row_newbcast:3 row_mask:0xf bank_mask:0xf
  s_add_u32 s89, s21, s24
  s_add_u32 s89, s89, 16384
  buffer_load_dwordx4 v[60:63], v249, s[44:47], s89 offen sc1
  v_fmac_f32_dpp v193, v209, v21 row_newbcast:2 row_mask:0xf bank_mask:0xf
  v_mov_b32_dpp v194, v210 row_newbcast:3 row_mask:0xf bank_mask:0xf
  v_fmac_f32_dpp v194, v210, v22 row_newbcast:2 row_mask:0xf bank_mask:0xf
  v_mov_b32_dpp v195, v211 row_newbcast:3 row_mask:0xf bank_mask:0xf
  v_fmac_f32_dpp v195, v211, v23 row_newbcast:2 row_mask:0xf bank_mask:0xf
  v_lshlrev_b32 v20, 16, v236
  v_and_b32 v21, 0xffff0000, v236
  v_lshlrev_b32 v22, 16, v237
  v_and_b32 v23, 0xffff0000, v237
  s_add_u32 s89, s21, s24
  s_add_u32 s89, s89, 24576
  buffer_load_dwordx4 v[212:215], v249, s[44:47], s89 offen sc1
  v_pk_fma_f32 v[20:21], v[20:21], v[18:19], v[24:25] op_sel:[0,1,0] op_sel_hi:[1,1,0] neg_lo:[0,0,1] neg_hi:[0,0,1]
  v_pk_fma_f32 v[22:23], v[22:23], v[18:19], v[24:25] op_sel:[0,1,0] op_sel_hi:[1,1,0] neg_lo:[0,0,1] neg_hi:[0,0,1]
  v_mov_b32_dpp v200, v208 row_newbcast:5 row_mask:0xf bank_mask:0xf
  v_fmac_f32_dpp v200, v208, v20 row_newbcast:4 row_mask:0xf bank_mask:0xf
  v_mov_b32_dpp v201, v209 row_newbcast:5 row_mask:0xf bank_mask:0xf
  v_fmac_f32_dpp v201, v209, v21 row_newbcast:4 row_mask:0xf bank_mask:0xf
  v_mov_b32_dpp v202, v210 row_newbcast:5 row_mask:0xf bank_mask:0xf
  v_fmac_f32_dpp v202, v210, v22 row_newbcast:4 row_mask:0xf bank_mask:0xf
  v_mov_b32_dpp v203, v211 row_newbcast:5 row_mask:0xf bank_mask:0xf
  v_fmac_f32_dpp v203, v211, v23 row_newbcast:4 row_mask:0xf bank_mask:0xf
  s_waitcnt lgkmcnt(0)
  s_barrier
  ds_read_b128 v[64:67], v16 offset:2048
  ds_read_b128 v[68:71], v16 offset:3072
  s_waitcnt lgkmcnt(1)
  v_pk_add_f32 v[40:41], v[112:113], v[64:65]
  v_pk_add_f32 v[42:43], v[114:115], v[66:67]
  s_waitcnt lgkmcnt(0)
  v_pk_add_f32 v[44:45], v[116:117], v[68:69]
  v_pk_add_f32 v[46:47], v[118:119], v[70:71]
L_G2R:
  s_lshl_b32 s71, s79, 8
  s_add_u32 s71, s71, 708608
  v_add_u32 v84, 0, v1
  v_min_u32 v84, 15, v84
  v_lshlrev_b32 v84, 4, v84
  buffer_load_dwordx2 v[76:77], v84, s[48:51], s71 offen sc1
  v_pk_add_f32 v[40:41], v[40:41], v[184:185]
  v_pk_add_f32 v[42:43], v[42:43], v[186:187]
  v_pk_add_f32 v[44:45], v[44:45], v[192:193]
  v_pk_add_f32 v[46:47], v[46:47], v[194:195]
  v_cvt_pk_bf16_f32 v240, v40, v41
  v_cvt_pk_bf16_f32 v241, v42, v43
  v_cvt_pk_bf16_f32 v242, v44, v45
  v_cvt_pk_bf16_f32 v243, v46, v47
  s_waitcnt vmcnt(0)
  s_branch LP_95
LP_93:
  buffer_load_dwordx2 v[76:77], v84, s[48:51], s71 offen sc1
  s_waitcnt vmcnt(0)
LP_95:
  v_cmp_ne_u64 vcc, s[42:43], v[76:77]
  s_cbranch_vccz LD_94
  s_add_u32 s95, s95, 1
  s_cmp_gt_u32 s95, 262144
  s_cbranch_scc1 LD_94
  s_sleep 1
  s_branch LP_93
LD_94:
  s_cmp_eq_u32 s98, 0
  s_cbranch_scc1 LQ_96
  buffer_store_dwordx4 v[240:243], v249, s[48:51], s31 offen
  s_branch LQ_97
LQ_96:
  buffer_store_dwordx4 v[240:243], v249, s[48:51], s31 offen sc1
LQ_97:
  v_pk_add_f32 v[20:21], v[40:41], v[42:43]
  v_pk_mul_f32 v[22:23], v[40:41], v[40:41]
  v_pk_fma_f32 v[22:23], v[42:43], v[42:43], v[22:23]
  v_pk_add_f32 v[20:21], v[20:21], v[44:45]
  v_pk_fma_f32 v[22:23], v[44:45], v[44:45], v[22:23]
  v_pk_add_f32 v[20:21], v[20:21], v[46:47]
  v_pk_fma_f32 v[22:23], v[46:47], v[46:47], v[22:23]
  s_cmp_lg_u32 s73, 0
  s_cbranch_scc1 L_G2E
  v_pk_add_f32 v[48:49], v[48:49], v[200:201]
  v_pk_add_f32 v[50:51], v[50:51], v[202:203]
  v_cvt_pk_bf16_f32 v244, v48, v49
  v_cvt_pk_bf16_f32 v245, v50, v51
  s_cmp_eq_u32 s98, 0
  s_cbranch_scc1 LQ_98
  buffer_store_dwordx2 v[244:245], v249, s[48:51], s30 offen
  s_branch LQ_99
LQ_98:
  buffer_store_dwordx2 v[244:245], v249, s[48:51], s30 offen sc1
LQ_99:
  v_pk_add_f32 v[20:21], v[20:21], v[48:49]
  v_pk_fma_f32 v[22:23], v[48:49], v[48:49], v[22:23]
  v_pk_add_f32 v[20:21], v[20:21], v[50:51]
  v_pk_fma_f32 v[22:23], v[50:51], v[50:51], v[22:23]
L_G2E:
  v_add_f32 v16, v20, v21
  v_add_f32 v17, v22, v23
  s_nop 1
  v_permlane32_swap_b32 v16, v17
  v_add_f32 v16, v16, v17
  v_mov_b32 v17, v16
  s_nop 1
  v_permlane16_swap_b32 v16, v17
  v_add_f32 v16, v16, v17
  s_cmp_eq_u32 s98, 0
  s_cbranch_scc1 LQ_100
  buffer_store_dword v16, v12, s[48:51], s32 offen
  s_branch LQ_101
LQ_100:
  buffer_store_dword v16, v12, s[48:51], s32 offen sc1
LQ_101:
  s_lshl_b32 s86, s79, 4
  s_lshl_b32 s87, s10, 1
  s_add_u32 s86, s86, s87
  s_add_u32 s86, s86, s73
  s_lshl_b32 s86, s86, 4
  s_add_u32 s86, s86, 704512
  v_mov_b32 v16, s42
  v_mov_b32 v17, s43
  s_waitcnt vmcnt(0)
  s_mov_b64 exec, 1
  s_cmp_eq_u32 s98, 0
  s_cbranch_scc1 LQ_102
  buffer_store_dwordx2 v[16:17], v248, s[48:51], s86 offen
  s_branch LQ_103
LQ_102:
  buffer_store_dwordx2 v[16:17], v248, s[48:51], s86 offen sc1
LQ_103:
  s_mov_b64 exec, -1
  s_add_u32 m0, s21, 73728
  s_add_u32 s89, s21, s24
  s_add_u32 s89, s89, 32768
  buffer_load_dwordx4 v249, s[44:47], s89 offen sc1 lds
  s_add_u32 m0, s21, 81920
  s_add_u32 s89, s21, s24
  s_add_u32 s89, s89, 40960
  buffer_load_dwordx4 v249, s[44:47], s89 offen sc1 lds
  s_add_u32 m0, s21, 90112
  s_add_u32 s89, s21, s24
  s_add_u32 s89, s89, 49152
  buffer_load_dwordx4 v249, s[44:47], s89 offen sc1 lds
  s_min_u32 s87, s21, 3072
  s_add_u32 m0, s87, 98304
  s_add_u32 s89, s87, s24
  s_add_u32 s89, s89, 57344
  buffer_load_dwordx4 v249, s[44:47], s89 offen sc1 lds
  s_add_u32 s86, s21, 40960
  v_add_u32 v8, s86, v249
  s_waitcnt vmcnt(6)
  ds_write_b128 v8, v[52:55] offset:0
  ds_write_b128 v8, v[56:59] offset:8192
  ds_write_b128 v8, v[60:63] offset:16384
  ds_write_b128 v8, v[212:215] offset:24576
  s_lshr_b32 s82, s16, 4
  s_lshl_b32 s71, s82, 10
  s_add_u32 s71, s71, 698368
  s_lshl_b32 s82, s82, 3
  s_add_u32 s82, s82, s3
  s_mul_i32 s81, s82, 20480
  s_add_u32 s81, s81, 0
  v_add_u32 v14, 40960, v249
  v_add_u32 v15, 102400, v249
  v_mov_b32 v13, 39936
  ds_write_b32 v13, v248
  v_lshlrev_b32 v5, 7, v2
  v_lshl_add_u32 v5, v3, 5, v5
  s_lshl_b32 s83, s82, 11
  s_add_u32 s83, s83, 655360
  s_mul_i32 s86, s19, 384
  s_add_u32 s86, s86, 408576
  v_min_u32 v4, 5, v2
  v_lshlrev_b32 v4, 6, v4
  v_lshl_add_u32 v4, v3, 4, v4
  buffer_load_dwordx4 v[216:219], v4, s[44:47], s86 offen sc1
  v_mov_b32 v12, v5
  v_min_u32 v4, 11, v2
  v_lshrrev_b32 v5, 2, v4
  v_cmp_eq_u32 vcc, 2, v5
  v_lshl_add_u32 v5, v5, 4, s76
  v_mov_b32 v10, s13
  v_cndmask_b32 v5, v5, v10, vcc
  v_lshl_add_u32 v5, v3, 2, v5
  v_and_b32 v10, 2, v4
  v_add_lshl_u32 v5, v5, v10, 3
  v_and_b32 v10, 1, v4
  v_mul_u32_u24 v10, 30720, v10
  v_add_u32 v10, v10, v5
  s_lshl_b32 s71, s82, 8
  s_add_u32 s71, s71, 704512
  s_barrier
  s_add_u32 m0, s21, 102400
  s_add_u32 s89, s21, s24
  s_add_u32 s89, s89, 61440
  buffer_load_dwordx4 v249, s[44:47], s89 offen sc1 lds
  s_add_u32 m0, s21, 110592
  s_add_u32 s89, s21, s24
  s_add_u32 s89, s89, 69632
  buffer_load_dwordx4 v249, s[44:47], s89 offen sc1 lds
  s_min_u32 s87, s21, 3072
  s_add_u32 m0, s87, 118784
  s_add_u32 s89, s87, s24
  s_add_u32 s89, s89, 77824
  buffer_load_dwordx4 v249, s[44:47], s89 offen sc1 lds
  v_add_u32 v48, 0, v1
  v_min_u32 v48, 15, v48
  v_lshlrev_b32 v48, 4, v48
  buffer_load_dwordx2 v[40:41], v48, s[48:51], s71 offen sc1
  s_waitcnt vmcnt(0) lgkmcnt(0)
  s_barrier
  s_branch LP_106
LP_104:
  buffer_load_dwordx2 v[40:41], v48, s[48:51], s71 offen sc1
  s_waitcnt vmcnt(0)
LP_106:
  v_cmp_ne_u64 vcc, s[42:43], v[40:41]
  s_cbranch_vccz LD_105
  s_add_u32 s95, s95, 1
  s_cmp_gt_u32 s95, 262144
  s_cbranch_scc1 LD_105
  s_sleep 1
  s_branch LP_104
LD_105:
  buffer_load_dwordx4 v[56:59], v249, s[48:51], s81 offen offset:0 sc1
  buffer_load_dwordx4 v[60:63], v249, s[48:51], s81 offen offset:1024 sc1
  buffer_load_dwordx4 v[64:67], v249, s[48:51], s81 offen offset:2048 sc1
  buffer_load_dwordx4 v[68:71], v249, s[48:51], s81 offen offset:3072 sc1
  s_add_u32 s81, s81, 4096
  buffer_load_dwordx4 v[72:75], v249, s[48:51], s81 offen offset:0 sc1
  buffer_load_dwordx4 v[76:79], v249, s[48:51], s81 offen offset:1024 sc1
  buffer_load_dwordx4 v[80:83], v249, s[48:51], s81 offen offset:2048 sc1
  buffer_load_dwordx4 v[84:87], v249, s[48:51], s81 offen offset:3072 sc1
  ds_read_b128 v[144:147], v14 offset:0
  ds_read_b128 v[148:151], v14 offset:1024
  ds_read_b128 v[152:155], v14 offset:2048
  ds_read_b128 v[156:159], v14 offset:3072
  ds_read_b128 v[160:163], v14 offset:4096
  ds_read_b128 v[164:167], v14 offset:5120
  ds_read_b128 v[168:171], v14 offset:6144
  ds_read_b128 v[172:175], v14 offset:7168
  ds_read_b128 v[176:179], v14 offset:8192
  ds_read_b128 v[180:183], v14 offset:9216
  ds_read_b128 v[184:187], v14 offset:10240
  ds_read_b128 v[188:191], v14 offset:11264
  s_add_u32 s81, s81, 4096
  buffer_load_dwordx4 v[88:91], v249, s[48:51], s81 offen offset:0 sc1
  s_waitcnt vmcnt(8) lgkmcnt(6)
  v_mfma_f32_16x16x32_bf16 v[16:19], v[144:147], v[56:59], 0
  ds_read_b128 v[192:195], v14 offset:12288
  v_mfma_f32_16x16x32_bf16 v[20:23], v[148:151], v[56:59], 0
  ds_read_b128 v[196:199], v14 offset:13312
  v_mfma_f32_16x16x32_bf16 v[24:27], v[152:155], v[56:59], 0
  ds_read_b128 v[200:203], v14 offset:14336
  v_mfma_f32_16x16x32_bf16 v[28:31], v[156:159], v[56:59], 0
  ds_read_b128 v[204:207], v14 offset:15360
  v_mfma_f32_16x16x32_bf16 v[32:35], v[160:163], v[56:59], 0
  ds_read_b128 v[208:211], v14 offset:16384
  v_mfma_f32_16x16x32_bf16 v[36:39], v[164:167], v[56:59], 0
  ds_read_b128 v[212:215], v14 offset:17408
  buffer_load_dwordx4 v[56:59], v249, s[48:51], s81 offen offset:1024 sc1
  buffer_load_dwordx4 v[224:227], v12, s[48:51], s83 offen sc1
  buffer_load_dwordx4 v[228:231], v12, s[48:51], s83 offen offset:16 sc1
  s_mov_b32 s86, 173056
  buffer_load_dwordx4 v[136:139], v10, s[44:47], s86 offen sc1
  s_waitcnt vmcnt(11) lgkmcnt(6)
  v_mfma_f32_16x16x32_bf16 v[16:19], v[168:171], v[60:63], v[16:19]
  ds_read_b128 v[144:147], v14 offset:18432
  v_mfma_f32_16x16x32_bf16 v[20:23], v[172:175], v[60:63], v[20:23]
  ds_read_b128 v[148:151], v14 offset:19456
  v_mfma_f32_16x16x32_bf16 v[24:27], v[176:179], v[60:63], v[24:27]
  ds_read_b128 v[152:155], v14 offset:20480
  v_mfma_f32_16x16x32_bf16 v[28:31], v[180:183], v[60:63], v[28:31]
  ds_read_b128 v[156:159], v14 offset:21504
  v_mfma_f32_16x16x32_bf16 v[32:35], v[184:187], v[60:63], v[32:35]
  ds_read_b128 v[160:163], v14 offset:22528
  v_mfma_f32_16x16x32_bf16 v[36:39], v[188:191], v[60:63], v[36:39]
  ds_read_b128 v[164:167], v14 offset:23552
  buffer_load_dwordx4 v[60:63], v249, s[48:51], s81 offen offset:2048 sc1
  s_waitcnt vmcnt(11) lgkmcnt(6)
  v_mfma_f32_16x16x32_bf16 v[16:19], v[192:195], v[64:67], v[16:19]
  ds_read_b128 v[168:171], v14 offset:24576
  v_mfma_f32_16x16x32_bf16 v[20:23], v[196:199], v[64:67], v[20:23]
  ds_read_b128 v[172:175], v14 offset:25600
  v_mfma_f32_16x16x32_bf16 v[24:27], v[200:203], v[64:67], v[24:27]
  ds_read_b128 v[176:179], v14 offset:26624
  v_mfma_f32_16x16x32_bf16 v[28:31], v[204:207], v[64:67], v[28:31]
  ds_read_b128 v[180:183], v14 offset:27648
  v_mfma_f32_16x16x32_bf16 v[32:35], v[208:211], v[64:67], v[32:35]
  ds_read_b128 v[184:187], v14 offset:28672
  v_mfma_f32_16x16x32_bf16 v[36:39], v[212:215], v[64:67], v[36:39]
  ds_read_b128 v[188:191], v14 offset:29696
  buffer_load_dwordx4 v[64:67], v249, s[48:51], s81 offen offset:3072 sc1
  s_waitcnt vmcnt(11) lgkmcnt(6)
  v_mfma_f32_16x16x32_bf16 v[16:19], v[144:147], v[68:71], v[16:19]
  ds_read_b128 v[192:195], v14 offset:30720
  v_mfma_f32_16x16x32_bf16 v[20:23], v[148:151], v[68:71], v[20:23]
  ds_read_b128 v[196:199], v14 offset:31744
  v_mfma_f32_16x16x32_bf16 v[24:27], v[152:155], v[68:71], v[24:27]
  ds_read_b128 v[200:203], v14 offset:32768
  v_mfma_f32_16x16x32_bf16 v[28:31], v[156:159], v[68:71], v[28:31]
  ds_read_b128 v[204:207], v14 offset:33792
  v_mfma_f32_16x16x32_bf16 v[32:35], v[160:163], v[68:71], v[32:35]
  ds_read_b128 v[208:211], v14 offset:34816
  v_mfma_f32_16x16x32_bf16 v[36:39], v[164:167], v[68:71], v[36:39]
  ds_read_b128 v[212:215], v14 offset:35840
  s_add_u32 s81, s81, 4096
  buffer_load_dwordx4 v[68:71], v249, s[48:51], s81 offen offset:0 sc1
  s_waitcnt vmcnt(11) lgkmcnt(6)
  v_mfma_f32_16x16x32_bf16 v[16:19], v[168:171], v[72:75], v[16:19]
  ds_read_b128 v[144:147], v14 offset:36864
  v_mfma_f32_16x16x32_bf16 v[20:23], v[172:175], v[72:75], v[20:23]
  ds_read_b128 v[148:151], v14 offset:37888
  v_mfma_f32_16x16x32_bf16 v[24:27], v[176:179], v[72:75], v[24:27]
  ds_read_b128 v[152:155], v14 offset:38912
  v_mfma_f32_16x16x32_bf16 v[28:31], v[180:183], v[72:75], v[28:31]
  ds_read_b128 v[156:159], v14 offset:39936
  v_mfma_f32_16x16x32_bf16 v[32:35], v[184:187], v[72:75], v[32:35]
  ds_read_b128 v[160:163], v14 offset:40960
  v_mfma_f32_16x16x32_bf16 v[36:39], v[188:191], v[72:75], v[36:39]
  ds_read_b128 v[164:167], v14 offset:41984
  buffer_load_dwordx4 v[72:75], v249, s[48:51], s81 offen offset:1024 sc1
  s_waitcnt vmcnt(11) lgkmcnt(6)
  v_mfma_f32_16x16x32_bf16 v[16:19], v[192:195], v[76:79], v[16:19]
  ds_read_b128 v[168:171], v14 offset:43008
  v_mfma_f32_16x16x32_bf16 v[20:23], v[196:199], v[76:79], v[20:23]
  ds_read_b128 v[172:175], v14 offset:44032
  v_mfma_f32_16x16x32_bf16 v[24:27], v[200:203], v[76:79], v[24:27]
  ds_read_b128 v[176:179], v14 offset:45056
  v_mfma_f32_16x16x32_bf16 v[28:31], v[204:207], v[76:79], v[28:31]
  ds_read_b128 v[180:183], v14 offset:46080
  v_mfma_f32_16x16x32_bf16 v[32:35], v[208:211], v[76:79], v[32:35]
  ds_read_b128 v[184:187], v14 offset:47104
  v_mfma_f32_16x16x32_bf16 v[36:39], v[212:215], v[76:79], v[36:39]
  ds_read_b128 v[188:191], v14 offset:48128
  buffer_load_dwordx4 v[76:79], v249, s[48:51], s81 offen offset:2048 sc1
  s_waitcnt vmcnt(11) lgkmcnt(6)
  v_mfma_f32_16x16x32_bf16 v[16:19], v[144:147], v[80:83], v[16:19]
  ds_read_b128 v[192:195], v14 offset:49152
  v_mfma_f32_16x16x32_bf16 v[20:23], v[148:151], v[80:83], v[20:23]
  ds_read_b128 v[196:199], v14 offset:50176
  v_mfma_f32_16x16x32_bf16 v[24:27], v[152:155], v[80:83], v[24:27]
  ds_read_b128 v[200:203], v14 offset:51200
  v_mfma_f32_16x16x32_bf16 v[28:31], v[156:159], v[80:83], v[28:31]
  ds_read_b128 v[204:207], v14 offset:52224
  v_mfma_f32_16x16x32_bf16 v[32:35], v[160:163], v[80:83], v[32:35]
  ds_read_b128 v[208:211], v14 offset:53248
  v_mfma_f32_16x16x32_bf16 v[36:39], v[164:167], v[80:83], v[36:39]
  ds_read_b128 v[212:215], v14 offset:54272
  buffer_load_dwordx4 v[80:83], v249, s[48:51], s81 offen offset:3072 sc1
  s_waitcnt vmcnt(11) lgkmcnt(6)
  v_mfma_f32_16x16x32_bf16 v[16:19], v[168:171], v[84:87], v[16:19]
  ds_read_b128 v[144:147], v14 offset:55296
  v_mfma_f32_16x16x32_bf16 v[20:23], v[172:175], v[84:87], v[20:23]
  ds_read_b128 v[148:151], v14 offset:56320
  v_mfma_f32_16x16x32_bf16 v[24:27], v[176:179], v[84:87], v[24:27]
  ds_read_b128 v[152:155], v14 offset:57344
  v_mfma_f32_16x16x32_bf16 v[28:31], v[180:183], v[84:87], v[28:31]
  ds_read_b128 v[156:159], v14 offset:58368
  v_mfma_f32_16x16x32_bf16 v[32:35], v[184:187], v[84:87], v[32:35]
  ds_read_b128 v[160:163], v14 offset:59392
  v_mfma_f32_16x16x32_bf16 v[36:39], v[188:191], v[84:87], v[36:39]
  ds_read_b128 v[164:167], v14 offset:60416
  s_add_u32 s81, s81, 4096
  buffer_load_dwordx4 v[84:87], v249, s[48:51], s81 offen offset:0 sc1
  s_waitcnt vmcnt(11) lgkmcnt(6)
  v_mfma_f32_16x16x32_bf16 v[16:19], v[192:195], v[88:91], v[16:19]
  ds_read_b128 v[168:171], v15 offset:0
  v_mfma_f32_16x16x32_bf16 v[20:23], v[196:199], v[88:91], v[20:23]
  ds_read_b128 v[172:175], v15 offset:1024
  v_mfma_f32_16x16x32_bf16 v[24:27], v[200:203], v[88:91], v[24:27]
  ds_read_b128 v[176:179], v15 offset:2048
  v_mfma_f32_16x16x32_bf16 v[28:31], v[204:207], v[88:91], v[28:31]
  ds_read_b128 v[180:183], v15 offset:3072
  v_mfma_f32_16x16x32_bf16 v[32:35], v[208:211], v[88:91], v[32:35]
  ds_read_b128 v[184:187], v15 offset:4096
  v_mfma_f32_16x16x32_bf16 v[36:39], v[212:215], v[88:91], v[36:39]
  ds_read_b128 v[188:191], v15 offset:5120
  buffer_load_dwordx4 v[88:91], v249, s[48:51], s81 offen offset:1024 sc1
  s_waitcnt vmcnt(11) lgkmcnt(6)
  v_mfma_f32_16x16x32_bf16 v[16:19], v[144:147], v[56:59], v[16:19]
  ds_read_b128 v[192:195], v15 offset:6144
  v_mfma_f32_16x16x32_bf16 v[20:23], v[148:151], v[56:59], v[20:23]
  ds_read_b128 v[196:199], v15 offset:7168
  v_mfma_f32_16x16x32_bf16 v[24:27], v[152:155], v[56:59], v[24:27]
  ds_read_b128 v[200:203], v15 offset:8192
  v_mfma_f32_16x16x32_bf16 v[28:31], v[156:159], v[56:59], v[28:31]
  ds_read_b128 v[204:207], v15 offset:9216
  v_mfma_f32_16x16x32_bf16 v[32:35], v[160:163], v[56:59], v[32:35]
  ds_read_b128 v[208:211], v15 offset:10240
  v_mfma_f32_16x16x32_bf16 v[36:39], v[164:167], v[56:59], v[36:39]
  ds_read_b128 v[212:215], v15 offset:11264
  buffer_load_dwordx4 v[56:59], v249, s[48:51], s81 offen offset:2048 sc1
  s_add_u32 m0, s21, 0
  s_add_u32 s89, s21, s25
  s_add_u32 s89, s89, 0
  buffer_load_dwordx4 v249, s[44:47], s89 offen sc1 lds
  s_add_u32 m0, s21, 8192
  s_add_u32 s89, s21, s25
  s_add_u32 s89, s89, 8192
  buffer_load_dwordx4 v249, s[44:47], s89 offen sc1 lds
  s_waitcnt vmcnt(10) lgkmcnt(6)
  v_mfma_f32_16x16x32_bf16 v[16:19], v[168:171], v[60:63], v[16:19]
  ds_read_b128 v[144:147], v15 offset:12288
  v_mfma_f32_16x16x32_bf16 v[20:23], v[172:175], v[60:63], v[20:23]
  ds_read_b128 v[148:151], v15 offset:13312
  v_mfma_f32_16x16x32_bf16 v[24:27], v[176:179], v[60:63], v[24:27]
  ds_read_b128 v[152:155], v15 offset:14336
  v_mfma_f32_16x16x32_bf16 v[28:31], v[180:183], v[60:63], v[28:31]
  ds_read_b128 v[156:159], v15 offset:15360
  v_mfma_f32_16x16x32_bf16 v[32:35], v[184:187], v[60:63], v[32:35]
  ds_read_b128 v[160:163], v15 offset:16384
  v_mfma_f32_16x16x32_bf16 v[36:39], v[188:191], v[60:63], v[36:39]
  ds_read_b128 v[164:167], v15 offset:17408
  buffer_load_dwordx4 v[60:63], v249, s[48:51], s81 offen offset:3072 sc1
  s_add_u32 m0, s21, 16384
  s_add_u32 s89, s21, s25
  s_add_u32 s89, s89, 16384
  buffer_load_dwordx4 v249, s[44:47], s89 offen sc1 lds
  s_add_u32 m0, s21, 24576
  s_add_u32 s89, s21, s25
  s_add_u32 s89, s89, 24576
  buffer_load_dwordx4 v249, s[44:47], s89 offen sc1 lds
  s_waitcnt vmcnt(12) lgkmcnt(6)
  v_mfma_f32_16x16x32_bf16 v[16:19], v[192:195], v[64:67], v[16:19]
  ds_read_b128 v[168:171], v15 offset:18432
  v_mfma_f32_16x16x32_bf16 v[20:23], v[196:199], v[64:67], v[20:23]
  ds_read_b128 v[172:175], v15 offset:19456
  v_mfma_f32_16x16x32_bf16 v[24:27], v[200:203], v[64:67], v[24:27]
  ds_read_b128 v[176:179], v15 offset:20480
  v_mfma_f32_16x16x32_bf16 v[28:31], v[204:207], v[64:67], v[28:31]
  ds_read_b128 v[180:183], v15 offset:21504
  v_mfma_f32_16x16x32_bf16 v[32:35], v[208:211], v[64:67], v[32:35]
  ds_read_b128 v[184:187], v15 offset:22528
  v_mfma_f32_16x16x32_bf16 v[36:39], v[212:215], v[64:67], v[36:39]
  ds_read_b128 v[188:191], v15 offset:23552
  s_min_u32 s87, s21, 6144
  s_add_u32 m0, s87, 32768
  s_add_u32 s89, s87, s25
  s_add_u32 s89, s89, 32768
  buffer_load_dwordx4 v249, s[44:47], s89 offen sc1 lds
  s_add_u32 s89, s25, 39936
  buffer_load_dwordx4 v[132:135], v249, s[44:47], s89 offen sc1
  s_waitcnt vmcnt(13) lgkmcnt(6)
  v_mfma_f32_16x16x32_bf16 v[16:19], v[144:147], v[68:71], v[16:19]
  ds_read_b128 v[192:195], v15 offset:24576
  v_mfma_f32_16x16x32_bf16 v[20:23], v[148:151], v[68:71], v[20:23]
  ds_read_b128 v[196:199], v15 offset:25600
  v_mfma_f32_16x16x32_bf16 v[24:27], v[152:155], v[68:71], v[24:27]
  ds_read_b128 v[200:203], v15 offset:26624
  v_mfma_f32_16x16x32_bf16 v[28:31], v[156:159], v[68:71], v[28:31]
  ds_read_b128 v[204:207], v15 offset:27648
  v_mfma_f32_16x16x32_bf16 v[32:35], v[160:163], v[68:71], v[32:35]
  ds_read_b128 v[208:211], v15 offset:28672
  v_mfma_f32_16x16x32_bf16 v[36:39], v[164:167], v[68:71], v[36:39]
  ds_read_b128 v[212:215], v15 offset:29696
  s_add_u32 s89, s21, s25
  s_add_u32 s89, s89, 40960
  buffer_load_dwordx4 v[92:95], v249, s[44:47], s89 offen sc1
  s_add_u32 s89, s21, s25
  s_add_u32 s89, s89, 49152
  buffer_load_dwordx4 v[96:99], v249, s[44:47], s89 offen sc1
  s_waitcnt vmcnt(14) lgkmcnt(6)
  v_mfma_f32_16x16x32_bf16 v[16:19], v[168:171], v[72:75], v[16:19]
  ds_read_b128 v[144:147], v15 offset:30720
  v_mfma_f32_16x16x32_bf16 v[20:23], v[172:175], v[72:75], v[20:23]
  ds_read_b128 v[148:151], v15 offset:31744
  v_mfma_f32_16x16x32_bf16 v[24:27], v[176:179], v[72:75], v[24:27]
  ds_read_b128 v[152:155], v15 offset:32768
  v_mfma_f32_16x16x32_bf16 v[28:31], v[180:183], v[72:75], v[28:31]
  ds_read_b128 v[156:159], v15 offset:33792
  v_mfma_f32_16x16x32_bf16 v[32:35], v[184:187], v[72:75], v[32:35]
  ds_read_b128 v[160:163], v15 offset:34816
  v_mfma_f32_16x16x32_bf16 v[36:39], v[188:191], v[72:75], v[36:39]
  ds_read_b128 v[164:167], v15 offset:35840
  s_add_u32 s89, s21, s25
  s_add_u32 s89, s89, 57344
  buffer_load_dwordx4 v[100:103], v249, s[44:47], s89 offen sc1
  s_add_u32 s89, s21, s25
  s_add_u32 s89, s89, 65536
  buffer_load_dwordx4 v[104:107], v249, s[44:47], s89 offen sc1
  s_waitcnt vmcnt(15) lgkmcnt(6)
  v_mfma_f32_16x16x32_bf16 v[16:19], v[192:195], v[76:79], v[16:19]
  ds_read_b128 v[168:171], v15 offset:36864
  v_mfma_f32_16x16x32_bf16 v[20:23], v[196:199], v[76:79], v[20:23]
  ds_read_b128 v[172:175], v15 offset:37888
  v_mfma_f32_16x16x32_bf16 v[24:27], v[200:203], v[76:79], v[24:27]
  ds_read_b128 v[176:179], v15 offset:38912
  v_mfma_f32_16x16x32_bf16 v[28:31], v[204:207], v[76:79], v[28:31]
  ds_read_b128 v[180:183], v15 offset:39936
  v_mfma_f32_16x16x32_bf16 v[32:35], v[208:211], v[76:79], v[32:35]
  ds_read_b128 v[184:187], v15 offset:40960
  v_mfma_f32_16x16x32_bf16 v[36:39], v[212:215], v[76:79], v[36:39]
  ds_read_b128 v[188:191], v15 offset:41984
  s_add_u32 s89, s21, s25
  s_add_u32 s89, s89, 73728
  buffer_load_dwordx4 v[108:111], v249, s[44:47], s89 offen sc1
  s_add_u32 s89, s21, s25
  s_add_u32 s89, s89, 81920
  buffer_load_dwordx4 v[112:115], v249, s[44:47], s89 offen sc1
  s_waitcnt vmcnt(16) lgkmcnt(6)
  v_mfma_f32_16x16x32_bf16 v[16:19], v[144:147], v[80:83], v[16:19]
  ds_read_b128 v[192:195], v15 offset:43008
  v_mfma_f32_16x16x32_bf16 v[20:23], v[148:151], v[80:83], v[20:23]
  ds_read_b128 v[196:199], v15 offset:44032
  v_mfma_f32_16x16x32_bf16 v[24:27], v[152:155], v[80:83], v[24:27]
  ds_read_b128 v[200:203], v15 offset:45056
  v_mfma_f32_16x16x32_bf16 v[28:31], v[156:159], v[80:83], v[28:31]
  ds_read_b128 v[204:207], v15 offset:46080
  v_mfma_f32_16x16x32_bf16 v[32:35], v[160:163], v[80:83], v[32:35]
  ds_read_b128 v[208:211], v15 offset:47104
  v_mfma_f32_16x16x32_bf16 v[36:39], v[164:167], v[80:83], v[36:39]
  ds_read_b128 v[212:215], v15 offset:48128
  s_add_u32 s89, s21, s25
  s_add_u32 s89, s89, 90112
  buffer_load_dwordx4 v[116:119], v249, s[44:47], s89 offen sc1
  s_waitcnt vmcnt(16) lgkmcnt(6)
  v_mfma_f32_16x16x32_bf16 v[16:19], v[168:171], v[84:87], v[16:19]
  ds_read_b128 v[144:147], v15 offset:49152
  v_mfma_f32_16x16x32_bf16 v[20:23], v[172:175], v[84:87], v[20:23]
  ds_read_b128 v[148:151], v15 offset:50176
  v_mfma_f32_16x16x32_bf16 v[24:27], v[176:179], v[84:87], v[24:27]
  ds_read_b128 v[152:155], v15 offset:51200
  v_mfma_f32_16x16x32_bf16 v[28:31], v[180:183], v[84:87], v[28:31]
  ds_read_b128 v[156:159], v15 offset:52224
  v_mfma_f32_16x16x32_bf16 v[32:35], v[184:187], v[84:87], v[32:35]
  ds_read_b128 v[160:163], v15 offset:53248
  v_mfma_f32_16x16x32_bf16 v[36:39], v[188:191], v[84:87], v[36:39]
  ds_read_b128 v[164:167], v15 offset:54272
  s_add_u32 s89, s21, s25
  s_add_u32 s89, s89, 98304
  buffer_load_dwordx4 v[120:123], v249, s[44:47], s89 offen sc1
  s_waitcnt vmcnt(16) lgkmcnt(6)
  v_mfma_f32_16x16x32_bf16 v[16:19], v[192:195], v[88:91], v[16:19]
  ds_read_b128 v[168:171], v15 offset:55296
  v_mfma_f32_16x16x32_bf16 v[20:23], v[196:199], v[88:91], v[20:23]
  ds_read_b128 v[172:175], v15 offset:56320
  v_mfma_f32_16x16x32_bf16 v[24:27], v[200:203], v[88:91], v[24:27]
  ds_read_b128 v[176:179], v15 offset:57344
  v_mfma_f32_16x16x32_bf16 v[28:31], v[204:207], v[88:91], v[28:31]
  ds_read_b128 v[180:183], v15 offset:58368
  v_mfma_f32_16x16x32_bf16 v[32:35], v[208:211], v[88:91], v[32:35]
  ds_read_b128 v[184:187], v15 offset:59392
  v_mfma_f32_16x16x32_bf16 v[36:39], v[212:215], v[88:91], v[36:39]
  ds_read_b128 v[188:191], v15 offset:60416
  s_add_u32 s89, s21, s25
  s_add_u32 s89, s89, 106496
  buffer_load_dwordx4 v[124:127], v249, s[44:47], s89 offen sc1
  s_waitcnt vmcnt(16) lgkmcnt(6)
  v_mfma_f32_16x16x32_bf16 v[16:19], v[144:147], v[56:59], v[16:19]
  v_mfma_f32_16x16x32_bf16 v[20:23], v[148:151], v[56:59], v[20:23]
  v_mfma_f32_16x16x32_bf16 v[24:27], v[152:155], v[56:59], v[24:27]
  v_mfma_f32_16x16x32_bf16 v[28:31], v[156:159], v[56:59], v[28:31]
  v_mfma_f32_16x16x32_bf16 v[32:35], v[160:163], v[56:59], v[32:35]
  v_mfma_f32_16x16x32_bf16 v[36:39], v[164:167], v[56:59], v[36:39]
  s_add_u32 s89, s21, s25
  s_add_u32 s89, s89, 114688
  buffer_load_dwordx4 v[128:131], v249, s[44:47], s89 offen sc1
  s_waitcnt vmcnt(14) lgkmcnt(0)
  v_mfma_f32_16x16x32_bf16 v[16:19], v[168:171], v[60:63], v[16:19]
  v_mfma_f32_16x16x32_bf16 v[20:23], v[172:175], v[60:63], v[20:23]
  v_mfma_f32_16x16x32_bf16 v[24:27], v[176:179], v[60:63], v[24:27]
  v_mfma_f32_16x16x32_bf16 v[28:31], v[180:183], v[60:63], v[28:31]
  v_mfma_f32_16x16x32_bf16 v[32:35], v[184:187], v[60:63], v[32:35]
  v_mfma_f32_16x16x32_bf16 v[36:39], v[188:191], v[60:63], v[36:39]
  v_mov_b32 v52, 1
  s_mov_b64 exec, 1
  ds_add_u32 v13, v52
  s_mov_b64 exec, -1
  v_add_f32 v40, v224, v226
  v_add_f32 v41, v225, v227
  v_add_f32 v42, v228, v230
  v_add_f32 v43, v229, v231
  v_add_f32 v40, v40, v42
  v_add_f32 v41, v41, v43
  s_nop 1
  v_permlane32_swap_b32 v40, v41
  v_add_f32 v40, v40, v41
  v_mov_b32 v41, v40
  s_nop 1
  v_permlane16_swap_b32 v40, v41
  v_add_f32 v40, v40, v41
  v_mov_b32 v41, v40
  s_nop 1
  v_permlane32_swap_b32 v40, v41
  v_mul_f32 v40, 0x3acccccd, v40
  v_mul_f32 v41, 0x3acccccd, v41
  v_fma_f32 v41, -v40, v40, v41
  v_max_f32 v41, 0, v41
  v_cvt_pk_bf16_f32 v41, v41, v41
  v_and_b32 v41, 0xffff0000, v41
  v_add_f32 v41, 0x3727c5ac, v41
  v_cvt_pk_bf16_f32 v41, v41, v41
  v_and_b32 v41, 0xffff0000, v41
  v_sqrt_f32 v41, v41
  s_nop 0
  v_cvt_pk_bf16_f32 v41, v41, v41
  v_and_b32 v41, 0xffff0000, v41
  v_cvt_pk_bf16_f32 v40, v40, v40
  v_and_b32 v40, 0xffff0000, v40
  v_rcp_f32 v41, v41
  s_nop 0
  v_mul_f32 v40, v40, v41
  v_sub_f32 v42, 0, v40
  v_mul_f32 v16, v41, v16
  v_mul_f32 v17, v41, v17
  v_mul_f32 v18, v41, v18
  v_mul_f32 v19, v41, v19
  v_mul_f32 v20, v41, v20
  v_mul_f32 v21, v41, v21
  v_mul_f32 v22, v41, v22
  v_mul_f32 v23, v41, v23
  v_fmac_f32_dpp v16, v216, v42 row_newbcast:0 row_mask:0xf bank_mask:0xf
  v_fmac_f32_dpp v17, v217, v42 row_newbcast:0 row_mask:0xf bank_mask:0xf
  v_fmac_f32_dpp v18, v218, v42 row_newbcast:0 row_mask:0xf bank_mask:0xf
  v_fmac_f32_dpp v19, v219, v42 row_newbcast:0 row_mask:0xf bank_mask:0xf
  v_fmac_f32_dpp v20, v216, v42 row_newbcast:1 row_mask:0xf bank_mask:0xf
  v_fmac_f32_dpp v21, v217, v42 row_newbcast:1 row_mask:0xf bank_mask:0xf
  v_fmac_f32_dpp v22, v218, v42 row_newbcast:1 row_mask:0xf bank_mask:0xf
  v_fmac_f32_dpp v23, v219, v42 row_newbcast:1 row_mask:0xf bank_mask:0xf
  v_mul_f32 v44, v16, v16
  v_mul_f32 v45, v17, v17
  v_mul_f32 v46, v18, v18
  v_mul_f32 v47, v19, v19
  v_mul_f32 v48, v20, v20
  v_mul_f32 v49, v21, v21
  v_mul_f32 v50, v22, v22
  v_mul_f32 v51, v23, v23
  v_fmaak_f32 v44, v250, v44, 0xc0135761
  v_fmaak_f32 v45, v250, v45, 0xc0135761
  v_fmaak_f32 v46, v250, v46, 0xc0135761
  v_fmaak_f32 v47, v250, v47, 0xc0135761
  v_fmaak_f32 v48, v250, v48, 0xc0135761
  v_fmaak_f32 v49, v250, v49, 0xc0135761
  v_fmaak_f32 v50, v250, v50, 0xc0135761
  v_fmaak_f32 v51, v250, v51, 0xc0135761
  v_mul_f32 v44, v44, v16
  v_mul_f32 v45, v45, v17
  v_mul_f32 v46, v46, v18
  v_mul_f32 v47, v47, v19
  v_mul_f32 v48, v48, v20
  v_mul_f32 v49, v49, v21
  v_mul_f32 v50, v50, v22
  v_mul_f32 v51, v51, v23
  v_exp_f32 v44, v44
  v_exp_f32 v45, v45
  v_exp_f32 v46, v46
  v_exp_f32 v47, v47
  v_exp_f32 v48, v48
  v_exp_f32 v49, v49
  v_exp_f32 v50, v50
  v_exp_f32 v51, v51
  v_add_f32 v44, 1.0, v44
  v_add_f32 v45, 1.0, v45
  v_add_f32 v46, 1.0, v46
  v_add_f32 v47, 1.0, v47
  v_add_f32 v48, 1.0, v48
  v_add_f32 v49, 1.0, v49
  v_add_f32 v50, 1.0, v50
  v_add_f32 v51, 1.0, v51
  v_rcp_f32 v44, v44
  v_rcp_f32 v45, v45
  v_rcp_f32 v46, v46
  v_rcp_f32 v47, v47
  v_rcp_f32 v48, v48
  v_rcp_f32 v49, v49
  v_rcp_f32 v50, v50
  v_rcp_f32 v51, v51
  v_mul_f32 v16, v16, v44
  v_mul_f32 v17, v17, v45
  v_mul_f32 v18, v18, v46
  v_mul_f32 v19, v19, v47
  v_mul_f32 v20, v20, v48
  v_mul_f32 v21, v21, v49
  v_mul_f32 v22, v22, v50
  v_mul_f32 v23, v23, v51
  v_cvt_pk_bf16_f32 v64, v16, v17
  v_cvt_pk_bf16_f32 v65, v18, v19
  v_cvt_pk_bf16_f32 v66, v20, v21
  v_cvt_pk_bf16_f32 v67, v22, v23
  buffer_store_dwordx4 v[64:67], v249, s[48:51], s33 offen offset:0 sc1
  v_mul_f32 v24, v41, v24
  v_mul_f32 v25, v41, v25
  v_mul_f32 v26, v41, v26
  v_mul_f32 v27, v41, v27
  v_mul_f32 v28, v41, v28
  v_mul_f32 v29, v41, v29
  v_mul_f32 v30, v41, v30
  v_mul_f32 v31, v41, v31
  v_fmac_f32_dpp v24, v216, v42 row_newbcast:2 row_mask:0xf bank_mask:0xf
  v_fmac_f32_dpp v25, v217, v42 row_newbcast:2 row_mask:0xf bank_mask:0xf
  v_fmac_f32_dpp v26, v218, v42 row_newbcast:2 row_mask:0xf bank_mask:0xf
  v_fmac_f32_dpp v27, v219, v42 row_newbcast:2 row_mask:0xf bank_mask:0xf
  v_fmac_f32_dpp v28, v216, v42 row_newbcast:3 row_mask:0xf bank_mask:0xf
  v_fmac_f32_dpp v29, v217, v42 row_newbcast:3 row_mask:0xf bank_mask:0xf
  v_fmac_f32_dpp v30, v218, v42 row_newbcast:3 row_mask:0xf bank_mask:0xf
  v_fmac_f32_dpp v31, v219, v42 row_newbcast:3 row_mask:0xf bank_mask:0xf
  v_mul_f32 v44, v24, v24
  v_mul_f32 v45, v25, v25
  v_mul_f32 v46, v26, v26
  v_mul_f32 v47, v27, v27
  v_mul_f32 v48, v28, v28
  v_mul_f32 v49, v29, v29
  v_mul_f32 v50, v30, v30
  v_mul_f32 v51, v31, v31
  v_fmaak_f32 v44, v250, v44, 0xc0135761
  v_fmaak_f32 v45, v250, v45, 0xc0135761
  v_fmaak_f32 v46, v250, v46, 0xc0135761
  v_fmaak_f32 v47, v250, v47, 0xc0135761
  v_fmaak_f32 v48, v250, v48, 0xc0135761
  v_fmaak_f32 v49, v250, v49, 0xc0135761
  v_fmaak_f32 v50, v250, v50, 0xc0135761
  v_fmaak_f32 v51, v250, v51, 0xc0135761
  v_mul_f32 v44, v44, v24
  v_mul_f32 v45, v45, v25
  v_mul_f32 v46, v46, v26
  v_mul_f32 v47, v47, v27
  v_mul_f32 v48, v48, v28
  v_mul_f32 v49, v49, v29
  v_mul_f32 v50, v50, v30
  v_mul_f32 v51, v51, v31
  v_exp_f32 v44, v44
  v_exp_f32 v45, v45
  v_exp_f32 v46, v46
  v_exp_f32 v47, v47
  v_exp_f32 v48, v48
  v_exp_f32 v49, v49
  v_exp_f32 v50, v50
  v_exp_f32 v51, v51
  v_add_f32 v44, 1.0, v44
  v_add_f32 v45, 1.0, v45
  v_add_f32 v46, 1.0, v46
  v_add_f32 v47, 1.0, v47
  v_add_f32 v48, 1.0, v48
  v_add_f32 v49, 1.0, v49
  v_add_f32 v50, 1.0, v50
  v_add_f32 v51, 1.0, v51
  v_rcp_f32 v44, v44
  v_rcp_f32 v45, v45
  v_rcp_f32 v46, v46
  v_rcp_f32 v47, v47
  v_rcp_f32 v48, v48
  v_rcp_f32 v49, v49
  v_rcp_f32 v50, v50
  v_rcp_f32 v51, v51
  v_mul_f32 v24, v24, v44
  v_mul_f32 v25, v25, v45
  v_mul_f32 v26, v26, v46
  v_mul_f32 v27, v27, v47
  v_mul_f32 v28, v28, v48
  v_mul_f32 v29, v29, v49
  v_mul_f32 v30, v30, v50
  v_mul_f32 v31, v31, v51
  v_cvt_pk_bf16_f32 v68, v24, v25
  v_cvt_pk_bf16_f32 v69, v26, v27
  v_cvt_pk_bf16_f32 v70, v28, v29
  v_cvt_pk_bf16_f32 v71, v30, v31
  buffer_store_dwordx4 v[68:71], v249, s[48:51], s33 offen offset:1024 sc1
  v_mul_f32 v32, v41, v32
  v_mul_f32 v33, v41, v33
  v_mul_f32 v34, v41, v34
  v_mul_f32 v35, v41, v35
  v_mul_f32 v36, v41, v36
  v_mul_f32 v37, v41, v37
  v_mul_f32 v38, v41, v38
  v_mul_f32 v39, v41, v39
  v_fmac_f32_dpp v32, v216, v42 row_newbcast:4 row_mask:0xf bank_mask:0xf
  v_fmac_f32_dpp v33, v217, v42 row_newbcast:4 row_mask:0xf bank_mask:0xf
  v_fmac_f32_dpp v34, v218, v42 row_newbcast:4 row_mask:0xf bank_mask:0xf
  v_fmac_f32_dpp v35, v219, v42 row_newbcast:4 row_mask:0xf bank_mask:0xf
  v_fmac_f32_dpp v36, v216, v42 row_newbcast:5 row_mask:0xf bank_mask:0xf
  v_fmac_f32_dpp v37, v217, v42 row_newbcast:5 row_mask:0xf bank_mask:0xf
  v_fmac_f32_dpp v38, v218, v42 row_newbcast:5 row_mask:0xf bank_mask:0xf
  v_fmac_f32_dpp v39, v219, v42 row_newbcast:5 row_mask:0xf bank_mask:0xf
  v_mul_f32 v44, v32, v32
  v_mul_f32 v45, v33, v33
  v_mul_f32 v46, v34, v34
  v_mul_f32 v47, v35, v35
  v_mul_f32 v48, v36, v36
  v_mul_f32 v49, v37, v37
  v_mul_f32 v50, v38, v38
  v_mul_f32 v51, v39, v39
  v_fmaak_f32 v44, v250, v44, 0xc0135761
  v_fmaak_f32 v45, v250, v45, 0xc0135761
  v_fmaak_f32 v46, v250, v46, 0xc0135761
  v_fmaak_f32 v47, v250, v47, 0xc0135761
  v_fmaak_f32 v48, v250, v48, 0xc0135761
  v_fmaak_f32 v49, v250, v49, 0xc0135761
  v_fmaak_f32 v50, v250, v50, 0xc0135761
  v_fmaak_f32 v51, v250, v51, 0xc0135761
  v_mul_f32 v44, v44, v32
  v_mul_f32 v45, v45, v33
  v_mul_f32 v46, v46, v34
  v_mul_f32 v47, v47, v35
  v_mul_f32 v48, v48, v36
  v_mul_f32 v49, v49, v37
  v_mul_f32 v50, v50, v38
  v_mul_f32 v51, v51, v39
  v_exp_f32 v44, v44
  v_exp_f32 v45, v45
  v_exp_f32 v46, v46
  v_exp_f32 v47, v47
  v_exp_f32 v48, v48
  v_exp_f32 v49, v49
  v_exp_f32 v50, v50
  v_exp_f32 v51, v51
  v_add_f32 v44, 1.0, v44
  v_add_f32 v45, 1.0, v45
  v_add_f32 v46, 1.0, v46
  v_add_f32 v47, 1.0, v47
  v_add_f32 v48, 1.0, v48
  v_add_f32 v49, 1.0, v49
  v_add_f32 v50, 1.0, v50
  v_add_f32 v51, 1.0, v51
  v_rcp_f32 v44, v44
  v_rcp_f32 v45, v45
  v_rcp_f32 v46, v46
  v_rcp_f32 v47, v47
  v_rcp_f32 v48, v48
  v_rcp_f32 v49, v49
  v_rcp_f32 v50, v50
  v_rcp_f32 v51, v51
  v_mul_f32 v32, v32, v44
  v_mul_f32 v33, v33, v45
  v_mul_f32 v34, v34, v46
  v_mul_f32 v35, v35, v47
  v_mul_f32 v36, v36, v48
  v_mul_f32 v37, v37, v49
  v_mul_f32 v38, v38, v50
  v_mul_f32 v39, v39, v51
  v_cvt_pk_bf16_f32 v72, v32, v33
  v_cvt_pk_bf16_f32 v73, v34, v35
  v_cvt_pk_bf16_f32 v74, v36, v37
  v_cvt_pk_bf16_f32 v75, v38, v39
  buffer_store_dwordx4 v[72:75], v249, s[48:51], s33 offen offset:2048 sc1
  s_add_u32 s86, s21, 40960
  v_add_u32 v8, s86, v249
  v_add_u32 v9, 0x10000, v8
L_G3P:
  ds_read_b32 v52, v13
  s_waitcnt lgkmcnt(0)
  v_cmp_gt_u32 vcc, 8, v52
  s_cbranch_vccz L_G3Q
  s_sleep 1
  s_branch L_G3P
L_G3Q:
  s_waitcnt vmcnt(3)
  ds_write_b128 v8, v[92:95] offset:0
  ds_write_b128 v8, v[96:99] offset:8192
  ds_write_b128 v8, v[100:103] offset:16384
  ds_write_b128 v8, v[104:107] offset:24576
  ds_write_b128 v8, v[108:111] offset:32768
  ds_write_b128 v8, v[112:115] offset:40960
  ds_write_b128 v8, v[116:119] offset:49152
  ds_write_b128 v8, v[120:123] offset:57344
  ds_write_b128 v9, v[124:127] offset:0
  ds_write_b128 v9, v[128:131] offset:8192
  v_add_u32 v9, 122880, v249
  ds_write_b128 v9, v[132:135]
  s_lshl_b32 s86, s82, 4
  s_add_u32 s86, s86, s19
  s_lshl_b32 s86, s86, 3
  s_add_u32 s86, s86, 693248
  v_mov_b32 v16, s42
  v_mov_b32 v17, s43
  s_waitcnt vmcnt(0)
  s_mov_b64 exec, 1
  s_cmp_eq_u32 s98, 0
  s_cbranch_scc1 LQ_107
  buffer_store_dwordx2 v[16:17], v248, s[48:51], s86 offen
  s_branch LQ_108
LQ_107:
  buffer_store_dwordx2 v[16:17], v248, s[48:51], s86 offen sc1
LQ_108:
  s_mov_b64 exec, -1
  s_and_b32 s84, s17, 1
  s_xor_b32 s85, s79, 4
  s_cmp_eq_u32 s73, 0
  s_cselect_b32 s81, s79, s85
  s_mul_i32 s81, s81, 49152
  s_mul_i32 s86, s84, 24576
  s_add_u32 s81, s81, s86
  s_add_u32 s81, s81, 720896
  v_add_u32 v7, 61440, v249
  s_lshl_b32 s86, s84, 9
  s_add_u32 s71, s71, s86
  s_add_u32 s71, s71, 2048
  s_mov_b32 s52, s36
  s_mov_b32 s53, s37
  s_mov_b32 s54, 2621440
  s_mov_b32 s55, 0x20000
  s_movk_i32 s86, 1280
  v_mul_lo_u32 v5, v221, s86
  v_lshl_add_u32 v5, v3, 3, v5
  s_lshl_b32 s30, s16, 2
  s_add_u32 s30, s30, s72
  s_xor_b32 s31, s30, 32
  s_lshl_b32 s32, s30, 6
  s_add_u32 s32, s32, 712704
  s_lshl_b32 s33, s31, 6
  s_add_u32 s33, s33, 712704
  s_mul_i32 s86, s10, 2560
  s_mul_i32 s30, s79, 20480
  s_add_u32 s30, s30, s86
  s_mul_i32 s31, s85, 20480
  s_add_u32 s31, s31, s86
  s_lshl_b32 s86, s16, 6
  s_add_u32 s86, s86, 700416
  s_cmp_eq_u32 s73, 0
  s_cselect_b32 s71, s79, s85
  s_lshl_b32 s71, s71, 7
  s_lshl_b32 s86, s84, 31
  s_lshl_b32 s86, s86, 1
  s_add_u32 s71, s71, s86
  s_add_u32 s71, s71, 693248
L_GB0:
  v_cmp_ne_u64 vcc, s[42:43], v[138:139]
  s_cbranch_vccnz L_GB1
L_GB2:
  v_mov_b32 v184, v136
  v_mov_b32 v185, v137
  v_add_u32 v48, 0, v1
  v_min_u32 v48, 15, v48
  v_lshlrev_b32 v48, 3, v48
  buffer_load_dwordx2 v[40:41], v48, s[48:51], s71 offen sc1
  s_waitcnt vmcnt(0) lgkmcnt(0)
  s_barrier
  s_branch LP_111
LP_109:
  buffer_load_dwordx2 v[40:41], v48, s[48:51], s71 offen sc1
  s_waitcnt vmcnt(0)
LP_111:
  v_cmp_ne_u64 vcc, s[42:43], v[40:41]
  s_cbranch_vccz LD_110
  s_add_u32 s95, s95, 1
  s_cmp_gt_u32 s95, 262144
  s_cbranch_scc1 LD_110
  s_sleep 1
  s_branch LP_109
LD_110:
  s_cmp_eq_u32 s73, 0
  s_cbranch_scc1 L_G4O
  s_setprio 2
  buffer_load_dwordx4 v[8:11], v249, s[48:51], s81 offen offset:0 sc1
  buffer_load_dwordx4 v[12:15], v249, s[48:51], s81 offen offset:1024 sc1
  buffer_load_dwordx4 v[16:19], v249, s[48:51], s81 offen offset:2048 sc1
  buffer_load_dwordx4 v[20:23], v249, s[48:51], s81 offen offset:3072 sc1
  s_add_u32 s81, s81, 4096
  buffer_load_dwordx4 v[24:27], v249, s[48:51], s81 offen offset:0 sc1
  buffer_load_dwordx4 v[28:31], v249, s[48:51], s81 offen offset:1024 sc1
  buffer_load_dwordx4 v[32:35], v249, s[48:51], s81 offen offset:2048 sc1
  buffer_load_dwordx4 v[36:39], v249, s[48:51], s81 offen offset:3072 sc1
  s_add_u32 s81, s81, 4096
  buffer_load_dwordx4 v[40:43], v249, s[48:51], s81 offen offset:0 sc1
  buffer_load_dwordx4 v[44:47], v249, s[48:51], s81 offen offset:1024 sc1
  ds_read_b128 v[124:127], v249 offset:0
  ds_read_b128 v[128:131], v249 offset:1024
  ds_read_b128 v[132:135], v249 offset:2048
  ds_read_b128 v[136:139], v249 offset:3072
  ds_read_b128 v[140:143], v249 offset:4096
  ds_read_b128 v[144:147], v249 offset:5120
  ds_read_b128 v[148:151], v249 offset:6144
  ds_read_b128 v[152:155], v249 offset:7168
  ds_read_b128 v[156:159], v249 offset:8192
  ds_read_b128 v[160:163], v249 offset:9216
  buffer_load_dwordx4 v[48:51], v249, s[48:51], s81 offen offset:2048 sc1
  s_waitcnt vmcnt(10) lgkmcnt(5)
  v_mfma_f32_16x16x32_bf16 v[104:107], v[124:127], v[8:11], 0
  ds_read_b128 v[164:167], v249 offset:10240
  v_mfma_f32_16x16x32_bf16 v[108:111], v[128:131], v[8:11], 0
  ds_read_b128 v[168:171], v249 offset:11264
  v_mfma_f32_16x16x32_bf16 v[112:115], v[132:135], v[8:11], 0
  ds_read_b128 v[172:175], v249 offset:12288
  v_mfma_f32_16x16x32_bf16 v[116:119], v[136:139], v[8:11], 0
  ds_read_b128 v[176:179], v249 offset:13312
  v_mfma_f32_16x16x32_bf16 v[120:123], v[140:143], v[8:11], 0
  ds_read_b128 v[180:183], v249 offset:14336
  buffer_load_dwordx4 v[52:55], v249, s[48:51], s81 offen offset:3072 sc1
  s_waitcnt vmcnt(10) lgkmcnt(5)
  v_mfma_f32_16x16x32_bf16 v[104:107], v[144:147], v[12:15], v[104:107]
  ds_read_b128 v[124:127], v249 offset:15360
  v_mfma_f32_16x16x32_bf16 v[108:111], v[148:151], v[12:15], v[108:111]
  ds_read_b128 v[128:131], v249 offset:16384
  v_mfma_f32_16x16x32_bf16 v[112:115], v[152:155], v[12:15], v[112:115]
  ds_read_b128 v[132:135], v249 offset:17408
  v_mfma_f32_16x16x32_bf16 v[116:119], v[156:159], v[12:15], v[116:119]
  ds_read_b128 v[136:139], v249 offset:18432
  v_mfma_f32_16x16x32_bf16 v[120:123], v[160:163], v[12:15], v[120:123]
  ds_read_b128 v[140:143], v249 offset:19456
  s_add_u32 s81, s81, 4096
  buffer_load_dwordx4 v[56:59], v249, s[48:51], s81 offen offset:0 sc1
  s_waitcnt vmcnt(10) lgkmcnt(5)
  v_mfma_f32_16x16x32_bf16 v[104:107], v[164:167], v[16:19], v[104:107]
  ds_read_b128 v[144:147], v249 offset:20480
  v_mfma_f32_16x16x32_bf16 v[108:111], v[168:171], v[16:19], v[108:111]
  v_add_f32_dpp v184, v184, v184 quad_perm:[1,0,3,2] row_mask:0xf bank_mask:0xf
  ds_read_b128 v[148:151], v249 offset:21504
  v_mfma_f32_16x16x32_bf16 v[112:115], v[172:175], v[16:19], v[112:115]
  ds_read_b128 v[152:155], v249 offset:22528
  v_mfma_f32_16x16x32_bf16 v[116:119], v[176:179], v[16:19], v[116:119]
  v_add_f32_dpp v185, v185, v185 quad_perm:[1,0,3,2] row_mask:0xf bank_mask:0xf
  ds_read_b128 v[156:159], v249 offset:23552
  v_mfma_f32_16x16x32_bf16 v[120:123], v[180:183], v[16:19], v[120:123]
  ds_read_b128 v[160:163], v249 offset:24576
  buffer_load_dwordx4 v[60:63], v249, s[48:51], s81 offen offset:1024 sc1
  s_waitcnt vmcnt(10) lgkmcnt(5)
  v_mfma_f32_16x16x32_bf16 v[104:107], v[124:127], v[20:23], v[104:107]
  v_cvt_pk_bf16_f32 v185, v184, v185
  ds_read_b128 v[164:167], v249 offset:25600
  v_mfma_f32_16x16x32_bf16 v[108:111], v[128:131], v[20:23], v[108:111]
  ds_read_b128 v[168:171], v249 offset:26624
  v_mfma_f32_16x16x32_bf16 v[112:115], v[132:135], v[20:23], v[112:115]
  v_lshlrev_b32 v184, 16, v185
  ds_read_b128 v[172:175], v249 offset:27648
  v_mfma_f32_16x16x32_bf16 v[116:119], v[136:139], v[20:23], v[116:119]
  ds_read_b128 v[176:179], v249 offset:28672
  v_mfma_f32_16x16x32_bf16 v[120:123], v[140:143], v[20:23], v[120:123]
  v_and_b32 v185, 0xffff0000, v185
  ds_read_b128 v[180:183], v249 offset:29696
  buffer_load_dwordx4 v[64:67], v249, s[48:51], s81 offen offset:2048 sc1
  s_waitcnt vmcnt(10) lgkmcnt(5)
  v_mfma_f32_16x16x32_bf16 v[104:107], v[144:147], v[24:27], v[104:107]
  ds_read_b128 v[124:127], v249 offset:30720
  v_mfma_f32_16x16x32_bf16 v[108:111], v[148:151], v[24:27], v[108:111]
  v_lshlrev_b32 v192, 16, v240
  ds_read_b128 v[128:131], v249 offset:31744
  v_mfma_f32_16x16x32_bf16 v[112:115], v[152:155], v[24:27], v[112:115]
  ds_read_b128 v[132:135], v249 offset:32768
  v_mfma_f32_16x16x32_bf16 v[116:119], v[156:159], v[24:27], v[116:119]
  v_and_b32 v193, 0xffff0000, v240
  ds_read_b128 v[136:139], v249 offset:33792
  v_mfma_f32_16x16x32_bf16 v[120:123], v[160:163], v[24:27], v[120:123]
  ds_read_b128 v[140:143], v249 offset:34816
  buffer_load_dwordx4 v[68:71], v249, s[48:51], s81 offen offset:3072 sc1
  s_waitcnt vmcnt(10) lgkmcnt(5)
  v_mfma_f32_16x16x32_bf16 v[104:107], v[164:167], v[28:31], v[104:107]
  v_lshlrev_b32 v194, 16, v241
  ds_read_b128 v[144:147], v249 offset:35840
  v_mfma_f32_16x16x32_bf16 v[108:111], v[168:171], v[28:31], v[108:111]
  ds_read_b128 v[148:151], v249 offset:36864
  v_mfma_f32_16x16x32_bf16 v[112:115], v[172:175], v[28:31], v[112:115]
  v_and_b32 v195, 0xffff0000, v241
  ds_read_b128 v[152:155], v249 offset:37888
  v_mfma_f32_16x16x32_bf16 v[116:119], v[176:179], v[28:31], v[116:119]
  ds_read_b128 v[156:159], v249 offset:38912
  v_mfma_f32_16x16x32_bf16 v[120:123], v[180:183], v[28:31], v[120:123]
  v_lshlrev_b32 v204, 16, v232
  ds_read_b128 v[160:163], v7 offset:61440
  s_add_u32 s81, s81, 4096
  buffer_load_dwordx4 v[72:75], v249, s[48:51], s81 offen offset:0 sc1
  s_waitcnt vmcnt(10) lgkmcnt(5)
  v_mfma_f32_16x16x32_bf16 v[104:107], v[124:127], v[32:35], v[104:107]
  ds_read_b128 v[164:167], v249 offset:40960
  v_mfma_f32_16x16x32_bf16 v[108:111], v[128:131], v[32:35], v[108:111]
  v_and_b32 v205, 0xffff0000, v232
  ds_read_b128 v[168:171], v249 offset:41984
  v_mfma_f32_16x16x32_bf16 v[112:115], v[132:135], v[32:35], v[112:115]
  ds_read_b128 v[172:175], v249 offset:43008
  v_mfma_f32_16x16x32_bf16 v[116:119], v[136:139], v[32:35], v[116:119]
  v_lshlrev_b32 v206, 16, v233
  ds_read_b128 v[176:179], v249 offset:44032
  v_mfma_f32_16x16x32_bf16 v[120:123], v[140:143], v[32:35], v[120:123]
  ds_read_b128 v[180:183], v249 offset:45056
  buffer_load_dwordx4 v[76:79], v249, s[48:51], s81 offen offset:1024 sc1
  s_waitcnt vmcnt(10) lgkmcnt(5)
  v_mfma_f32_16x16x32_bf16 v[104:107], v[144:147], v[36:39], v[104:107]
  v_and_b32 v207, 0xffff0000, v233
  ds_read_b128 v[124:127], v249 offset:46080
  v_mfma_f32_16x16x32_bf16 v[108:111], v[148:151], v[36:39], v[108:111]
  ds_read_b128 v[128:131], v249 offset:47104
  v_mfma_f32_16x16x32_bf16 v[112:115], v[152:155], v[36:39], v[112:115]
  v_fmac_f32_dpp v204, v184, v192 row_newbcast:0 row_mask:0xf bank_mask:0xf
  ds_read_b128 v[132:135], v249 offset:48128
  v_mfma_f32_16x16x32_bf16 v[116:119], v[156:159], v[36:39], v[116:119]
  ds_read_b128 v[136:139], v249 offset:49152
  v_mfma_f32_16x16x32_bf16 v[120:123], v[160:163], v[36:39], v[120:123]
  v_fmac_f32_dpp v205, v185, v193 row_newbcast:0 row_mask:0xf bank_mask:0xf
  ds_read_b128 v[140:143], v249 offset:50176
  buffer_load_dwordx4 v[80:83], v249, s[48:51], s81 offen offset:2048 sc1
  v_lshl_add_u32 v246, v1, 7, s31
  v_mov_b32 v4, s33
  v_cmp_gt_u32 vcc, 20, v1
  s_nop 1
  v_cndmask_b32 v246, v4, v246, vcc
  buffer_load_dword v247, v246, s[48:51], 0 offen sc1
  s_waitcnt vmcnt(11) lgkmcnt(5)
  v_mfma_f32_16x16x32_bf16 v[104:107], v[164:167], v[40:43], v[104:107]
  ds_read_b128 v[144:147], v249 offset:51200
  v_mfma_f32_16x16x32_bf16 v[108:111], v[168:171], v[40:43], v[108:111]
  v_fmac_f32_dpp v206, v184, v194 row_newbcast:2 row_mask:0xf bank_mask:0xf
  ds_read_b128 v[148:151], v249 offset:52224
  v_mfma_f32_16x16x32_bf16 v[112:115], v[172:175], v[40:43], v[112:115]
  ds_read_b128 v[152:155], v249 offset:53248
  v_mfma_f32_16x16x32_bf16 v[116:119], v[176:179], v[40:43], v[116:119]
  v_fmac_f32_dpp v207, v185, v195 row_newbcast:2 row_mask:0xf bank_mask:0xf
  ds_read_b128 v[156:159], v249 offset:54272
  v_mfma_f32_16x16x32_bf16 v[120:123], v[180:183], v[40:43], v[120:123]
  ds_read_b128 v[160:163], v249 offset:55296
  buffer_load_dwordx4 v[84:87], v249, s[48:51], s81 offen offset:3072 sc1
  s_waitcnt vmcnt(11) lgkmcnt(5)
  v_mfma_f32_16x16x32_bf16 v[104:107], v[124:127], v[44:47], v[104:107]
  v_lshlrev_b32 v196, 16, v242
  ds_read_b128 v[164:167], v249 offset:56320
  v_mfma_f32_16x16x32_bf16 v[108:111], v[128:131], v[44:47], v[108:111]
  ds_read_b128 v[168:171], v249 offset:57344
  v_mfma_f32_16x16x32_bf16 v[112:115], v[132:135], v[44:47], v[112:115]
  v_and_b32 v197, 0xffff0000, v242
  ds_read_b128 v[172:175], v249 offset:58368
  v_mfma_f32_16x16x32_bf16 v[116:119], v[136:139], v[44:47], v[116:119]
  ds_read_b128 v[176:179], v249 offset:59392
  v_mfma_f32_16x16x32_bf16 v[120:123], v[140:143], v[44:47], v[120:123]
  v_lshlrev_b32 v198, 16, v243
  ds_read_b128 v[180:183], v249 offset:60416
  s_add_u32 s81, s81, 4096
  buffer_load_dwordx4 v[88:91], v249, s[48:51], s81 offen offset:0 sc1
  s_waitcnt vmcnt(11) lgkmcnt(5)
  v_mfma_f32_16x16x32_bf16 v[104:107], v[144:147], v[48:51], v[104:107]
  ds_read_b128 v[124:127], v7 offset:0
  v_mfma_f32_16x16x32_bf16 v[108:111], v[148:151], v[48:51], v[108:111]
  v_and_b32 v199, 0xffff0000, v243
  ds_read_b128 v[128:131], v7 offset:1024
  v_mfma_f32_16x16x32_bf16 v[112:115], v[152:155], v[48:51], v[112:115]
  ds_read_b128 v[132:135], v7 offset:2048
  v_mfma_f32_16x16x32_bf16 v[116:119], v[156:159], v[48:51], v[116:119]
  v_lshlrev_b32 v208, 16, v234
  ds_read_b128 v[136:139], v7 offset:3072
  v_mfma_f32_16x16x32_bf16 v[120:123], v[160:163], v[48:51], v[120:123]
  ds_read_b128 v[140:143], v7 offset:4096
  buffer_load_dwordx4 v[92:95], v249, s[48:51], s81 offen offset:1024 sc1
  s_waitcnt vmcnt(11) lgkmcnt(5)
  v_mfma_f32_16x16x32_bf16 v[104:107], v[164:167], v[52:55], v[104:107]
  v_and_b32 v209, 0xffff0000, v234
  ds_read_b128 v[144:147], v7 offset:5120
  v_mfma_f32_16x16x32_bf16 v[108:111], v[168:171], v[52:55], v[108:111]
  ds_read_b128 v[148:151], v7 offset:6144
  v_mfma_f32_16x16x32_bf16 v[112:115], v[172:175], v[52:55], v[112:115]
  v_lshlrev_b32 v210, 16, v235
  ds_read_b128 v[152:155], v7 offset:7168
  v_mfma_f32_16x16x32_bf16 v[116:119], v[176:179], v[52:55], v[116:119]
  ds_read_b128 v[156:159], v7 offset:8192
  v_mfma_f32_16x16x32_bf16 v[120:123], v[180:183], v[52:55], v[120:123]
  v_and_b32 v211, 0xffff0000, v235
  ds_read_b128 v[160:163], v7 offset:9216
  buffer_load_dwordx4 v[96:99], v249, s[48:51], s81 offen offset:2048 sc1
  s_waitcnt vmcnt(11) lgkmcnt(5)
  v_mfma_f32_16x16x32_bf16 v[104:107], v[124:127], v[56:59], v[104:107]
  ds_read_b128 v[164:167], v7 offset:10240
  v_mfma_f32_16x16x32_bf16 v[108:111], v[128:131], v[56:59], v[108:111]
  v_fmac_f32_dpp v208, v184, v196 row_newbcast:4 row_mask:0xf bank_mask:0xf
  ds_read_b128 v[168:171], v7 offset:11264
  v_mfma_f32_16x16x32_bf16 v[112:115], v[132:135], v[56:59], v[112:115]
  ds_read_b128 v[172:175], v7 offset:12288
  v_mfma_f32_16x16x32_bf16 v[116:119], v[136:139], v[56:59], v[116:119]
  v_fmac_f32_dpp v209, v185, v197 row_newbcast:4 row_mask:0xf bank_mask:0xf
  ds_read_b128 v[176:179], v7 offset:13312
  v_mfma_f32_16x16x32_bf16 v[120:123], v[140:143], v[56:59], v[120:123]
  ds_read_b128 v[180:183], v7 offset:14336
  buffer_load_dwordx4 v[100:103], v249, s[48:51], s81 offen offset:3072 sc1
  s_waitcnt vmcnt(11) lgkmcnt(5)
  v_mfma_f32_16x16x32_bf16 v[104:107], v[144:147], v[60:63], v[104:107]
  v_fmac_f32_dpp v210, v184, v198 row_newbcast:6 row_mask:0xf bank_mask:0xf
  ds_read_b128 v[124:127], v7 offset:15360
  v_mfma_f32_16x16x32_bf16 v[108:111], v[148:151], v[60:63], v[108:111]
  ds_read_b128 v[128:131], v7 offset:16384
  v_mfma_f32_16x16x32_bf16 v[112:115], v[152:155], v[60:63], v[112:115]
  v_fmac_f32_dpp v211, v185, v199 row_newbcast:6 row_mask:0xf bank_mask:0xf
  ds_read_b128 v[132:135], v7 offset:17408
  v_mfma_f32_16x16x32_bf16 v[116:119], v[156:159], v[60:63], v[116:119]
  ds_read_b128 v[136:139], v7 offset:18432
  v_mfma_f32_16x16x32_bf16 v[120:123], v[160:163], v[60:63], v[120:123]
  v_lshlrev_b32 v200, 16, v244
  ds_read_b128 v[140:143], v7 offset:19456
  s_waitcnt vmcnt(10) lgkmcnt(5)
  v_mfma_f32_16x16x32_bf16 v[104:107], v[164:167], v[64:67], v[104:107]
  ds_read_b128 v[144:147], v7 offset:20480
  v_mfma_f32_16x16x32_bf16 v[108:111], v[168:171], v[64:67], v[108:111]
  v_and_b32 v201, 0xffff0000, v244
  ds_read_b128 v[148:151], v7 offset:21504
  v_mfma_f32_16x16x32_bf16 v[112:115], v[172:175], v[64:67], v[112:115]
  ds_read_b128 v[152:155], v7 offset:22528
  v_mfma_f32_16x16x32_bf16 v[116:119], v[176:179], v[64:67], v[116:119]
  v_lshlrev_b32 v202, 16, v245
  ds_read_b128 v[156:159], v7 offset:23552
  v_mfma_f32_16x16x32_bf16 v[120:123], v[180:183], v[64:67], v[120:123]
  ds_read_b128 v[160:163], v7 offset:24576
  s_waitcnt vmcnt(9) lgkmcnt(5)
  v_mfma_f32_16x16x32_bf16 v[104:107], v[124:127], v[68:71], v[104:107]
  v_and_b32 v203, 0xffff0000, v245
  ds_read_b128 v[164:167], v7 offset:25600
  v_mfma_f32_16x16x32_bf16 v[108:111], v[128:131], v[68:71], v[108:111]
  ds_read_b128 v[168:171], v7 offset:26624
  v_mfma_f32_16x16x32_bf16 v[112:115], v[132:135], v[68:71], v[112:115]
  v_lshlrev_b32 v212, 16, v236
  ds_read_b128 v[172:175], v7 offset:27648
  v_mfma_f32_16x16x32_bf16 v[116:119], v[136:139], v[68:71], v[116:119]
  ds_read_b128 v[176:179], v7 offset:28672
  v_mfma_f32_16x16x32_bf16 v[120:123], v[140:143], v[68:71], v[120:123]
  v_and_b32 v213, 0xffff0000, v236
  ds_read_b128 v[180:183], v7 offset:29696
  s_waitcnt vmcnt(8) lgkmcnt(5)
  v_mfma_f32_16x16x32_bf16 v[104:107], v[144:147], v[72:75], v[104:107]
  ds_read_b128 v[124:127], v7 offset:30720
  v_mfma_f32_16x16x32_bf16 v[108:111], v[148:151], v[72:75], v[108:111]
  v_lshlrev_b32 v214, 16, v237
  ds_read_b128 v[128:131], v7 offset:31744
  v_mfma_f32_16x16x32_bf16 v[112:115], v[152:155], v[72:75], v[112:115]
  ds_read_b128 v[132:135], v7 offset:32768
  v_mfma_f32_16x16x32_bf16 v[116:119], v[156:159], v[72:75], v[116:119]
  v_and_b32 v215, 0xffff0000, v237
  ds_read_b128 v[136:139], v7 offset:33792
  v_mfma_f32_16x16x32_bf16 v[120:123], v[160:163], v[72:75], v[120:123]
  ds_read_b128 v[140:143], v7 offset:34816
  s_waitcnt vmcnt(7) lgkmcnt(5)
  v_mfma_f32_16x16x32_bf16 v[104:107], v[164:167], v[76:79], v[104:107]
  v_fmac_f32_dpp v212, v184, v200 row_newbcast:8 row_mask:0xf bank_mask:0xf
  ds_read_b128 v[144:147], v7 offset:35840
  v_mfma_f32_16x16x32_bf16 v[108:111], v[168:171], v[76:79], v[108:111]
  ds_read_b128 v[148:151], v7 offset:36864
  v_mfma_f32_16x16x32_bf16 v[112:115], v[172:175], v[76:79], v[112:115]
  v_fmac_f32_dpp v213, v185, v201 row_newbcast:8 row_mask:0xf bank_mask:0xf
  ds_read_b128 v[152:155], v7 offset:37888
  v_mfma_f32_16x16x32_bf16 v[116:119], v[176:179], v[76:79], v[116:119]
  ds_read_b128 v[156:159], v7 offset:38912
  v_mfma_f32_16x16x32_bf16 v[120:123], v[180:183], v[76:79], v[120:123]
  v_fmac_f32_dpp v214, v184, v202 row_newbcast:10 row_mask:0xf bank_mask:0xf
  ds_read_b128 v[160:163], v7 offset:39936
  s_waitcnt vmcnt(6) lgkmcnt(5)
  v_mfma_f32_16x16x32_bf16 v[104:107], v[124:127], v[80:83], v[104:107]
  ds_read_b128 v[164:167], v7 offset:40960
  v_mfma_f32_16x16x32_bf16 v[108:111], v[128:131], v[80:83], v[108:111]
  v_fmac_f32_dpp v215, v185, v203 row_newbcast:10 row_mask:0xf bank_mask:0xf
  ds_read_b128 v[168:171], v7 offset:41984
  v_mfma_f32_16x16x32_bf16 v[112:115], v[132:135], v[80:83], v[112:115]
  ds_read_b128 v[172:175], v7 offset:43008
  v_mfma_f32_16x16x32_bf16 v[116:119], v[136:139], v[80:83], v[116:119]
  s_lshl_b32 s28, s76, 1
  ds_read_b128 v[176:179], v7 offset:44032
  v_mfma_f32_16x16x32_bf16 v[120:123], v[140:143], v[80:83], v[120:123]
  ds_read_b128 v[180:183], v7 offset:45056
  s_waitcnt vmcnt(4) lgkmcnt(5)
  v_mfma_f32_16x16x32_bf16 v[104:107], v[144:147], v[84:87], v[104:107]
  s_lshl_b32 s29, s13, 1
  ds_read_b128 v[124:127], v7 offset:46080
  v_mfma_f32_16x16x32_bf16 v[108:111], v[148:151], v[84:87], v[108:111]
  ds_read_b128 v[128:131], v7 offset:47104
  v_mfma_f32_16x16x32_bf16 v[112:115], v[152:155], v[84:87], v[112:115]
  s_lshl_b32 s86, s72, 11
  ds_read_b128 v[132:135], v7 offset:48128
  v_mfma_f32_16x16x32_bf16 v[116:119], v[156:159], v[84:87], v[116:119]
  ds_read_b128 v[136:139], v7 offset:49152
  v_mfma_f32_16x16x32_bf16 v[120:123], v[160:163], v[84:87], v[120:123]
  s_add_u32 s86, s86, 124928
  ds_read_b128 v[140:143], v7 offset:50176
  s_waitcnt vmcnt(3) lgkmcnt(5)
  v_mfma_f32_16x16x32_bf16 v[104:107], v[164:167], v[88:91], v[104:107]
  ds_read_b128 v[144:147], v7 offset:51200
  v_mfma_f32_16x16x32_bf16 v[108:111], v[168:171], v[88:91], v[108:111]
  v_add_u32 v6, s86, v249
  ds_read_b128 v[148:151], v7 offset:52224
  v_mfma_f32_16x16x32_bf16 v[112:115], v[172:175], v[88:91], v[112:115]
  ds_read_b128 v[152:155], v7 offset:53248
  v_mfma_f32_16x16x32_bf16 v[116:119], v[176:179], v[88:91], v[116:119]
  v_and_b32 v216, 1, v3
  ds_read_b128 v[156:159], v7 offset:54272
  v_mfma_f32_16x16x32_bf16 v[120:123], v[180:183], v[88:91], v[120:123]
  ds_read_b128 v[160:163], v7 offset:55296
  s_waitcnt vmcnt(2) lgkmcnt(5)
  v_mfma_f32_16x16x32_bf16 v[104:107], v[124:127], v[92:95], v[104:107]
  v_mul_u32_u24 v216, 24, v216
  ds_read_b128 v[164:167], v7 offset:56320
  v_mfma_f32_16x16x32_bf16 v[108:111], v[128:131], v[92:95], v[108:111]
  ds_read_b128 v[168:171], v7 offset:57344
  v_mfma_f32_16x16x32_bf16 v[112:115], v[132:135], v[92:95], v[112:115]
  v_add_u32 v216, v216, v5
  ds_read_b128 v[172:175], v7 offset:58368
  v_mfma_f32_16x16x32_bf16 v[116:119], v[136:139], v[92:95], v[116:119]
  ds_read_b128 v[176:179], v7 offset:59392
  v_mfma_f32_16x16x32_bf16 v[120:123], v[140:143], v[92:95], v[120:123]
  ds_read_b128 v[180:183], v7 offset:60416
  s_waitcnt vmcnt(1) lgkmcnt(5)
  v_mfma_f32_16x16x32_bf16 v[104:107], v[144:147], v[96:99], v[104:107]
  v_mfma_f32_16x16x32_bf16 v[108:111], v[148:151], v[96:99], v[108:111]
  v_mfma_f32_16x16x32_bf16 v[112:115], v[152:155], v[96:99], v[112:115]
  v_mfma_f32_16x16x32_bf16 v[116:119], v[156:159], v[96:99], v[116:119]
  v_mfma_f32_16x16x32_bf16 v[120:123], v[160:163], v[96:99], v[120:123]
  s_waitcnt vmcnt(0) lgkmcnt(0)
  v_mfma_f32_16x16x32_bf16 v[104:107], v[164:167], v[100:103], v[104:107]
  v_mfma_f32_16x16x32_bf16 v[108:111], v[168:171], v[100:103], v[108:111]
  v_mfma_f32_16x16x32_bf16 v[112:115], v[172:175], v[100:103], v[112:115]
  v_mfma_f32_16x16x32_bf16 v[116:119], v[176:179], v[100:103], v[116:119]
  v_mfma_f32_16x16x32_bf16 v[120:123], v[180:183], v[100:103], v[120:123]
  s_setprio 0
  v_lshlrev_b32 v4, 3, v1
  s_nop 1
  v_cvt_pk_bf16_f32 v8, v104, v105
  v_cvt_pk_bf16_f32 v9, v106, v107
  v_cvt_pk_bf16_f32 v10, v108, v109
  v_cvt_pk_bf16_f32 v11, v110, v111
  v_cvt_pk_bf16_f32 v12, v112, v113
  v_cvt_pk_bf16_f32 v13, v114, v115
  v_cvt_pk_bf16_f32 v14, v116, v117
  v_cvt_pk_bf16_f32 v15, v118, v119
  v_cvt_pk_bf16_f32 v16, v120, v121
  v_cvt_pk_bf16_f32 v17, v122, v123
  s_cmp_eq_u32 s98, 0
  s_cbranch_scc1 LQ_112
  buffer_store_dwordx4 v[8:11], v249, s[48:51], s31 offen
  buffer_store_dwordx4 v[12:15], v249, s[48:51], s31 offen offset:1024
  buffer_store_dwordx2 v[16:17], v4, s[48:51], s31 offen offset:2048
  s_branch LQ_113
LQ_112:
  buffer_store_dwordx4 v[8:11], v249, s[48:51], s31 offen sc1
  buffer_store_dwordx4 v[12:15], v249, s[48:51], s31 offen offset:1024 sc1
  buffer_store_dwordx2 v[16:17], v4, s[48:51], s31 offen offset:2048 sc1
LQ_113:
  v_mov_b32 v18, s42
  v_mov_b32 v19, s43
  s_waitcnt vmcnt(0)
  s_mov_b64 exec, 1
  s_cmp_eq_u32 s98, 0
  s_cbranch_scc1 LQ_114
  buffer_store_dwordx2 v[18:19], v248, s[48:51], s33 offen
  s_branch LQ_115
LQ_114:
  buffer_store_dwordx2 v[18:19], v248, s[48:51], s33 offen sc1
LQ_115:
  s_mov_b64 exec, -1
  v_add_u32 v48, 0, v1
  v_min_u32 v48, 0, v48
  v_lshlrev_b32 v48, 6, v48
LP_116:
  buffer_load_dwordx2 v[40:41], v48, s[48:51], s32 offen sc1
  s_waitcnt vmcnt(0)
  v_cmp_ne_u64 vcc, s[42:43], v[40:41]
  s_cbranch_vccz LD_117
  s_add_u32 s95, s95, 1
  s_cmp_gt_u32 s95, 262144
  s_cbranch_scc1 LD_117
  s_sleep 1
  s_branch LP_116
LD_117:
  buffer_load_dwordx4 v[76:79], v249, s[48:51], s30 offen offset:1024 sc1
  s_barrier
  ds_read_b128 v[104:107], v6
  ds_read_b128 v[108:111], v6 offset:1024
  s_waitcnt vmcnt(0) lgkmcnt(0)
  s_branch L_G4R
L_G4O:
  buffer_load_dwordx4 v[8:11], v249, s[48:51], s81 offen offset:0 sc1
  buffer_load_dwordx4 v[12:15], v249, s[48:51], s81 offen offset:1024 sc1
  buffer_load_dwordx4 v[16:19], v249, s[48:51], s81 offen offset:2048 sc1
  buffer_load_dwordx4 v[20:23], v249, s[48:51], s81 offen offset:3072 sc1
  ds_read_b128 v[124:127], v249 offset:0
  ds_read_b128 v[128:131], v249 offset:1024
  ds_read_b128 v[132:135], v249 offset:2048
  ds_read_b128 v[136:139], v249 offset:3072
  ds_read_b128 v[140:143], v249 offset:4096
  ds_read_b128 v[144:147], v249 offset:5120
  ds_read_b128 v[148:151], v249 offset:6144
  ds_read_b128 v[152:155], v249 offset:7168
  ds_read_b128 v[156:159], v249 offset:8192
  ds_read_b128 v[160:163], v249 offset:9216
  s_add_u32 s81, s81, 4096
  buffer_load_dwordx4 v[24:27], v249, s[48:51], s81 offen offset:0 sc1
  s_waitcnt vmcnt(4) lgkmcnt(5)
  v_mfma_f32_16x16x32_bf16 v[104:107], v[124:127], v[8:11], 0
  ds_read_b128 v[164:167], v249 offset:10240
  v_mfma_f32_16x16x32_bf16 v[108:111], v[128:131], v[8:11], 0
  ds_read_b128 v[168:171], v249 offset:11264
  v_mfma_f32_16x16x32_bf16 v[112:115], v[132:135], v[8:11], 0
  ds_read_b128 v[172:175], v249 offset:12288
  v_mfma_f32_16x16x32_bf16 v[116:119], v[136:139], v[8:11], 0
  ds_read_b128 v[176:179], v249 offset:13312
  v_mfma_f32_16x16x32_bf16 v[120:123], v[140:143], v[8:11], 0
  ds_read_b128 v[180:183], v249 offset:14336
  buffer_load_dwordx4 v[28:31], v249, s[48:51], s81 offen offset:1024 sc1
  s_waitcnt vmcnt(4) lgkmcnt(5)
  v_mfma_f32_16x16x32_bf16 v[104:107], v[144:147], v[12:15], v[104:107]
  ds_read_b128 v[124:127], v249 offset:15360
  v_mfma_f32_16x16x32_bf16 v[108:111], v[148:151], v[12:15], v[108:111]
  ds_read_b128 v[128:131], v249 offset:16384
  v_mfma_f32_16x16x32_bf16 v[112:115], v[152:155], v[12:15], v[112:115]
  ds_read_b128 v[132:135], v249 offset:17408
  v_mfma_f32_16x16x32_bf16 v[116:119], v[156:159], v[12:15], v[116:119]
  ds_read_b128 v[136:139], v249 offset:18432
  v_mfma_f32_16x16x32_bf16 v[120:123], v[160:163], v[12:15], v[120:123]
  ds_read_b128 v[140:143], v249 offset:19456
  buffer_load_dwordx4 v[32:35], v249, s[48:51], s81 offen offset:2048 sc1
  s_waitcnt vmcnt(4) lgkmcnt(5)
  v_mfma_f32_16x16x32_bf16 v[104:107], v[164:167], v[16:19], v[104:107]
  ds_read_b128 v[144:147], v249 offset:20480
  v_mfma_f32_16x16x32_bf16 v[108:111], v[168:171], v[16:19], v[108:111]
  v_add_f32_dpp v184, v184, v184 quad_perm:[1,0,3,2] row_mask:0xf bank_mask:0xf
  ds_read_b128 v[148:151], v249 offset:21504
  v_mfma_f32_16x16x32_bf16 v[112:115], v[172:175], v[16:19], v[112:115]
  ds_read_b128 v[152:155], v249 offset:22528
  v_mfma_f32_16x16x32_bf16 v[116:119], v[176:179], v[16:19], v[116:119]
  v_add_f32_dpp v185, v185, v185 quad_perm:[1,0,3,2] row_mask:0xf bank_mask:0xf
  ds_read_b128 v[156:159], v249 offset:23552
  v_mfma_f32_16x16x32_bf16 v[120:123], v[180:183], v[16:19], v[120:123]
  ds_read_b128 v[160:163], v249 offset:24576
  buffer_load_dwordx4 v[36:39], v249, s[48:51], s81 offen offset:3072 sc1
  s_waitcnt vmcnt(4) lgkmcnt(5)
  v_mfma_f32_16x16x32_bf16 v[104:107], v[124:127], v[20:23], v[104:107]
  v_cvt_pk_bf16_f32 v185, v184, v185
  ds_read_b128 v[164:167], v249 offset:25600
  v_mfma_f32_16x16x32_bf16 v[108:111], v[128:131], v[20:23], v[108:111]
  ds_read_b128 v[168:171], v249 offset:26624
  v_mfma_f32_16x16x32_bf16 v[112:115], v[132:135], v[20:23], v[112:115]
  v_lshlrev_b32 v184, 16, v185
  ds_read_b128 v[172:175], v249 offset:27648
  v_mfma_f32_16x16x32_bf16 v[116:119], v[136:139], v[20:23], v[116:119]
  ds_read_b128 v[176:179], v249 offset:28672
  v_mfma_f32_16x16x32_bf16 v[120:123], v[140:143], v[20:23], v[120:123]
  v_and_b32 v185, 0xffff0000, v185
  ds_read_b128 v[180:183], v249 offset:29696
  s_add_u32 s81, s81, 4096
  buffer_load_dwordx4 v[40:43], v249, s[48:51], s81 offen offset:0 sc1
  s_waitcnt vmcnt(4) lgkmcnt(5)
  v_mfma_f32_16x16x32_bf16 v[104:107], v[144:147], v[24:27], v[104:107]
  ds_read_b128 v[124:127], v249 offset:30720
  v_mfma_f32_16x16x32_bf16 v[108:111], v[148:151], v[24:27], v[108:111]
  v_lshlrev_b32 v192, 16, v240
  ds_read_b128 v[128:131], v249 offset:31744
  v_mfma_f32_16x16x32_bf16 v[112:115], v[152:155], v[24:27], v[112:115]
  ds_read_b128 v[132:135], v249 offset:32768
  v_mfma_f32_16x16x32_bf16 v[116:119], v[156:159], v[24:27], v[116:119]
  v_and_b32 v193, 0xffff0000, v240
  ds_read_b128 v[136:139], v249 offset:33792
  v_mfma_f32_16x16x32_bf16 v[120:123], v[160:163], v[24:27], v[120:123]
  ds_read_b128 v[140:143], v249 offset:34816
  buffer_load_dwordx4 v[44:47], v249, s[48:51], s81 offen offset:1024 sc1
  s_waitcnt vmcnt(4) lgkmcnt(5)
  v_mfma_f32_16x16x32_bf16 v[104:107], v[164:167], v[28:31], v[104:107]
  v_lshlrev_b32 v194, 16, v241
  ds_read_b128 v[144:147], v249 offset:35840
  v_mfma_f32_16x16x32_bf16 v[108:111], v[168:171], v[28:31], v[108:111]
  ds_read_b128 v[148:151], v249 offset:36864
  v_mfma_f32_16x16x32_bf16 v[112:115], v[172:175], v[28:31], v[112:115]
  v_and_b32 v195, 0xffff0000, v241
  ds_read_b128 v[152:155], v249 offset:37888
  v_mfma_f32_16x16x32_bf16 v[116:119], v[176:179], v[28:31], v[116:119]
  ds_read_b128 v[156:159], v249 offset:38912
  v_mfma_f32_16x16x32_bf16 v[120:123], v[180:183], v[28:31], v[120:123]
  v_lshlrev_b32 v204, 16, v232
  ds_read_b128 v[160:163], v7 offset:61440
  buffer_load_dwordx4 v[48:51], v249, s[48:51], s81 offen offset:2048 sc1
  s_waitcnt vmcnt(4) lgkmcnt(5)
  v_mfma_f32_16x16x32_bf16 v[104:107], v[124:127], v[32:35], v[104:107]
  ds_read_b128 v[164:167], v249 offset:40960
  v_mfma_f32_16x16x32_bf16 v[108:111], v[128:131], v[32:35], v[108:111]
  v_and_b32 v205, 0xffff0000, v232
  ds_read_b128 v[168:171], v249 offset:41984
  v_mfma_f32_16x16x32_bf16 v[112:115], v[132:135], v[32:35], v[112:115]
  ds_read_b128 v[172:175], v249 offset:43008
  v_mfma_f32_16x16x32_bf16 v[116:119], v[136:139], v[32:35], v[116:119]
  v_lshlrev_b32 v206, 16, v233
  ds_read_b128 v[176:179], v249 offset:44032
  v_mfma_f32_16x16x32_bf16 v[120:123], v[140:143], v[32:35], v[120:123]
  ds_read_b128 v[180:183], v249 offset:45056
  buffer_load_dwordx4 v[52:55], v249, s[48:51], s81 offen offset:3072 sc1
  s_add_u32 s81, s81, 4096
  buffer_load_dwordx4 v[56:59], v249, s[48:51], s81 offen offset:0 sc1
  s_waitcnt vmcnt(5) lgkmcnt(5)
  v_mfma_f32_16x16x32_bf16 v[104:107], v[144:147], v[36:39], v[104:107]
  v_and_b32 v207, 0xffff0000, v233
  ds_read_b128 v[124:127], v249 offset:46080
  v_mfma_f32_16x16x32_bf16 v[108:111], v[148:151], v[36:39], v[108:111]
  ds_read_b128 v[128:131], v249 offset:47104
  v_mfma_f32_16x16x32_bf16 v[112:115], v[152:155], v[36:39], v[112:115]
  v_fmac_f32_dpp v204, v184, v192 row_newbcast:0 row_mask:0xf bank_mask:0xf
  ds_read_b128 v[132:135], v249 offset:48128
  v_mfma_f32_16x16x32_bf16 v[116:119], v[156:159], v[36:39], v[116:119]
  ds_read_b128 v[136:139], v249 offset:49152
  v_mfma_f32_16x16x32_bf16 v[120:123], v[160:163], v[36:39], v[120:123]
  v_fmac_f32_dpp v205, v185, v193 row_newbcast:0 row_mask:0xf bank_mask:0xf
  ds_read_b128 v[140:143], v249 offset:50176
  buffer_load_dwordx4 v[60:63], v249, s[48:51], s81 offen offset:1024 sc1
  buffer_load_dwordx4 v[64:67], v249, s[48:51], s81 offen offset:2048 sc1
  s_waitcnt vmcnt(6) lgkmcnt(5)
  v_mfma_f32_16x16x32_bf16 v[104:107], v[164:167], v[40:43], v[104:107]
  ds_read_b128 v[144:147], v249 offset:51200
  v_mfma_f32_16x16x32_bf16 v[108:111], v[168:171], v[40:43], v[108:111]
  v_fmac_f32_dpp v206, v184, v194 row_newbcast:2 row_mask:0xf bank_mask:0xf
  ds_read_b128 v[148:151], v249 offset:52224
  v_mfma_f32_16x16x32_bf16 v[112:115], v[172:175], v[40:43], v[112:115]
  ds_read_b128 v[152:155], v249 offset:53248
  v_mfma_f32_16x16x32_bf16 v[116:119], v[176:179], v[40:43], v[116:119]
  v_fmac_f32_dpp v207, v185, v195 row_newbcast:2 row_mask:0xf bank_mask:0xf
  ds_read_b128 v[156:159], v249 offset:54272
  v_mfma_f32_16x16x32_bf16 v[120:123], v[180:183], v[40:43], v[120:123]
  ds_read_b128 v[160:163], v249 offset:55296
  buffer_load_dwordx4 v[68:71], v249, s[48:51], s81 offen offset:3072 sc1
  s_add_u32 s81, s81, 4096
  buffer_load_dwordx4 v[72:75], v249, s[48:51], s81 offen offset:0 sc1
  s_waitcnt vmcnt(7) lgkmcnt(5)
  v_mfma_f32_16x16x32_bf16 v[104:107], v[124:127], v[44:47], v[104:107]
  v_lshlrev_b32 v196, 16, v242
  ds_read_b128 v[164:167], v249 offset:56320
  v_mfma_f32_16x16x32_bf16 v[108:111], v[128:131], v[44:47], v[108:111]
  ds_read_b128 v[168:171], v249 offset:57344
  v_mfma_f32_16x16x32_bf16 v[112:115], v[132:135], v[44:47], v[112:115]
  v_and_b32 v197, 0xffff0000, v242
  ds_read_b128 v[172:175], v249 offset:58368
  v_mfma_f32_16x16x32_bf16 v[116:119], v[136:139], v[44:47], v[116:119]
  ds_read_b128 v[176:179], v249 offset:59392
  v_mfma_f32_16x16x32_bf16 v[120:123], v[140:143], v[44:47], v[120:123]
  v_lshlrev_b32 v198, 16, v243
  ds_read_b128 v[180:183], v249 offset:60416
  buffer_load_dwordx4 v[76:79], v249, s[48:51], s81 offen offset:1024 sc1
  buffer_load_dwordx4 v[80:83], v249, s[48:51], s81 offen offset:2048 sc1
  s_waitcnt vmcnt(8) lgkmcnt(5)
  v_mfma_f32_16x16x32_bf16 v[104:107], v[144:147], v[48:51], v[104:107]
  ds_read_b128 v[124:127], v7 offset:0
  v_mfma_f32_16x16x32_bf16 v[108:111], v[148:151], v[48:51], v[108:111]
  v_and_b32 v199, 0xffff0000, v243
  ds_read_b128 v[128:131], v7 offset:1024
  v_mfma_f32_16x16x32_bf16 v[112:115], v[152:155], v[48:51], v[112:115]
  ds_read_b128 v[132:135], v7 offset:2048
  v_mfma_f32_16x16x32_bf16 v[116:119], v[156:159], v[48:51], v[116:119]
  v_lshlrev_b32 v208, 16, v234
  ds_read_b128 v[136:139], v7 offset:3072
  v_mfma_f32_16x16x32_bf16 v[120:123], v[160:163], v[48:51], v[120:123]
  ds_read_b128 v[140:143], v7 offset:4096
  buffer_load_dwordx4 v[84:87], v249, s[48:51], s81 offen offset:3072 sc1
  s_add_u32 s81, s81, 4096
  buffer_load_dwordx4 v[88:91], v249, s[48:51], s81 offen offset:0 sc1
  s_waitcnt vmcnt(9) lgkmcnt(5)
  v_mfma_f32_16x16x32_bf16 v[104:107], v[164:167], v[52:55], v[104:107]
  v_and_b32 v209, 0xffff0000, v234
  ds_read_b128 v[144:147], v7 offset:5120
  v_mfma_f32_16x16x32_bf16 v[108:111], v[168:171], v[52:55], v[108:111]
  ds_read_b128 v[148:151], v7 offset:6144
  v_mfma_f32_16x16x32_bf16 v[112:115], v[172:175], v[52:55], v[112:115]
  v_lshlrev_b32 v210, 16, v235
  ds_read_b128 v[152:155], v7 offset:7168
  v_mfma_f32_16x16x32_bf16 v[116:119], v[176:179], v[52:55], v[116:119]
  ds_read_b128 v[156:159], v7 offset:8192
  v_mfma_f32_16x16x32_bf16 v[120:123], v[180:183], v[52:55], v[120:123]
  v_and_b32 v211, 0xffff0000, v235
  ds_read_b128 v[160:163], v7 offset:9216
  buffer_load_dwordx4 v[92:95], v249, s[48:51], s81 offen offset:1024 sc1
  s_waitcnt vmcnt(9) lgkmcnt(5)
  v_mfma_f32_16x16x32_bf16 v[104:107], v[124:127], v[56:59], v[104:107]
  ds_read_b128 v[164:167], v7 offset:10240
  v_mfma_f32_16x16x32_bf16 v[108:111], v[128:131], v[56:59], v[108:111]
  v_fmac_f32_dpp v208, v184, v196 row_newbcast:4 row_mask:0xf bank_mask:0xf
  ds_read_b128 v[168:171], v7 offset:11264
  v_mfma_f32_16x16x32_bf16 v[112:115], v[132:135], v[56:59], v[112:115]
  ds_read_b128 v[172:175], v7 offset:12288
  v_mfma_f32_16x16x32_bf16 v[116:119], v[136:139], v[56:59], v[116:119]
  v_fmac_f32_dpp v209, v185, v197 row_newbcast:4 row_mask:0xf bank_mask:0xf
  ds_read_b128 v[176:179], v7 offset:13312
  v_mfma_f32_16x16x32_bf16 v[120:123], v[140:143], v[56:59], v[120:123]
  ds_read_b128 v[180:183], v7 offset:14336
  buffer_load_dwordx4 v[96:99], v249, s[48:51], s81 offen offset:2048 sc1
  s_waitcnt vmcnt(9) lgkmcnt(5)
  v_mfma_f32_16x16x32_bf16 v[104:107], v[144:147], v[60:63], v[104:107]
  v_fmac_f32_dpp v210, v184, v198 row_newbcast:6 row_mask:0xf bank_mask:0xf
  ds_read_b128 v[124:127], v7 offset:15360
  v_mfma_f32_16x16x32_bf16 v[108:111], v[148:151], v[60:63], v[108:111]
  ds_read_b128 v[128:131], v7 offset:16384
  v_mfma_f32_16x16x32_bf16 v[112:115], v[152:155], v[60:63], v[112:115]
  v_fmac_f32_dpp v211, v185, v199 row_newbcast:6 row_mask:0xf bank_mask:0xf
  ds_read_b128 v[132:135], v7 offset:17408
  v_mfma_f32_16x16x32_bf16 v[116:119], v[156:159], v[60:63], v[116:119]
  ds_read_b128 v[136:139], v7 offset:18432
  v_mfma_f32_16x16x32_bf16 v[120:123], v[160:163], v[60:63], v[120:123]
  v_lshlrev_b32 v200, 16, v244
  ds_read_b128 v[140:143], v7 offset:19456
  buffer_load_dwordx4 v[100:103], v249, s[48:51], s81 offen offset:3072 sc1
  s_waitcnt vmcnt(9) lgkmcnt(5)
  v_mfma_f32_16x16x32_bf16 v[104:107], v[164:167], v[64:67], v[104:107]
  ds_read_b128 v[144:147], v7 offset:20480
  v_mfma_f32_16x16x32_bf16 v[108:111], v[168:171], v[64:67], v[108:111]
  v_and_b32 v201, 0xffff0000, v244
  ds_read_b128 v[148:151], v7 offset:21504
  v_mfma_f32_16x16x32_bf16 v[112:115], v[172:175], v[64:67], v[112:115]
  ds_read_b128 v[152:155], v7 offset:22528
  v_mfma_f32_16x16x32_bf16 v[116:119], v[176:179], v[64:67], v[116:119]
  v_lshlrev_b32 v202, 16, v245
  ds_read_b128 v[156:159], v7 offset:23552
  v_mfma_f32_16x16x32_bf16 v[120:123], v[180:183], v[64:67], v[120:123]
  ds_read_b128 v[160:163], v7 offset:24576
  s_waitcnt vmcnt(8) lgkmcnt(5)
  v_mfma_f32_16x16x32_bf16 v[104:107], v[124:127], v[68:71], v[104:107]
  v_and_b32 v203, 0xffff0000, v245
  ds_read_b128 v[164:167], v7 offset:25600
  v_mfma_f32_16x16x32_bf16 v[108:111], v[128:131], v[68:71], v[108:111]
  ds_read_b128 v[168:171], v7 offset:26624
  v_mfma_f32_16x16x32_bf16 v[112:115], v[132:135], v[68:71], v[112:115]
  v_lshlrev_b32 v212, 16, v236
  ds_read_b128 v[172:175], v7 offset:27648
  v_mfma_f32_16x16x32_bf16 v[116:119], v[136:139], v[68:71], v[116:119]
  ds_read_b128 v[176:179], v7 offset:28672
  v_mfma_f32_16x16x32_bf16 v[120:123], v[140:143], v[68:71], v[120:123]
  v_and_b32 v213, 0xffff0000, v236
  ds_read_b128 v[180:183], v7 offset:29696
  s_waitcnt vmcnt(7) lgkmcnt(5)
  v_mfma_f32_16x16x32_bf16 v[104:107], v[144:147], v[72:75], v[104:107]
  ds_read_b128 v[124:127], v7 offset:30720
  v_mfma_f32_16x16x32_bf16 v[108:111], v[148:151], v[72:75], v[108:111]
  v_lshlrev_b32 v214, 16, v237
  ds_read_b128 v[128:131], v7 offset:31744
  v_mfma_f32_16x16x32_bf16 v[112:115], v[152:155], v[72:75], v[112:115]
  ds_read_b128 v[132:135], v7 offset:32768
  v_mfma_f32_16x16x32_bf16 v[116:119], v[156:159], v[72:75], v[116:119]
  v_and_b32 v215, 0xffff0000, v237
  ds_read_b128 v[136:139], v7 offset:33792
  v_mfma_f32_16x16x32_bf16 v[120:123], v[160:163], v[72:75], v[120:123]
  ds_read_b128 v[140:143], v7 offset:34816
  s_waitcnt vmcnt(6) lgkmcnt(5)
  v_mfma_f32_16x16x32_bf16 v[104:107], v[164:167], v[76:79], v[104:107]
  v_fmac_f32_dpp v212, v184, v200 row_newbcast:8 row_mask:0xf bank_mask:0xf
  ds_read_b128 v[144:147], v7 offset:35840
  v_mfma_f32_16x16x32_bf16 v[108:111], v[168:171], v[76:79], v[108:111]
  ds_read_b128 v[148:151], v7 offset:36864
  v_mfma_f32_16x16x32_bf16 v[112:115], v[172:175], v[76:79], v[112:115]
  v_fmac_f32_dpp v213, v185, v201 row_newbcast:8 row_mask:0xf bank_mask:0xf
  ds_read_b128 v[152:155], v7 offset:37888
  v_mfma_f32_16x16x32_bf16 v[116:119], v[176:179], v[76:79], v[116:119]
  ds_read_b128 v[156:159], v7 offset:38912
  v_mfma_f32_16x16x32_bf16 v[120:123], v[180:183], v[76:79], v[120:123]
  v_fmac_f32_dpp v214, v184, v202 row_newbcast:10 row_mask:0xf bank_mask:0xf
  ds_read_b128 v[160:163], v7 offset:39936
  s_waitcnt vmcnt(5) lgkmcnt(5)
  v_mfma_f32_16x16x32_bf16 v[104:107], v[124:127], v[80:83], v[104:107]
  ds_read_b128 v[164:167], v7 offset:40960
  v_mfma_f32_16x16x32_bf16 v[108:111], v[128:131], v[80:83], v[108:111]
  v_fmac_f32_dpp v215, v185, v203 row_newbcast:10 row_mask:0xf bank_mask:0xf
  ds_read_b128 v[168:171], v7 offset:41984
  v_mfma_f32_16x16x32_bf16 v[112:115], v[132:135], v[80:83], v[112:115]
  ds_read_b128 v[172:175], v7 offset:43008
  v_mfma_f32_16x16x32_bf16 v[116:119], v[136:139], v[80:83], v[116:119]
  s_lshl_b32 s28, s76, 1
  ds_read_b128 v[176:179], v7 offset:44032
  v_mfma_f32_16x16x32_bf16 v[120:123], v[140:143], v[80:83], v[120:123]
  ds_read_b128 v[180:183], v7 offset:45056
  s_waitcnt vmcnt(4) lgkmcnt(5)
  v_mfma_f32_16x16x32_bf16 v[104:107], v[144:147], v[84:87], v[104:107]
  s_lshl_b32 s29, s13, 1
  ds_read_b128 v[124:127], v7 offset:46080
  v_mfma_f32_16x16x32_bf16 v[108:111], v[148:151], v[84:87], v[108:111]
  ds_read_b128 v[128:131], v7 offset:47104
  v_mfma_f32_16x16x32_bf16 v[112:115], v[152:155], v[84:87], v[112:115]
  s_lshl_b32 s86, s72, 11
  ds_read_b128 v[132:135], v7 offset:48128
  v_mfma_f32_16x16x32_bf16 v[116:119], v[156:159], v[84:87], v[116:119]
  ds_read_b128 v[136:139], v7 offset:49152
  v_mfma_f32_16x16x32_bf16 v[120:123], v[160:163], v[84:87], v[120:123]
  s_add_u32 s86, s86, 124928
  ds_read_b128 v[140:143], v7 offset:50176
  s_waitcnt vmcnt(3) lgkmcnt(5)
  v_mfma_f32_16x16x32_bf16 v[104:107], v[164:167], v[88:91], v[104:107]
  ds_read_b128 v[144:147], v7 offset:51200
  v_mfma_f32_16x16x32_bf16 v[108:111], v[168:171], v[88:91], v[108:111]
  v_add_u32 v6, s86, v249
  ds_read_b128 v[148:151], v7 offset:52224
  v_mfma_f32_16x16x32_bf16 v[112:115], v[172:175], v[88:91], v[112:115]
  ds_read_b128 v[152:155], v7 offset:53248
  v_mfma_f32_16x16x32_bf16 v[116:119], v[176:179], v[88:91], v[116:119]
  v_and_b32 v216, 1, v3
  ds_read_b128 v[156:159], v7 offset:54272
  v_mfma_f32_16x16x32_bf16 v[120:123], v[180:183], v[88:91], v[120:123]
  ds_read_b128 v[160:163], v7 offset:55296
  s_waitcnt vmcnt(2) lgkmcnt(5)
  v_mfma_f32_16x16x32_bf16 v[104:107], v[124:127], v[92:95], v[104:107]
  v_mul_u32_u24 v216, 24, v216
  ds_read_b128 v[164:167], v7 offset:56320
  v_mfma_f32_16x16x32_bf16 v[108:111], v[128:131], v[92:95], v[108:111]
  ds_read_b128 v[168:171], v7 offset:57344
  v_mfma_f32_16x16x32_bf16 v[112:115], v[132:135], v[92:95], v[112:115]
  v_add_u32 v216, v216, v5
  ds_read_b128 v[172:175], v7 offset:58368
  v_mfma_f32_16x16x32_bf16 v[116:119], v[136:139], v[92:95], v[116:119]
  ds_read_b128 v[176:179], v7 offset:59392
  v_mfma_f32_16x16x32_bf16 v[120:123], v[140:143], v[92:95], v[120:123]
  ds_read_b128 v[180:183], v7 offset:60416
  s_waitcnt vmcnt(1) lgkmcnt(5)
  v_mfma_f32_16x16x32_bf16 v[104:107], v[144:147], v[96:99], v[104:107]
  v_mfma_f32_16x16x32_bf16 v[108:111], v[148:151], v[96:99], v[108:111]
  v_mfma_f32_16x16x32_bf16 v[112:115], v[152:155], v[96:99], v[112:115]
  v_mfma_f32_16x16x32_bf16 v[116:119], v[156:159], v[96:99], v[116:119]
  v_mfma_f32_16x16x32_bf16 v[120:123], v[160:163], v[96:99], v[120:123]
  s_waitcnt vmcnt(0) lgkmcnt(0)
  v_mfma_f32_16x16x32_bf16 v[104:107], v[164:167], v[100:103], v[104:107]
  v_mfma_f32_16x16x32_bf16 v[108:111], v[168:171], v[100:103], v[108:111]
  v_mfma_f32_16x16x32_bf16 v[112:115], v[172:175], v[100:103], v[112:115]
  v_mfma_f32_16x16x32_bf16 v[116:119], v[176:179], v[100:103], v[116:119]
  v_mfma_f32_16x16x32_bf16 v[120:123], v[180:183], v[100:103], v[120:123]
  s_nop 5
  ds_write_b128 v6, v[112:115]
  ds_write_b128 v6, v[116:119] offset:1024
  v_add_u32 v48, 0, v1
  v_min_u32 v48, 0, v48
  v_lshlrev_b32 v48, 6, v48
LP_118:
  buffer_load_dwordx2 v[40:41], v48, s[48:51], s32 offen sc1
  s_waitcnt vmcnt(0)
  v_cmp_ne_u64 vcc, s[42:43], v[40:41]
  s_cbranch_vccz LD_119
  s_add_u32 s95, s95, 1
  s_cmp_gt_u32 s95, 262144
  s_cbranch_scc1 LD_119
  s_sleep 1
  s_branch LP_118
LD_119:
  v_lshlrev_b32 v4, 3, v1
  buffer_load_dwordx4 v[76:79], v249, s[48:51], s30 offen sc1
  buffer_load_dwordx2 v[80:81], v4, s[48:51], s30 offen offset:2048 sc1
L_G4Q:
  s_waitcnt lgkmcnt(0)
  s_barrier
  s_waitcnt vmcnt(0)
L_G4R:
  v_lshlrev_b32 v64, 16, v76
  v_and_b32 v65, 0xffff0000, v76
  v_lshlrev_b32 v66, 16, v77
  v_and_b32 v67, 0xffff0000, v77
  v_pk_add_f32 v[40:41], v[104:105], v[64:65]
  v_pk_add_f32 v[42:43], v[106:107], v[66:67]
  v_fmac_f32_dpp v204, v184, v40 row_newbcast:0 row_mask:0xf bank_mask:0xf
  v_fmac_f32_dpp v205, v185, v41 row_newbcast:0 row_mask:0xf bank_mask:0xf
  v_fmac_f32_dpp v206, v184, v42 row_newbcast:2 row_mask:0xf bank_mask:0xf
  v_fmac_f32_dpp v207, v185, v43 row_newbcast:2 row_mask:0xf bank_mask:0xf
  v_cvt_pk_bf16_f32 v52, v204, v205
  v_cvt_pk_bf16_f32 v53, v206, v207
  v_lshlrev_b32 v68, 16, v78
  v_and_b32 v69, 0xffff0000, v78
  v_lshlrev_b32 v70, 16, v79
  v_and_b32 v71, 0xffff0000, v79
  v_pk_add_f32 v[44:45], v[108:109], v[68:69]
  v_pk_add_f32 v[46:47], v[110:111], v[70:71]
  v_fmac_f32_dpp v208, v184, v44 row_newbcast:4 row_mask:0xf bank_mask:0xf
  v_fmac_f32_dpp v209, v185, v45 row_newbcast:4 row_mask:0xf bank_mask:0xf
  v_fmac_f32_dpp v210, v184, v46 row_newbcast:6 row_mask:0xf bank_mask:0xf
  v_fmac_f32_dpp v211, v185, v47 row_newbcast:6 row_mask:0xf bank_mask:0xf
  v_cvt_pk_bf16_f32 v54, v208, v209
  v_cvt_pk_bf16_f32 v55, v210, v211
  s_nop 0
  v_permlane16_swap_b32 v52, v54
  v_permlane16_swap_b32 v53, v55
  buffer_store_dwordx4 v[52:55], v216, s[52:55], s28 offen
  s_cmp_lg_u32 s73, 0
  s_cbranch_scc1 L_FIN
  v_lshlrev_b32 v72, 16, v80
  v_and_b32 v73, 0xffff0000, v80
  v_lshlrev_b32 v74, 16, v81
  v_and_b32 v75, 0xffff0000, v81
  v_pk_add_f32 v[48:49], v[120:121], v[72:73]
  v_pk_add_f32 v[50:51], v[122:123], v[74:75]
  v_fmac_f32_dpp v212, v184, v48 row_newbcast:8 row_mask:0xf bank_mask:0xf
  v_fmac_f32_dpp v213, v185, v49 row_newbcast:8 row_mask:0xf bank_mask:0xf
  v_fmac_f32_dpp v214, v184, v50 row_newbcast:10 row_mask:0xf bank_mask:0xf
  v_fmac_f32_dpp v215, v185, v51 row_newbcast:10 row_mask:0xf bank_mask:0xf
  v_cvt_pk_bf16_f32 v56, v212, v213
  v_cvt_pk_bf16_f32 v57, v214, v215
  buffer_store_dwordx2 v[56:57], v5, s[52:55], s29 offen
L_FIN:
L_END:
  s_endpgm
LM_3:
  s_add_u32 s95, s95, 1
  s_cmp_gt_u32 s95, 262144
  s_cbranch_scc1 LM_4
  s_sleep 2
  buffer_load_dwordx4 v[224:227], v12, s[44:47], s72 offen sc1
  s_waitcnt vmcnt(0)
  s_branch LM_2
LM_6:
  s_add_u32 s95, s95, 1
  s_cmp_gt_u32 s95, 262144
  s_cbranch_scc1 LM_7
  s_sleep 2
  buffer_load_dwordx4 v[224:227], v12, s[44:47], s72 offen sc1
  s_waitcnt vmcnt(0)
  s_branch LM_5
LR_31:
  s_add_u32 s95, s95, 1
  s_cmp_gt_u32 s95, 262144
  s_cbranch_scc1 LK_32
  s_sleep 2
  s_mov_b64 exec, vcc
  buffer_load_dwordx4 v[96:99], v7, s[44:47], s78 offen sc1
  buffer_load_dwordx4 v[100:103], v8, s[44:47], s79 offen sc1
  s_mov_b64 exec, -1
  s_waitcnt vmcnt(0)
  s_branch LC_30
LR_34:
  s_add_u32 s95, s95, 1
  s_cmp_gt_u32 s95, 262144
  s_cbranch_scc1 LK_35
  s_sleep 2
  s_mov_b64 exec, vcc
  buffer_load_dwordx4 v[96:99], v7, s[44:47], s78 offen sc1
  s_mov_b64 exec, -1
  s_waitcnt vmcnt(0)
  s_branch LC_33
LR_39:
  s_add_u32 s95, s95, 1
  s_cmp_gt_u32 s95, 262144
  s_cbranch_scc1 LK_40
  s_sleep 1
  s_add_u32 s94, s35, 0
  buffer_load_dwordx4 v[16:19], v14, s[44:47], s94 offen sc1
  s_add_u32 s94, s94, 68096
  buffer_load_dwordx4 v[20:23], v14, s[44:47], s94 offen sc1
  s_waitcnt vmcnt(0)
  s_branch LC_38
LR_42:
  s_add_u32 s95, s95, 1
  s_cmp_gt_u32 s95, 262144
  s_cbranch_scc1 LK_43
  s_sleep 1
  s_add_u32 s94, s35, 136192
  buffer_load_dwordx4 v[24:27], v14, s[44:47], s94 offen sc1
  s_add_u32 s94, s94, 68096
  buffer_load_dwordx4 v[28:31], v14, s[44:47], s94 offen sc1
  s_waitcnt vmcnt(0)
  s_branch LC_41
LR_45:
  s_add_u32 s95, s95, 1
  s_cmp_gt_u32 s95, 262144
  s_cbranch_scc1 LK_46
  s_sleep 1
  s_add_u32 s94, s35, 272384
  buffer_load_dwordx4 v[32:35], v14, s[44:47], s94 offen sc1
  s_add_u32 s94, s94, 68096
  buffer_load_dwordx4 v[36:39], v14, s[44:47], s94 offen sc1
  s_waitcnt vmcnt(0)
  s_branch LC_44
LR_48:
  s_add_u32 s95, s95, 1
  s_cmp_gt_u32 s95, 262144
  s_cbranch_scc1 LK_49
  s_sleep 1
  s_add_u32 s94, s35, 408576
  buffer_load_dwordx4 v[40:43], v14, s[44:47], s94 offen sc1
  s_add_u32 s94, s94, 68096
  buffer_load_dwordx4 v[44:47], v14, s[44:47], s94 offen sc1
  s_waitcnt vmcnt(0)
  s_branch LC_47
LR_51:
  s_add_u32 s95, s95, 1
  s_cmp_gt_u32 s95, 262144
  s_cbranch_scc1 LK_52
  s_sleep 1
  s_add_u32 s94, s35, 544768
  buffer_load_dwordx4 v[48:51], v14, s[44:47], s94 offen sc1
  s_add_u32 s94, s94, 68096
  buffer_load_dwordx4 v[52:55], v14, s[44:47], s94 offen sc1
  s_waitcnt vmcnt(0)
  s_branch LC_50
LR_54:
  s_add_u32 s95, s95, 1
  s_cmp_gt_u32 s95, 262144
  s_cbranch_scc1 LK_55
  s_sleep 1
  s_add_u32 s94, s35, 680960
  buffer_load_dwordx4 v[56:59], v14, s[44:47], s94 offen sc1
  s_add_u32 s94, s94, 68096
  buffer_load_dwordx4 v[60:63], v14, s[44:47], s94 offen sc1
  s_waitcnt vmcnt(0)
  s_branch LC_53
LR_57:
  s_add_u32 s95, s95, 1
  s_cmp_gt_u32 s95, 262144
  s_cbranch_scc1 LK_58
  s_sleep 1
  s_add_u32 s94, s35, 817152
  buffer_load_dwordx4 v[64:67], v14, s[44:47], s94 offen sc1
  s_add_u32 s94, s94, 68096
  buffer_load_dwordx4 v[68:71], v14, s[44:47], s94 offen sc1
  s_waitcnt vmcnt(0)
  s_branch LC_56
LR_60:
  s_add_u32 s95, s95, 1
  s_cmp_gt_u32 s95, 262144
  s_cbranch_scc1 LK_61
  s_sleep 1
  s_add_u32 s94, s35, 953344
  buffer_load_dwordx4 v[72:75], v14, s[44:47], s94 offen sc1
  s_add_u32 s94, s94, 68096
  buffer_load_dwordx4 v[76:79], v14, s[44:47], s94 offen sc1
  s_waitcnt vmcnt(0)
  s_branch LC_59
LR_63:
  s_add_u32 s95, s95, 1
  s_cmp_gt_u32 s95, 262144
  s_cbranch_scc1 LK_64
  s_sleep 1
  s_add_u32 s94, s35, 1089536
  buffer_load_dwordx4 v[80:83], v14, s[44:47], s94 offen sc1
  s_add_u32 s94, s94, 68096
  buffer_load_dwordx4 v[84:87], v14, s[44:47], s94 offen sc1
  s_waitcnt vmcnt(0)
  s_branch LC_62
LR_66:
  s_add_u32 s95, s95, 1
  s_cmp_gt_u32 s95, 262144
  s_cbranch_scc1 LK_67
  s_sleep 1
  s_add_u32 s94, s35, 1225728
  buffer_load_dwordx4 v[88:91], v14, s[44:47], s94 offen sc1
  s_add_u32 s94, s94, 68096
  buffer_load_dwordx4 v[92:95], v14, s[44:47], s94 offen sc1
  s_waitcnt vmcnt(0)
  s_branch LC_65
LH_81:
  s_add_u32 s95, s95, 1
  s_cmp_gt_u32 s95, 262144
  s_cbranch_scc1 LH_83
  buffer_load_dwordx4 v[224:227], v220, s[48:51], s70 offen sc1
  s_waitcnt vmcnt(0)
  s_branch LH_82
LR_85:
  s_add_u32 s95, s95, 1
  s_cmp_gt_u32 s95, 262144
  s_cbranch_scc1 LK_86
  s_sleep 1
  v_mul_u32_u24 v5, 17024, v3
  v_lshl_add_u32 v5, v221, 3, v5
  s_mul_i32 s86, s76, 4256
  s_add_u32 s86, s86, 1048704
  buffer_load_dwordx2 v[232:233], v5, s[44:47], s86 offen sc1
  s_add_u32 s86, s86, 68096
  buffer_load_dwordx2 v[234:235], v5, s[44:47], s86 offen sc1
  s_mul_i32 s86, s13, 4256
  s_add_u32 s86, s86, 1048704
  buffer_load_dwordx2 v[236:237], v5, s[44:47], s86 offen sc1
  s_waitcnt vmcnt(0)
  s_branch LC_84
LH_87:
  s_add_u32 s95, s95, 1
  s_cmp_gt_u32 s95, 262144
  s_cbranch_scc1 LH_89
  buffer_load_dwordx4 v[224:227], v220, s[48:51], s70 offen sc1
  s_waitcnt vmcnt(0)
  s_branch LH_88
LR_91:
  s_add_u32 s95, s95, 1
  s_cmp_gt_u32 s95, 262144
  s_cbranch_scc1 LK_92
  s_sleep 1
  v_mul_u32_u24 v5, 17024, v3
  v_lshl_add_u32 v5, v221, 3, v5
  s_mul_i32 s86, s76, 4256
  s_add_u32 s86, s86, 1048704
  buffer_load_dwordx2 v[232:233], v5, s[44:47], s86 offen sc1
  s_add_u32 s86, s86, 68096
  buffer_load_dwordx2 v[234:235], v5, s[44:47], s86 offen sc1
  s_mul_i32 s86, s13, 4256
  s_add_u32 s86, s86, 1048704
  buffer_load_dwordx2 v[236:237], v5, s[44:47], s86 offen sc1
  s_waitcnt vmcnt(0)
  s_branch LC_90
L_GB1:
  s_add_u32 s95, s95, 1
  s_cmp_gt_u32 s95, 262144
  s_cbranch_scc1 L_GB2
  s_mov_b32 s86, 173056
  buffer_load_dwordx4 v[136:139], v10, s[44:47], s86 offen sc1
  s_waitcnt vmcnt(0)
  s_branch L_GB0
.section .rodata,"a"
.p2align 6
.amdhsa_kernel adaLN_cond__ssm_conv_s4d__mixer_s_mlp__prompt_kernel
  .amdhsa_next_free_vgpr 256
  .amdhsa_next_free_sgpr 102
  .amdhsa_accum_offset 256
  .amdhsa_group_segment_fixed_size 0
  .amdhsa_kernarg_size 136
  .amdhsa_user_sgpr_count 2
  .amdhsa_user_sgpr_kernarg_segment_ptr 1
  .amdhsa_system_sgpr_workgroup_id_x 1
.end_amdhsa_kernel
```
